```python
import torch

def _softmax(x, axis=-1):
    return torch.softmax(x, dim=axis)

def _gelu(x):
    return torch.nn.functional.gelu(x, approximate='tanh')

def _silu(x):
    return torch.nn.functional.silu(x)

def _sigmoid(x):
    return torch.sigmoid(x)

def _layernorm(x, axis=-1, eps=1e-05):
    m = x.mean(dim=axis, keepdim=True)
    v = x.var(dim=axis, keepdim=True, unbiased=False)
    return (x - m) / torch.sqrt(v + eps)

def _scatter_add(tgt, idx, src, axis=0):
    return tgt.clone().index_add_(axis, idx, src)

def _segment_sum(src, seg, n):
    out = torch.zeros((n,) + src.shape[1:], dtype=src.dtype)
    return out.index_add_(0, seg, src)

def _pad(x, pw):
    flat = tuple((v for pair in reversed(pw) for v in pair))
    return torch.nn.functional.pad(x, flat)
kernel_name = 'adaLN_cond__memory_aug_recurrent_mem_tr__dense_activation_gelu__prompt'

def setup_inputs():

    _w = lambda a: (lambda t: t.to(torch.bfloat16) if t.is_floating_point() else t)(torch.as_tensor(a))

    def _A_setup():
        B, S, Dm = (1, 2048, 512)
        H, Dh = (32, 128)
        M, seg = (8, 32)
        seg = min(seg, S)
        S = S // seg * seg
        return {'x': _w((lambda *s: torch.randn(*s, dtype=torch.bfloat16) * 0.05)(B, S, Dm)), 'mem0': _w((lambda *s: torch.randn(*s, dtype=torch.bfloat16) * 0.8)(B, M, Dm)), 'Wq': _w((lambda *s: torch.randn(*s, dtype=torch.bfloat16) * 0.8)(Dm, H, Dh) * Dm ** (-0.5)), 'Wk': _w((lambda *s: torch.randn(*s, dtype=torch.bfloat16) * 0.8)(Dm, H, Dh) * Dm ** (-0.5)), 'Wv': _w((lambda *s: torch.randn(*s, dtype=torch.bfloat16) * 0.8)(Dm, H, Dh) * Dm ** (-0.5)), 'Wo': _w((lambda *s: torch.randn(*s, dtype=torch.bfloat16) * 0.8)(H, Dh, Dm) * (H * Dh) ** (-0.5)), 'seg_len': seg}
    _A_in = _A_setup()

    def _B_setup():
        B, S, D, F = (1, 2048, 512, 1792)
        return {'x': _w((lambda *s: torch.randn(*s, dtype=torch.bfloat16) * 0.05)(B, S, D)), 'w1': _w((lambda *s: torch.randn(*s, dtype=torch.bfloat16) * 0.8)(D, F) * D ** (-0.5)), 'b1': _w((lambda *s: torch.randn(*s, dtype=torch.bfloat16) * 12.8)(F) * 0.01), 'w2': _w((lambda *s: torch.randn(*s, dtype=torch.bfloat16) * 0.4)(F, D) * F ** (-0.5)), 'b2': _w((lambda *s: torch.randn(*s, dtype=torch.bfloat16) * 6.4)(D) * 0.01)}
    _B_in = _B_setup()
    return {'A_x': _A_in['x'], 'A_mem0': _A_in['mem0'], 'A_Wq': _A_in['Wq'], 'A_Wk': _A_in['Wk'], 'A_Wv': _A_in['Wv'], 'A_Wo': _A_in['Wo'], 'A_seg_len': _A_in['seg_len'], 'B_x': _B_in['x'], 'B_w1': _B_in['w1'], 'B_b1': _B_in['b1'], 'B_w2': _B_in['w2'], 'B_b2': _B_in['b2'], 'c': _w((lambda *s: torch.randn(*s, dtype=torch.bfloat16) * 0.1)(1, 512) * 8.0), 'w_mod': _w((lambda *s: torch.randn(*s, dtype=torch.bfloat16) * 0.1)(512, 6 * 512) * 512 ** (-0.5) * 8.0)}

def reference(A_x, A_mem0, A_Wq, A_Wk, A_Wv, A_Wo, A_seg_len, B_x, B_w1, B_b1, B_w2, B_b2, c, w_mod):

    def _A_ref(x, mem0, Wq, Wk, Wv, Wo, seg_len):
        B, S, Dm = x.shape
        H, Dh = (Wq.shape[1], Wq.shape[2])
        M = mem0.shape[1]
        scale = Dh ** (-0.5)
        n_seg = S // seg_len
        L = M + seg_len
        idx = torch.arange(L)
        mask = (idx[:, None] < M) | (idx[:, None] >= idx[None, :])
        mem = mem0
        outs = []
        for s in range(n_seg):
            xs = x[:, s * seg_len:(s + 1) * seg_len, :].clone()
            h = torch.concatenate([mem, xs], axis=1)
            q = torch.einsum('btd,dhe->bhte', h, Wq)
            k = torch.einsum('btd,dhe->bhte', h, Wk)
            v = torch.einsum('btd,dhe->bhte', h, Wv)
            scores = torch.einsum('bhqe,bhke->bhqk', q, k) * scale
            scores = torch.where(mask[None, None], scores, -1000000000.0)
            p = _softmax(scores, axis=-1)
            o = torch.einsum('bhqk,bhke->bhqe', p, v)
            o = torch.einsum('bhte,hed->btd', o, Wo)
            mem = o[:, :M, :].clone()
            outs.append(o[:, M:, :])
        return torch.concatenate(outs, axis=1)

    def _B_ref(x, w1, b1, w2, b2):
        h = torch.einsum('bsd,df->bsf', x, w1) + b1
        h = _gelu(h)
        return torch.einsum('bsf,fd->bsd', h, w2) + b2
    x = A_x
    mod = (_silu(c) @ w_mod).reshape(c.shape[0], 6, 1, -1)
    sa, ca, ga, sb, cb, gb = (mod[:, 0].clone(), mod[:, 1].clone(), mod[:, 2].clone(), mod[:, 3].clone(), mod[:, 4].clone(), mod[:, 5].clone())
    h = _layernorm(x, axis=-1) * (1 + ca) + sa
    x = x + ga * _A_ref(h, A_mem0, A_Wq, A_Wk, A_Wv, A_Wo, A_seg_len)
    h = _layernorm(x, axis=-1) * (1 + cb) + sb
    x = x + gb * _B_ref(h, B_w1, B_b1, B_w2, B_b2)
    return x
```

```asm
; @launch grid=(256,1,1) block=(256,1,1) lds=163840
.amdgcn_target "amdgcn-amd-amdhsa--gfx950"
.text
.globl adaLN_cond__memory_aug_recurrent_mem_tr__dense_activation_gelu__prompt_kernel
.p2align 8
.type adaLN_cond__memory_aug_recurrent_mem_tr__dense_activation_gelu__prompt_kernel,@function
adaLN_cond__memory_aug_recurrent_mem_tr__dense_activation_gelu__prompt_kernel:
s_cmp_ge_u32 s2, 256
s_cbranch_scc1 L_end
s_load_dwordx2 s[4:5], s[0:1], 128
s_mov_b32 s6, 268435456
s_mov_b32 s7, 0x20000
s_load_dwordx2 s[28:29], s[0:1], 120
s_mov_b32 s30, 256
s_mov_b32 s31, 0x20000
v_lshrrev_b32 v1, 6, v0
s_mov_b32 s51, 0
v_readfirstlane_b32 s33, v1
s_getreg_b32 s63, hwreg(HW_REG_XCC_ID)
s_and_b32 s63, s63, 7
v_mov_b32 v2, 0
s_waitcnt lgkmcnt(0)
s_cmp_lg_u32 s33, 0
s_cbranch_scc1 L_arr
s_cmp_lg_u32 s2, 0
s_cbranch_scc1 L_nodt
L_nodt:
s_mov_b64 exec, 0xff
v_mov_b32 v4, 0
v_mov_b32 v5, 0
v_mov_b32 v6, 0
v_mov_b32 v7, 0
v_lshlrev_b32 v3, 4, v0
s_lshl_b32 s40, s2, 7
s_add_u32 s40, s40, 51380224
buffer_store_dwordx4 v[4:7], v3, s[4:7], s40 offen sc1
s_mov_b64 exec, -1
v_mov_b32 v8, -1
v_mov_b32 v9, -1
v_mov_b32 v10, -1
v_mov_b32 v11, -1
v_lshlrev_b32 v3, 4, v0
s_mul_i32 s41, s2, 2048
s_add_u32 s41, s41, 46137344
buffer_store_dwordx4 v[8:11], v3, s[4:7], s41 offen offset:0 sc1
buffer_store_dwordx4 v[8:11], v3, s[4:7], s41 offen offset:1024 sc1
s_mov_b64 exec, 0xff
s_add_u32 s40, s40, 4290772992
buffer_store_dwordx4 v[8:11], v3, s[4:7], s40 offen sc1
s_waitcnt vmcnt(0)
s_mov_b64 exec, -1
s_and_b32 s41, s2, 7
s_lshl_b32 s41, s41, 3
s_lshl_b64 s[42:43], 1, s41
v_mov_b32 v126, s42
v_mov_b32 v127, s43
s_mov_b64 exec, 1
s_lshl_b32 s40, s63, 3
buffer_atomic_add_x2 v[126:127], off, s[28:31], s40 offset:128 sc0
s_mov_b64 exec, -1
L_arr:
s_mov_b32 s71, 0
s_mov_b32 s58, s63
s_lshr_b32 s32, s2, 3
L_pre:
s_cmp_eq_u32 s58, 0
s_cbranch_scc1 L_spec_ch
s_cmp_le_u32 s58, 2
s_cbranch_scc1 L_spec_kv
s_sub_u32 s101, s58, 3
s_lshl_b32 s101, s101, 5
s_add_u32 s101, s101, s32
s_cmp_ge_u32 s101, 128
s_cbranch_scc1 L_pre_mod
s_load_dwordx2 s[8:9], s[0:1], 0
s_mov_b32 s10, 2097152
s_mov_b32 s11, 0x20000
v_and_b32 v1, 63, v0
v_and_b32 v2, 15, v0
v_lshrrev_b32 v3, 4, v1
v_lshrrev_b32 v4, 2, v2
v_and_b32 v5, 3, v0
v_lshlrev_b32 v6, 10, v2
v_lshl_add_u32 v6, v3, 4, v6
s_lshl_b32 s41, s101, 14
s_lshl_b32 s42, s33, 8
s_add_u32 s41, s41, s42
s_waitcnt lgkmcnt(0)
buffer_load_dwordx4 v[16:19], v6, s[8:11], s41 offen offset:0
buffer_load_dwordx4 v[20:23], v6, s[8:11], s41 offen offset:64
buffer_load_dwordx4 v[24:27], v6, s[8:11], s41 offen offset:128
buffer_load_dwordx4 v[28:31], v6, s[8:11], s41 offen offset:192
s_cmp_lg_u32 s71, 0
s_cbranch_scc1 L_pf1
s_cmp_eq_u32 s33, 0
s_cbranch_scc1 L_pf1
v_and_b32 v7, 63, v0
v_lshlrev_b32 v7, 4, v7
s_load_dwordx2 s[12:13], s[0:1], 16
s_mov_b32 s14, 4194304
s_mov_b32 s15, 0x20000
s_lshl_b32 s41, s101, 15
s_mul_i32 s42, s33, 11264
s_add_u32 s41, s41, s42
s_sub_u32 s41, s41, 11264
s_waitcnt lgkmcnt(0)
buffer_load_dwordx4 v[96:99], v7, s[12:15], s41 offen offset:0
buffer_load_dwordx4 v[100:103], v7, s[12:15], s41 offen offset:1024
buffer_load_dwordx4 v[104:107], v7, s[12:15], s41 offen offset:2048
buffer_load_dwordx4 v[108:111], v7, s[12:15], s41 offen offset:3072
s_add_u32 s41, s41, 4096
buffer_load_dwordx4 v[112:115], v7, s[12:15], s41 offen offset:0
buffer_load_dwordx4 v[116:119], v7, s[12:15], s41 offen offset:1024
buffer_load_dwordx4 v[96:99], v7, s[12:15], s41 offen offset:2048
buffer_load_dwordx4 v[100:103], v7, s[12:15], s41 offen offset:3072
s_add_u32 s41, s41, 4096
buffer_load_dwordx4 v[104:107], v7, s[12:15], s41 offen offset:0
buffer_load_dwordx4 v[108:111], v7, s[12:15], s41 offen offset:1024
buffer_load_dwordx4 v[112:115], v7, s[12:15], s41 offen offset:2048
s_load_dwordx2 s[12:13], s[0:1], 24
s_mov_b32 s14, 4194304
s_mov_b32 s15, 0x20000
s_lshl_b32 s41, s101, 15
s_mul_i32 s42, s33, 11264
s_add_u32 s41, s41, s42
s_sub_u32 s41, s41, 11264
s_waitcnt lgkmcnt(0)
buffer_load_dwordx4 v[96:99], v7, s[12:15], s41 offen offset:0
buffer_load_dwordx4 v[100:103], v7, s[12:15], s41 offen offset:1024
buffer_load_dwordx4 v[104:107], v7, s[12:15], s41 offen offset:2048
buffer_load_dwordx4 v[108:111], v7, s[12:15], s41 offen offset:3072
s_add_u32 s41, s41, 4096
buffer_load_dwordx4 v[112:115], v7, s[12:15], s41 offen offset:0
buffer_load_dwordx4 v[116:119], v7, s[12:15], s41 offen offset:1024
buffer_load_dwordx4 v[96:99], v7, s[12:15], s41 offen offset:2048
buffer_load_dwordx4 v[100:103], v7, s[12:15], s41 offen offset:3072
s_add_u32 s41, s41, 4096
buffer_load_dwordx4 v[104:107], v7, s[12:15], s41 offen offset:0
buffer_load_dwordx4 v[108:111], v7, s[12:15], s41 offen offset:1024
buffer_load_dwordx4 v[112:115], v7, s[12:15], s41 offen offset:2048
s_load_dwordx2 s[12:13], s[0:1], 32
s_mov_b32 s14, 4194304
s_mov_b32 s15, 0x20000
s_lshl_b32 s41, s101, 15
s_mul_i32 s42, s33, 11264
s_add_u32 s41, s41, s42
s_sub_u32 s41, s41, 11264
s_waitcnt lgkmcnt(0)
buffer_load_dwordx4 v[96:99], v7, s[12:15], s41 offen offset:0
buffer_load_dwordx4 v[100:103], v7, s[12:15], s41 offen offset:1024
buffer_load_dwordx4 v[104:107], v7, s[12:15], s41 offen offset:2048
buffer_load_dwordx4 v[108:111], v7, s[12:15], s41 offen offset:3072
s_add_u32 s41, s41, 4096
buffer_load_dwordx4 v[112:115], v7, s[12:15], s41 offen offset:0
buffer_load_dwordx4 v[116:119], v7, s[12:15], s41 offen offset:1024
buffer_load_dwordx4 v[96:99], v7, s[12:15], s41 offen offset:2048
buffer_load_dwordx4 v[100:103], v7, s[12:15], s41 offen offset:3072
s_add_u32 s41, s41, 4096
buffer_load_dwordx4 v[104:107], v7, s[12:15], s41 offen offset:0
buffer_load_dwordx4 v[108:111], v7, s[12:15], s41 offen offset:1024
buffer_load_dwordx4 v[112:115], v7, s[12:15], s41 offen offset:2048
s_load_dwordx2 s[12:13], s[0:1], 40
s_mov_b32 s14, 4194304
s_mov_b32 s15, 0x20000
s_lshl_b32 s41, s101, 15
s_mul_i32 s42, s33, 11264
s_add_u32 s41, s41, s42
s_sub_u32 s41, s41, 11264
s_waitcnt lgkmcnt(0)
buffer_load_dwordx4 v[96:99], v7, s[12:15], s41 offen offset:0
buffer_load_dwordx4 v[100:103], v7, s[12:15], s41 offen offset:1024
buffer_load_dwordx4 v[104:107], v7, s[12:15], s41 offen offset:2048
buffer_load_dwordx4 v[108:111], v7, s[12:15], s41 offen offset:3072
s_add_u32 s41, s41, 4096
buffer_load_dwordx4 v[112:115], v7, s[12:15], s41 offen offset:0
buffer_load_dwordx4 v[116:119], v7, s[12:15], s41 offen offset:1024
buffer_load_dwordx4 v[96:99], v7, s[12:15], s41 offen offset:2048
buffer_load_dwordx4 v[100:103], v7, s[12:15], s41 offen offset:3072
s_add_u32 s41, s41, 4096
buffer_load_dwordx4 v[104:107], v7, s[12:15], s41 offen offset:0
buffer_load_dwordx4 v[108:111], v7, s[12:15], s41 offen offset:1024
buffer_load_dwordx4 v[112:115], v7, s[12:15], s41 offen offset:2048
s_waitcnt vmcnt(44)
s_branch L_pg1
L_pf1:
s_waitcnt vmcnt(0)
L_pg1:
v_lshlrev_b32 v32, 16, v16
v_and_b32 v33, 0xffff0000, v16
v_lshlrev_b32 v34, 16, v17
v_and_b32 v35, 0xffff0000, v17
v_lshlrev_b32 v36, 16, v18
v_and_b32 v37, 0xffff0000, v18
v_lshlrev_b32 v38, 16, v19
v_and_b32 v39, 0xffff0000, v19
v_lshlrev_b32 v40, 16, v20
v_and_b32 v41, 0xffff0000, v20
v_lshlrev_b32 v42, 16, v21
v_and_b32 v43, 0xffff0000, v21
v_lshlrev_b32 v44, 16, v22
v_and_b32 v45, 0xffff0000, v22
v_lshlrev_b32 v46, 16, v23
v_and_b32 v47, 0xffff0000, v23
v_lshlrev_b32 v48, 16, v24
v_and_b32 v49, 0xffff0000, v24
v_lshlrev_b32 v50, 16, v25
v_and_b32 v51, 0xffff0000, v25
v_lshlrev_b32 v52, 16, v26
v_and_b32 v53, 0xffff0000, v26
v_lshlrev_b32 v54, 16, v27
v_and_b32 v55, 0xffff0000, v27
v_lshlrev_b32 v56, 16, v28
v_and_b32 v57, 0xffff0000, v28
v_lshlrev_b32 v58, 16, v29
v_and_b32 v59, 0xffff0000, v29
v_lshlrev_b32 v60, 16, v30
v_and_b32 v61, 0xffff0000, v30
v_lshlrev_b32 v62, 16, v31
v_and_b32 v63, 0xffff0000, v31
v_add_f32 v8, v32, v33
v_add_f32 v8, v8, v34
v_add_f32 v8, v8, v35
v_add_f32 v8, v8, v36
v_add_f32 v8, v8, v37
v_add_f32 v8, v8, v38
v_add_f32 v8, v8, v39
v_add_f32 v8, v8, v40
v_add_f32 v8, v8, v41
v_add_f32 v8, v8, v42
v_add_f32 v8, v8, v43
v_add_f32 v8, v8, v44
v_add_f32 v8, v8, v45
v_add_f32 v8, v8, v46
v_add_f32 v8, v8, v47
v_add_f32 v8, v8, v48
v_add_f32 v8, v8, v49
v_add_f32 v8, v8, v50
v_add_f32 v8, v8, v51
v_add_f32 v8, v8, v52
v_add_f32 v8, v8, v53
v_add_f32 v8, v8, v54
v_add_f32 v8, v8, v55
v_add_f32 v8, v8, v56
v_add_f32 v8, v8, v57
v_add_f32 v8, v8, v58
v_add_f32 v8, v8, v59
v_add_f32 v8, v8, v60
v_add_f32 v8, v8, v61
v_add_f32 v8, v8, v62
v_add_f32 v8, v8, v63
v_mov_b32 v9, v8
s_nop 1
v_permlane16_swap_b32 v8, v9
v_add_f32 v8, v8, v9
v_mov_b32 v9, v8
s_nop 1
v_permlane32_swap_b32 v8, v9
v_add_f32 v8, v8, v9
s_lshl_b32 s42, s33, 6
v_lshlrev_b32 v9, 2, v2
v_add_u32 v10, s42, v9
ds_write_b32 v10, v8 offset:0
s_waitcnt lgkmcnt(0)
s_barrier
ds_read_b32 v12, v9 offset:0
ds_read_b32 v13, v9 offset:64
ds_read_b32 v14, v9 offset:128
ds_read_b32 v15, v9 offset:192
s_waitcnt lgkmcnt(0)
v_add_f32 v12, v12, v13
v_add_f32 v14, v14, v15
v_add_f32 v8, v12, v14
v_mul_f32 v8, 0x3b000000, v8
v_sub_f32 v32, v32, v8
v_sub_f32 v33, v33, v8
v_sub_f32 v34, v34, v8
v_sub_f32 v35, v35, v8
v_sub_f32 v36, v36, v8
v_sub_f32 v37, v37, v8
v_sub_f32 v38, v38, v8
v_sub_f32 v39, v39, v8
v_sub_f32 v40, v40, v8
v_sub_f32 v41, v41, v8
v_sub_f32 v42, v42, v8
v_sub_f32 v43, v43, v8
v_sub_f32 v44, v44, v8
v_sub_f32 v45, v45, v8
v_sub_f32 v46, v46, v8
v_sub_f32 v47, v47, v8
v_sub_f32 v48, v48, v8
v_sub_f32 v49, v49, v8
v_sub_f32 v50, v50, v8
v_sub_f32 v51, v51, v8
v_sub_f32 v52, v52, v8
v_sub_f32 v53, v53, v8
v_sub_f32 v54, v54, v8
v_sub_f32 v55, v55, v8
v_sub_f32 v56, v56, v8
v_sub_f32 v57, v57, v8
v_sub_f32 v58, v58, v8
v_sub_f32 v59, v59, v8
v_sub_f32 v60, v60, v8
v_sub_f32 v61, v61, v8
v_sub_f32 v62, v62, v8
v_sub_f32 v63, v63, v8
v_mul_f32 v8, v32, v32
v_fmac_f32 v8, v33, v33
v_fmac_f32 v8, v34, v34
v_fmac_f32 v8, v35, v35
v_fmac_f32 v8, v36, v36
v_fmac_f32 v8, v37, v37
v_fmac_f32 v8, v38, v38
v_fmac_f32 v8, v39, v39
v_fmac_f32 v8, v40, v40
v_fmac_f32 v8, v41, v41
v_fmac_f32 v8, v42, v42
v_fmac_f32 v8, v43, v43
v_fmac_f32 v8, v44, v44
v_fmac_f32 v8, v45, v45
v_fmac_f32 v8, v46, v46
v_fmac_f32 v8, v47, v47
v_fmac_f32 v8, v48, v48
v_fmac_f32 v8, v49, v49
v_fmac_f32 v8, v50, v50
v_fmac_f32 v8, v51, v51
v_fmac_f32 v8, v52, v52
v_fmac_f32 v8, v53, v53
v_fmac_f32 v8, v54, v54
v_fmac_f32 v8, v55, v55
v_fmac_f32 v8, v56, v56
v_fmac_f32 v8, v57, v57
v_fmac_f32 v8, v58, v58
v_fmac_f32 v8, v59, v59
v_fmac_f32 v8, v60, v60
v_fmac_f32 v8, v61, v61
v_fmac_f32 v8, v62, v62
v_fmac_f32 v8, v63, v63
v_mov_b32 v9, v8
s_nop 1
v_permlane16_swap_b32 v8, v9
v_add_f32 v8, v8, v9
v_mov_b32 v9, v8
s_nop 1
v_permlane32_swap_b32 v8, v9
v_add_f32 v8, v8, v9
s_lshl_b32 s42, s33, 6
v_lshlrev_b32 v9, 2, v2
v_add_u32 v10, s42, v9
ds_write_b32 v10, v8 offset:256
s_waitcnt lgkmcnt(0)
s_barrier
ds_read_b32 v12, v9 offset:256
ds_read_b32 v13, v9 offset:320
ds_read_b32 v14, v9 offset:384
ds_read_b32 v15, v9 offset:448
s_waitcnt lgkmcnt(0)
v_add_f32 v12, v12, v13
v_add_f32 v14, v14, v15
v_add_f32 v8, v12, v14
v_mov_b32 v9, 0x3727c5ac
v_fmac_f32 v9, 0x3b000000, v8
v_rsq_f32 v8, v9
s_mov_b32 s70, 3
s_branch L_decide0
L_pre_mod:
s_mov_b32 s70, 5
s_cmp_ge_u32 s101, 160
s_cbranch_scc1 L_decide0
s_sub_u32 s101, s101, 128
s_load_dwordx2 s[8:9], s[0:1], 96
s_mov_b32 s10, 1024
s_mov_b32 s11, 0x20000
s_load_dwordx2 s[12:13], s[0:1], 104
s_mov_b32 s14, 3145728
s_mov_b32 s15, 0x20000
s_waitcnt lgkmcnt(0)
v_lshlrev_b32 v1, 2, v0
buffer_load_dword v2, v1, s[8:11], 0 offen
v_lshrrev_b32 v3, 3, v0
v_mul_u32_u24 v3, 6144, v3
v_and_b32 v4, 7, v0
v_lshl_add_u32 v3, v4, 4, v3
s_lshl_b32 s41, s101, 7
buffer_load_dwordx4 v[32:35], v3, s[12:15], s41 offen
s_add_u32 s41, s41, 196608
buffer_load_dwordx4 v[36:39], v3, s[12:15], s41 offen
s_add_u32 s41, s41, 196608
buffer_load_dwordx4 v[40:43], v3, s[12:15], s41 offen
s_add_u32 s41, s41, 196608
buffer_load_dwordx4 v[44:47], v3, s[12:15], s41 offen
s_add_u32 s41, s41, 196608
buffer_load_dwordx4 v[48:51], v3, s[12:15], s41 offen
s_add_u32 s41, s41, 196608
buffer_load_dwordx4 v[52:55], v3, s[12:15], s41 offen
s_add_u32 s41, s41, 196608
buffer_load_dwordx4 v[56:59], v3, s[12:15], s41 offen
s_add_u32 s41, s41, 196608
buffer_load_dwordx4 v[60:63], v3, s[12:15], s41 offen
s_add_u32 s41, s41, 196608
buffer_load_dwordx4 v[64:67], v3, s[12:15], s41 offen
s_add_u32 s41, s41, 196608
buffer_load_dwordx4 v[68:71], v3, s[12:15], s41 offen
s_add_u32 s41, s41, 196608
buffer_load_dwordx4 v[72:75], v3, s[12:15], s41 offen
s_add_u32 s41, s41, 196608
buffer_load_dwordx4 v[76:79], v3, s[12:15], s41 offen
s_add_u32 s41, s41, 196608
buffer_load_dwordx4 v[80:83], v3, s[12:15], s41 offen
s_add_u32 s41, s41, 196608
buffer_load_dwordx4 v[84:87], v3, s[12:15], s41 offen
s_add_u32 s41, s41, 196608
buffer_load_dwordx4 v[88:91], v3, s[12:15], s41 offen
s_add_u32 s41, s41, 196608
buffer_load_dwordx4 v[92:95], v3, s[12:15], s41 offen
s_waitcnt vmcnt(16)
v_lshlrev_b32 v4, 16, v2
v_and_b32 v5, 0xffff0000, v2
v_mul_f32 v6, 0xbfb8aa3b, v4
v_exp_f32 v6, v6
s_nop 0
v_add_f32 v6, 1.0, v6
v_rcp_f32 v6, v6
s_nop 0
v_mul_f32 v4, v4, v6
v_mul_f32 v7, 0xbfb8aa3b, v5
v_exp_f32 v7, v7
s_nop 0
v_add_f32 v7, 1.0, v7
v_rcp_f32 v7, v7
s_nop 0
v_mul_f32 v5, v5, v7
v_cvt_pk_bf16_f32 v2, v4, v5
v_lshlrev_b32 v4, 16, v2
v_and_b32 v5, 0xffff0000, v2
v_lshlrev_b32 v6, 3, v0
ds_write_b64 v6, v[4:5]
s_waitcnt lgkmcnt(0)
s_barrier
v_lshrrev_b32 v6, 3, v0
v_lshlrev_b32 v6, 2, v6
ds_read_b32 v16, v6 offset:0
ds_read_b32 v17, v6 offset:128
ds_read_b32 v18, v6 offset:256
ds_read_b32 v19, v6 offset:384
ds_read_b32 v20, v6 offset:512
ds_read_b32 v21, v6 offset:640
ds_read_b32 v22, v6 offset:768
ds_read_b32 v23, v6 offset:896
ds_read_b32 v24, v6 offset:1024
ds_read_b32 v25, v6 offset:1152
ds_read_b32 v26, v6 offset:1280
ds_read_b32 v27, v6 offset:1408
ds_read_b32 v28, v6 offset:1536
ds_read_b32 v29, v6 offset:1664
ds_read_b32 v30, v6 offset:1792
ds_read_b32 v31, v6 offset:1920
v_mov_b32 v8, 0
v_mov_b32 v9, 0
v_mov_b32 v10, 0
v_mov_b32 v11, 0
v_mov_b32 v12, 0
v_mov_b32 v13, 0
v_mov_b32 v14, 0
v_mov_b32 v15, 0
s_waitcnt lgkmcnt(0)
s_waitcnt vmcnt(15)
v_lshlrev_b32 v4, 16, v32
v_and_b32 v5, 0xffff0000, v32
v_fmac_f32 v8, v4, v16
v_fmac_f32 v9, v5, v16
v_lshlrev_b32 v4, 16, v33
v_and_b32 v5, 0xffff0000, v33
v_fmac_f32 v10, v4, v16
v_fmac_f32 v11, v5, v16
v_lshlrev_b32 v4, 16, v34
v_and_b32 v5, 0xffff0000, v34
v_fmac_f32 v12, v4, v16
v_fmac_f32 v13, v5, v16
v_lshlrev_b32 v4, 16, v35
v_and_b32 v5, 0xffff0000, v35
v_fmac_f32 v14, v4, v16
v_fmac_f32 v15, v5, v16
s_waitcnt vmcnt(14)
v_lshlrev_b32 v4, 16, v36
v_and_b32 v5, 0xffff0000, v36
v_fmac_f32 v8, v4, v17
v_fmac_f32 v9, v5, v17
v_lshlrev_b32 v4, 16, v37
v_and_b32 v5, 0xffff0000, v37
v_fmac_f32 v10, v4, v17
v_fmac_f32 v11, v5, v17
v_lshlrev_b32 v4, 16, v38
v_and_b32 v5, 0xffff0000, v38
v_fmac_f32 v12, v4, v17
v_fmac_f32 v13, v5, v17
v_lshlrev_b32 v4, 16, v39
v_and_b32 v5, 0xffff0000, v39
v_fmac_f32 v14, v4, v17
v_fmac_f32 v15, v5, v17
s_waitcnt vmcnt(13)
v_lshlrev_b32 v4, 16, v40
v_and_b32 v5, 0xffff0000, v40
v_fmac_f32 v8, v4, v18
v_fmac_f32 v9, v5, v18
v_lshlrev_b32 v4, 16, v41
v_and_b32 v5, 0xffff0000, v41
v_fmac_f32 v10, v4, v18
v_fmac_f32 v11, v5, v18
v_lshlrev_b32 v4, 16, v42
v_and_b32 v5, 0xffff0000, v42
v_fmac_f32 v12, v4, v18
v_fmac_f32 v13, v5, v18
v_lshlrev_b32 v4, 16, v43
v_and_b32 v5, 0xffff0000, v43
v_fmac_f32 v14, v4, v18
v_fmac_f32 v15, v5, v18
s_waitcnt vmcnt(12)
v_lshlrev_b32 v4, 16, v44
v_and_b32 v5, 0xffff0000, v44
v_fmac_f32 v8, v4, v19
v_fmac_f32 v9, v5, v19
v_lshlrev_b32 v4, 16, v45
v_and_b32 v5, 0xffff0000, v45
v_fmac_f32 v10, v4, v19
v_fmac_f32 v11, v5, v19
v_lshlrev_b32 v4, 16, v46
v_and_b32 v5, 0xffff0000, v46
v_fmac_f32 v12, v4, v19
v_fmac_f32 v13, v5, v19
v_lshlrev_b32 v4, 16, v47
v_and_b32 v5, 0xffff0000, v47
v_fmac_f32 v14, v4, v19
v_fmac_f32 v15, v5, v19
s_waitcnt vmcnt(11)
v_lshlrev_b32 v4, 16, v48
v_and_b32 v5, 0xffff0000, v48
v_fmac_f32 v8, v4, v20
v_fmac_f32 v9, v5, v20
v_lshlrev_b32 v4, 16, v49
v_and_b32 v5, 0xffff0000, v49
v_fmac_f32 v10, v4, v20
v_fmac_f32 v11, v5, v20
v_lshlrev_b32 v4, 16, v50
v_and_b32 v5, 0xffff0000, v50
v_fmac_f32 v12, v4, v20
v_fmac_f32 v13, v5, v20
v_lshlrev_b32 v4, 16, v51
v_and_b32 v5, 0xffff0000, v51
v_fmac_f32 v14, v4, v20
v_fmac_f32 v15, v5, v20
s_waitcnt vmcnt(10)
v_lshlrev_b32 v4, 16, v52
v_and_b32 v5, 0xffff0000, v52
v_fmac_f32 v8, v4, v21
v_fmac_f32 v9, v5, v21
v_lshlrev_b32 v4, 16, v53
v_and_b32 v5, 0xffff0000, v53
v_fmac_f32 v10, v4, v21
v_fmac_f32 v11, v5, v21
v_lshlrev_b32 v4, 16, v54
v_and_b32 v5, 0xffff0000, v54
v_fmac_f32 v12, v4, v21
v_fmac_f32 v13, v5, v21
v_lshlrev_b32 v4, 16, v55
v_and_b32 v5, 0xffff0000, v55
v_fmac_f32 v14, v4, v21
v_fmac_f32 v15, v5, v21
s_waitcnt vmcnt(9)
v_lshlrev_b32 v4, 16, v56
v_and_b32 v5, 0xffff0000, v56
v_fmac_f32 v8, v4, v22
v_fmac_f32 v9, v5, v22
v_lshlrev_b32 v4, 16, v57
v_and_b32 v5, 0xffff0000, v57
v_fmac_f32 v10, v4, v22
v_fmac_f32 v11, v5, v22
v_lshlrev_b32 v4, 16, v58
v_and_b32 v5, 0xffff0000, v58
v_fmac_f32 v12, v4, v22
v_fmac_f32 v13, v5, v22
v_lshlrev_b32 v4, 16, v59
v_and_b32 v5, 0xffff0000, v59
v_fmac_f32 v14, v4, v22
v_fmac_f32 v15, v5, v22
s_waitcnt vmcnt(8)
v_lshlrev_b32 v4, 16, v60
v_and_b32 v5, 0xffff0000, v60
v_fmac_f32 v8, v4, v23
v_fmac_f32 v9, v5, v23
v_lshlrev_b32 v4, 16, v61
v_and_b32 v5, 0xffff0000, v61
v_fmac_f32 v10, v4, v23
v_fmac_f32 v11, v5, v23
v_lshlrev_b32 v4, 16, v62
v_and_b32 v5, 0xffff0000, v62
v_fmac_f32 v12, v4, v23
v_fmac_f32 v13, v5, v23
v_lshlrev_b32 v4, 16, v63
v_and_b32 v5, 0xffff0000, v63
v_fmac_f32 v14, v4, v23
v_fmac_f32 v15, v5, v23
s_waitcnt vmcnt(7)
v_lshlrev_b32 v4, 16, v64
v_and_b32 v5, 0xffff0000, v64
v_fmac_f32 v8, v4, v24
v_fmac_f32 v9, v5, v24
v_lshlrev_b32 v4, 16, v65
v_and_b32 v5, 0xffff0000, v65
v_fmac_f32 v10, v4, v24
v_fmac_f32 v11, v5, v24
v_lshlrev_b32 v4, 16, v66
v_and_b32 v5, 0xffff0000, v66
v_fmac_f32 v12, v4, v24
v_fmac_f32 v13, v5, v24
v_lshlrev_b32 v4, 16, v67
v_and_b32 v5, 0xffff0000, v67
v_fmac_f32 v14, v4, v24
v_fmac_f32 v15, v5, v24
s_waitcnt vmcnt(6)
v_lshlrev_b32 v4, 16, v68
v_and_b32 v5, 0xffff0000, v68
v_fmac_f32 v8, v4, v25
v_fmac_f32 v9, v5, v25
v_lshlrev_b32 v4, 16, v69
v_and_b32 v5, 0xffff0000, v69
v_fmac_f32 v10, v4, v25
v_fmac_f32 v11, v5, v25
v_lshlrev_b32 v4, 16, v70
v_and_b32 v5, 0xffff0000, v70
v_fmac_f32 v12, v4, v25
v_fmac_f32 v13, v5, v25
v_lshlrev_b32 v4, 16, v71
v_and_b32 v5, 0xffff0000, v71
v_fmac_f32 v14, v4, v25
v_fmac_f32 v15, v5, v25
s_waitcnt vmcnt(5)
v_lshlrev_b32 v4, 16, v72
v_and_b32 v5, 0xffff0000, v72
v_fmac_f32 v8, v4, v26
v_fmac_f32 v9, v5, v26
v_lshlrev_b32 v4, 16, v73
v_and_b32 v5, 0xffff0000, v73
v_fmac_f32 v10, v4, v26
v_fmac_f32 v11, v5, v26
v_lshlrev_b32 v4, 16, v74
v_and_b32 v5, 0xffff0000, v74
v_fmac_f32 v12, v4, v26
v_fmac_f32 v13, v5, v26
v_lshlrev_b32 v4, 16, v75
v_and_b32 v5, 0xffff0000, v75
v_fmac_f32 v14, v4, v26
v_fmac_f32 v15, v5, v26
s_waitcnt vmcnt(4)
v_lshlrev_b32 v4, 16, v76
v_and_b32 v5, 0xffff0000, v76
v_fmac_f32 v8, v4, v27
v_fmac_f32 v9, v5, v27
v_lshlrev_b32 v4, 16, v77
v_and_b32 v5, 0xffff0000, v77
v_fmac_f32 v10, v4, v27
v_fmac_f32 v11, v5, v27
v_lshlrev_b32 v4, 16, v78
v_and_b32 v5, 0xffff0000, v78
v_fmac_f32 v12, v4, v27
v_fmac_f32 v13, v5, v27
v_lshlrev_b32 v4, 16, v79
v_and_b32 v5, 0xffff0000, v79
v_fmac_f32 v14, v4, v27
v_fmac_f32 v15, v5, v27
s_waitcnt vmcnt(3)
v_lshlrev_b32 v4, 16, v80
v_and_b32 v5, 0xffff0000, v80
v_fmac_f32 v8, v4, v28
v_fmac_f32 v9, v5, v28
v_lshlrev_b32 v4, 16, v81
v_and_b32 v5, 0xffff0000, v81
v_fmac_f32 v10, v4, v28
v_fmac_f32 v11, v5, v28
v_lshlrev_b32 v4, 16, v82
v_and_b32 v5, 0xffff0000, v82
v_fmac_f32 v12, v4, v28
v_fmac_f32 v13, v5, v28
v_lshlrev_b32 v4, 16, v83
v_and_b32 v5, 0xffff0000, v83
v_fmac_f32 v14, v4, v28
v_fmac_f32 v15, v5, v28
s_waitcnt vmcnt(2)
v_lshlrev_b32 v4, 16, v84
v_and_b32 v5, 0xffff0000, v84
v_fmac_f32 v8, v4, v29
v_fmac_f32 v9, v5, v29
v_lshlrev_b32 v4, 16, v85
v_and_b32 v5, 0xffff0000, v85
v_fmac_f32 v10, v4, v29
v_fmac_f32 v11, v5, v29
v_lshlrev_b32 v4, 16, v86
v_and_b32 v5, 0xffff0000, v86
v_fmac_f32 v12, v4, v29
v_fmac_f32 v13, v5, v29
v_lshlrev_b32 v4, 16, v87
v_and_b32 v5, 0xffff0000, v87
v_fmac_f32 v14, v4, v29
v_fmac_f32 v15, v5, v29
s_waitcnt vmcnt(1)
v_lshlrev_b32 v4, 16, v88
v_and_b32 v5, 0xffff0000, v88
v_fmac_f32 v8, v4, v30
v_fmac_f32 v9, v5, v30
v_lshlrev_b32 v4, 16, v89
v_and_b32 v5, 0xffff0000, v89
v_fmac_f32 v10, v4, v30
v_fmac_f32 v11, v5, v30
v_lshlrev_b32 v4, 16, v90
v_and_b32 v5, 0xffff0000, v90
v_fmac_f32 v12, v4, v30
v_fmac_f32 v13, v5, v30
v_lshlrev_b32 v4, 16, v91
v_and_b32 v5, 0xffff0000, v91
v_fmac_f32 v14, v4, v30
v_fmac_f32 v15, v5, v30
s_waitcnt vmcnt(0)
v_lshlrev_b32 v4, 16, v92
v_and_b32 v5, 0xffff0000, v92
v_fmac_f32 v8, v4, v31
v_fmac_f32 v9, v5, v31
v_lshlrev_b32 v4, 16, v93
v_and_b32 v5, 0xffff0000, v93
v_fmac_f32 v10, v4, v31
v_fmac_f32 v11, v5, v31
v_lshlrev_b32 v4, 16, v94
v_and_b32 v5, 0xffff0000, v94
v_fmac_f32 v12, v4, v31
v_fmac_f32 v13, v5, v31
v_lshlrev_b32 v4, 16, v95
v_and_b32 v5, 0xffff0000, v95
v_fmac_f32 v14, v4, v31
v_fmac_f32 v15, v5, v31
v_lshlrev_b32 v6, 5, v0
ds_write_b128 v6, v[8:11] offset:4096
ds_write_b128 v6, v[12:15] offset:4112
s_waitcnt lgkmcnt(0)
s_barrier
s_cmp_lg_u32 s33, 0
s_cbranch_scc1 L_mt2
ds_read_b32 v16, v1 offset:4096
ds_read_b32 v17, v1 offset:4352
ds_read_b32 v18, v1 offset:4608
ds_read_b32 v19, v1 offset:4864
ds_read_b32 v20, v1 offset:5120
ds_read_b32 v21, v1 offset:5376
ds_read_b32 v22, v1 offset:5632
ds_read_b32 v23, v1 offset:5888
s_waitcnt lgkmcnt(0)
ds_read_b32 v24, v1 offset:6144
ds_read_b32 v25, v1 offset:6400
ds_read_b32 v26, v1 offset:6656
ds_read_b32 v27, v1 offset:6912
ds_read_b32 v28, v1 offset:7168
ds_read_b32 v29, v1 offset:7424
ds_read_b32 v30, v1 offset:7680
ds_read_b32 v31, v1 offset:7936
s_waitcnt lgkmcnt(0)
ds_read_b32 v32, v1 offset:8192
ds_read_b32 v33, v1 offset:8448
ds_read_b32 v34, v1 offset:8704
ds_read_b32 v35, v1 offset:8960
ds_read_b32 v36, v1 offset:9216
ds_read_b32 v37, v1 offset:9472
ds_read_b32 v38, v1 offset:9728
ds_read_b32 v39, v1 offset:9984
s_waitcnt lgkmcnt(0)
ds_read_b32 v40, v1 offset:10240
ds_read_b32 v41, v1 offset:10496
ds_read_b32 v42, v1 offset:10752
ds_read_b32 v43, v1 offset:11008
ds_read_b32 v44, v1 offset:11264
ds_read_b32 v45, v1 offset:11520
ds_read_b32 v46, v1 offset:11776
ds_read_b32 v47, v1 offset:12032
s_waitcnt lgkmcnt(0)
v_add_f32 v16, v16, v17
v_add_f32 v16, v16, v18
v_add_f32 v16, v16, v19
v_add_f32 v16, v16, v20
v_add_f32 v16, v16, v21
v_add_f32 v16, v16, v22
v_add_f32 v16, v16, v23
v_add_f32 v16, v16, v24
v_add_f32 v16, v16, v25
v_add_f32 v16, v16, v26
v_add_f32 v16, v16, v27
v_add_f32 v16, v16, v28
v_add_f32 v16, v16, v29
v_add_f32 v16, v16, v30
v_add_f32 v16, v16, v31
v_add_f32 v16, v16, v32
v_add_f32 v16, v16, v33
v_add_f32 v16, v16, v34
v_add_f32 v16, v16, v35
v_add_f32 v16, v16, v36
v_add_f32 v16, v16, v37
v_add_f32 v16, v16, v38
v_add_f32 v16, v16, v39
v_add_f32 v16, v16, v40
v_add_f32 v16, v16, v41
v_add_f32 v16, v16, v42
v_add_f32 v16, v16, v43
v_add_f32 v16, v16, v44
v_add_f32 v16, v16, v45
v_add_f32 v16, v16, v46
v_add_f32 v16, v16, v47
v_cvt_pk_bf16_f32 v16, v16, v16
s_lshr_b32 s41, s101, 3
s_cmp_eq_u32 s41, 1
s_cselect_b32 s42, 1.0, 0
s_cmp_eq_u32 s41, 4
s_cselect_b32 s42, 1.0, s42
v_lshlrev_b32 v16, 16, v16
v_add_f32 v16, s42, v16
v_cvt_pk_bf16_f32 v16, v16, v16
L_mt2:
s_barrier
s_mov_b32 s70, 4
L_decide0:
s_cmp_lg_u32 s33, 0
s_cbranch_scc1 L_dp3
v_lshlrev_b32 v124, 3, v0
s_mov_b64 exec, 0xff
buffer_load_dwordx2 v[120:121], v124, s[28:31], 0 offen offset:128 sc1
s_mov_b64 exec, -1
L_dp3:
s_branch L_decide
L_spec_ch:
s_mov_b32 s70, 1
s_load_dwordx2 s[8:9], s[0:1], 16
s_mov_b32 s10, 4194304
s_mov_b32 s11, 0x20000
s_load_dwordx2 s[12:13], s[0:1], 24
s_mov_b32 s14, 4194304
s_mov_b32 s15, 0x20000
s_load_dwordx2 s[16:17], s[0:1], 32
s_mov_b32 s18, 4194304
s_mov_b32 s19, 0x20000
s_load_dwordx2 s[20:21], s[0:1], 40
s_mov_b32 s22, 4194304
s_mov_b32 s23, 0x20000
s_load_dwordx2 s[24:25], s[0:1], 8
s_mov_b32 s26, 8192
s_mov_b32 s27, 0x20000
s_mov_b32 s36, 0x00ff00ff
s_mov_b32 s37, 0x00ff00ff
s_mov_b32 s38, 0x3e0293ee
s_mov_b32 s39, 0x3e0293ee
s_lshl_b32 s56, s32, 8
s_add_u32 s61, s56, 51380224
s_lshl_b32 s62, s32, 9
s_add_u32 s62, s62, 51388416
s_mov_b32 s60, 0
s_lshr_b32 s40, s32, 2
s_lshl_b32 s40, s40, 10
s_and_b32 s41, s32, 3
s_lshl_b32 s41, s41, 6
s_add_u32 s57, s40, s41
s_add_u32 s57, s57, 47185920
v_and_b32 v66, 63, v0
v_and_b32 v67, 15, v0
v_lshrrev_b32 v68, 4, v66
v_lshlrev_b32 v1, 4, v66
v_add_u32 v2, 114688, v1
v_and_b32 v69, 1, v0
v_cmp_ne_u32 vcc, 0, v69
v_mov_b32 v3, 0x4444
v_mov_b32 v75, 0xeeee
v_cndmask_b32 v3, v3, v75, vcc
v_lshrrev_b32 v70, 1, v68
v_and_b32 v71, 1, v68
v_and_b32 v72, 7, v0
v_lshrrev_b32 v73, 2, v67
v_and_b32 v74, 3, v0
s_lshl_b32 s40, s33, 9
v_lshlrev_b32 v69, 4, v67
v_lshl_add_u32 v69, v68, 2, v69
v_add_u32 v69, s40, v69
v_add_u32 v4, 159744, v69
v_lshlrev_b32 v69, 1, v69
v_add_u32 v5, 155648, v69
v_lshl_add_u32 v69, v68, 3, v73
v_and_b32 v75, 1, v74
v_lshlrev_b32 v75, 3, v75
v_lshl_add_u32 v75, v69, 4, v75
v_add_u32 v6, 159744, v75
v_lshlrev_b32 v75, 3, v74
v_lshl_add_u32 v75, v69, 5, v75
v_add_u32 v7, 155648, v75
v_mul_u32_u24 v75, 272, v72
s_lshl_b32 s40, s33, 6
s_add_u32 s40, s40, 147456
v_lshl_add_u32 v69, v68, 3, v75
v_add_u32 v8, s40, v69
v_lshrrev_b32 v69, 1, v67
v_mul_u32_u24 v75, 272, v69
v_lshl_add_u32 v75, v68, 5, v75
v_and_b32 v69, 1, v0
v_lshl_add_u32 v75, v69, 4, v75
v_add_u32 v9, 147456, v75
v_lshrrev_b32 v75, 1, v67
v_lshlrev_b32 v75, 10, v75
v_lshl_add_u32 v75, v68, 5, v75
v_lshl_add_u32 v65, v69, 4, v75
s_mul_i32 s40, s33, 14336
v_add_u32 v10, s40, v1
v_add_u32 v11, 57344, v10
v_lshlrev_b32 v69, 13, v68
v_lshl_add_u32 v60, v67, 4, v69
v_mul_u32_u24 v69, 8192, v68
v_lshl_add_u32 v12, v67, 4, v69
v_lshrrev_b32 v69, 1, v72
v_lshlrev_b32 v69, 8, v69
v_and_b32 v75, 1, v0
v_lshl_add_u32 v69, v75, 5, v69
v_lshl_add_u32 v69, v70, 4, v69
v_lshl_add_u32 v13, v71, 3, v69
v_lshrrev_b32 v69, 1, v73
v_lshlrev_b32 v69, 3, v69
v_lshl_add_u32 v69, v70, 4, v69
v_lshl_add_u32 v69, v71, 2, v69
v_and_b32 v75, 1, v73
v_add_u32 v69, v69, v75
s_lshl_b32 s40, s33, 6
v_lshlrev_b32 v75, 8, v69
v_lshl_add_u32 v75, v74, 3, v75
v_add_u32 v61, s40, v75
v_add_u32 v62, 0x10000, v61
s_lshl_b32 s40, s33, 8
v_lshlrev_b32 v75, 10, v69
v_lshl_add_u32 v75, v74, 3, v75
v_add_u32 v63, s40, v75
v_and_b32 v75, 1, v69
v_bfe_u32 v69, v69, 2, 2
v_lshl_add_u32 v75, v69, 1, v75
v_lshl_add_u32 v63, v75, 5, v63
v_add_u32 v64, 0x10000, v63
s_lshl_b32 s40, s33, 6
v_xor_b32 v110, s40, v1
v_xor_b32 v111, 32, v110
v_mov_b32 v16, 0x3f803f80
v_mov_b32 v17, 0x3f803f80
v_mov_b32 v18, 0x3f803f80
v_mov_b32 v19, 0x3f803f80
v_mov_b32 v24, 0
v_mov_b32 v25, 0
v_mov_b32 v26, 0
v_mov_b32 v27, 0
v_mov_b32 v69, 0x3f80
v_mov_b32 v75, 0x3f800000
v_mov_b32 v20, 0
v_cmp_eq_u32 vcc, 0, v72
s_nop 1
v_cndmask_b32 v20, v20, v69, vcc
v_cmp_eq_u32 vcc, 1, v72
s_nop 1
v_cndmask_b32 v20, v20, v75, vcc
v_mov_b32 v21, 0
v_cmp_eq_u32 vcc, 2, v72
s_nop 1
v_cndmask_b32 v21, v21, v69, vcc
v_cmp_eq_u32 vcc, 3, v72
s_nop 1
v_cndmask_b32 v21, v21, v75, vcc
v_mov_b32 v22, 0
v_cmp_eq_u32 vcc, 4, v72
s_nop 1
v_cndmask_b32 v22, v22, v69, vcc
v_cmp_eq_u32 vcc, 5, v72
s_nop 1
v_cndmask_b32 v22, v22, v75, vcc
v_mov_b32 v23, 0
v_cmp_eq_u32 vcc, 6, v72
s_nop 1
v_cndmask_b32 v23, v23, v69, vcc
v_cmp_eq_u32 vcc, 7, v72
s_nop 1
v_cndmask_b32 v23, v23, v75, vcc
s_waitcnt lgkmcnt(0)
s_lshl_b32 s40, s33, 12
s_add_u32 s40, s40, 0
s_mov_b32 m0, s40
s_lshl_b32 s41, s33, 17
s_add_u32 s41, s41, s56
s_add_u32 s41, s41, 0
buffer_load_dwordx4 v60, s[8:11], s41 offen offset:0 lds
s_add_u32 s41, s41, 31744
buffer_load_dwordx4 v60, s[8:11], s41 offen offset:1024 lds
s_add_u32 s41, s41, 31744
buffer_load_dwordx4 v60, s[8:11], s41 offen offset:2048 lds
s_add_u32 s41, s41, 31744
buffer_load_dwordx4 v60, s[8:11], s41 offen offset:3072 lds
s_lshl_b32 s40, s33, 12
s_add_u32 s40, s40, 16384
s_mov_b32 m0, s40
s_lshl_b32 s41, s33, 17
s_add_u32 s41, s41, s56
s_add_u32 s41, s41, 524288
buffer_load_dwordx4 v60, s[8:11], s41 offen offset:0 lds
s_add_u32 s41, s41, 31744
buffer_load_dwordx4 v60, s[8:11], s41 offen offset:1024 lds
s_add_u32 s41, s41, 31744
buffer_load_dwordx4 v60, s[8:11], s41 offen offset:2048 lds
s_add_u32 s41, s41, 31744
buffer_load_dwordx4 v60, s[8:11], s41 offen offset:3072 lds
s_lshl_b32 s40, s33, 12
s_add_u32 s40, s40, 32768
s_mov_b32 m0, s40
s_lshl_b32 s41, s33, 17
s_add_u32 s41, s41, s56
s_add_u32 s41, s41, 1048576
buffer_load_dwordx4 v60, s[8:11], s41 offen offset:0 lds
s_add_u32 s41, s41, 31744
buffer_load_dwordx4 v60, s[8:11], s41 offen offset:1024 lds
s_add_u32 s41, s41, 31744
buffer_load_dwordx4 v60, s[8:11], s41 offen offset:2048 lds
s_add_u32 s41, s41, 31744
buffer_load_dwordx4 v60, s[8:11], s41 offen offset:3072 lds
s_lshl_b32 s40, s33, 12
s_add_u32 s40, s40, 49152
s_mov_b32 m0, s40
s_lshl_b32 s41, s33, 17
s_add_u32 s41, s41, s56
s_add_u32 s41, s41, 1572864
buffer_load_dwordx4 v60, s[8:11], s41 offen offset:0 lds
s_add_u32 s41, s41, 31744
buffer_load_dwordx4 v60, s[8:11], s41 offen offset:1024 lds
s_add_u32 s41, s41, 31744
buffer_load_dwordx4 v60, s[8:11], s41 offen offset:2048 lds
s_add_u32 s41, s41, 31744
buffer_load_dwordx4 v60, s[8:11], s41 offen offset:3072 lds
s_lshl_b32 s40, s33, 12
s_add_u32 s40, s40, 65536
s_mov_b32 m0, s40
s_lshl_b32 s41, s33, 17
s_add_u32 s41, s41, s56
s_add_u32 s41, s41, 2097152
buffer_load_dwordx4 v60, s[8:11], s41 offen offset:0 lds
s_add_u32 s41, s41, 31744
buffer_load_dwordx4 v60, s[8:11], s41 offen offset:1024 lds
s_add_u32 s41, s41, 31744
buffer_load_dwordx4 v60, s[8:11], s41 offen offset:2048 lds
s_add_u32 s41, s41, 31744
buffer_load_dwordx4 v60, s[8:11], s41 offen offset:3072 lds
s_lshl_b32 s40, s33, 12
s_add_u32 s40, s40, 81920
s_mov_b32 m0, s40
s_lshl_b32 s41, s33, 17
s_add_u32 s41, s41, s56
s_add_u32 s41, s41, 2621440
buffer_load_dwordx4 v60, s[8:11], s41 offen offset:0 lds
s_add_u32 s41, s41, 31744
buffer_load_dwordx4 v60, s[8:11], s41 offen offset:1024 lds
s_add_u32 s41, s41, 31744
buffer_load_dwordx4 v60, s[8:11], s41 offen offset:2048 lds
s_add_u32 s41, s41, 31744
buffer_load_dwordx4 v60, s[8:11], s41 offen offset:3072 lds
s_lshl_b32 s40, s33, 12
s_add_u32 s40, s40, 98304
s_mov_b32 m0, s40
s_lshl_b32 s41, s33, 17
s_add_u32 s41, s41, s56
s_add_u32 s41, s41, 3145728
buffer_load_dwordx4 v60, s[8:11], s41 offen offset:0 lds
s_add_u32 s41, s41, 31744
buffer_load_dwordx4 v60, s[8:11], s41 offen offset:1024 lds
s_add_u32 s41, s41, 31744
buffer_load_dwordx4 v60, s[8:11], s41 offen offset:2048 lds
s_add_u32 s41, s41, 31744
buffer_load_dwordx4 v60, s[8:11], s41 offen offset:3072 lds
s_waitcnt vmcnt(24)
s_barrier
s_lshl_b32 s40, s33, 12
s_add_u32 s40, s40, 114688
s_mov_b32 m0, s40
s_lshl_b32 s41, s33, 17
s_add_u32 s41, s41, s56
s_add_u32 s41, s41, 3670016
buffer_load_dwordx4 v60, s[8:11], s41 offen offset:0 lds
s_add_u32 s41, s41, 31744
buffer_load_dwordx4 v60, s[8:11], s41 offen offset:1024 lds
s_add_u32 s41, s41, 31744
buffer_load_dwordx4 v60, s[8:11], s41 offen offset:2048 lds
s_add_u32 s41, s41, 31744
buffer_load_dwordx4 v60, s[8:11], s41 offen offset:3072 lds
ds_read_b64_tr_b16 a[0:1], v61 offset:0
ds_read_b64_tr_b16 a[2:3], v61 offset:512
ds_read_b64_tr_b16 a[4:5], v61 offset:8192
ds_read_b64_tr_b16 a[6:7], v61 offset:8704
ds_read_b64_tr_b16 a[64:65], v61 offset:32
ds_read_b64_tr_b16 a[66:67], v61 offset:544
ds_read_b64_tr_b16 a[68:69], v61 offset:8224
ds_read_b64_tr_b16 a[70:71], v61 offset:8736
s_waitcnt lgkmcnt(0)
s_waitcnt vmcnt(24)
s_barrier
s_lshl_b32 s40, s33, 12
s_add_u32 s40, s40, 0
s_mov_b32 m0, s40
s_lshl_b32 s41, s33, 17
s_add_u32 s41, s41, s56
s_add_u32 s41, s41, 0
buffer_load_dwordx4 v60, s[12:15], s41 offen offset:0 lds
s_add_u32 s41, s41, 31744
buffer_load_dwordx4 v60, s[12:15], s41 offen offset:1024 lds
s_add_u32 s41, s41, 31744
buffer_load_dwordx4 v60, s[12:15], s41 offen offset:2048 lds
s_add_u32 s41, s41, 31744
buffer_load_dwordx4 v60, s[12:15], s41 offen offset:3072 lds
ds_read_b64_tr_b16 a[8:9], v61 offset:16384
ds_read_b64_tr_b16 a[10:11], v61 offset:16896
ds_read_b64_tr_b16 a[12:13], v61 offset:24576
ds_read_b64_tr_b16 a[14:15], v61 offset:25088
ds_read_b64_tr_b16 a[72:73], v61 offset:16416
ds_read_b64_tr_b16 a[74:75], v61 offset:16928
ds_read_b64_tr_b16 a[76:77], v61 offset:24608
ds_read_b64_tr_b16 a[78:79], v61 offset:25120
s_waitcnt lgkmcnt(0)
s_waitcnt vmcnt(24)
s_barrier
s_lshl_b32 s40, s33, 12
s_add_u32 s40, s40, 16384
s_mov_b32 m0, s40
s_lshl_b32 s41, s33, 17
s_add_u32 s41, s41, s56
s_add_u32 s41, s41, 524288
buffer_load_dwordx4 v60, s[12:15], s41 offen offset:0 lds
s_add_u32 s41, s41, 31744
buffer_load_dwordx4 v60, s[12:15], s41 offen offset:1024 lds
s_add_u32 s41, s41, 31744
buffer_load_dwordx4 v60, s[12:15], s41 offen offset:2048 lds
s_add_u32 s41, s41, 31744
buffer_load_dwordx4 v60, s[12:15], s41 offen offset:3072 lds
ds_read_b64_tr_b16 a[16:17], v61 offset:32768
ds_read_b64_tr_b16 a[18:19], v61 offset:33280
ds_read_b64_tr_b16 a[20:21], v61 offset:40960
ds_read_b64_tr_b16 a[22:23], v61 offset:41472
ds_read_b64_tr_b16 a[80:81], v61 offset:32800
ds_read_b64_tr_b16 a[82:83], v61 offset:33312
ds_read_b64_tr_b16 a[84:85], v61 offset:40992
ds_read_b64_tr_b16 a[86:87], v61 offset:41504
s_waitcnt lgkmcnt(0)
s_waitcnt vmcnt(24)
s_barrier
s_lshl_b32 s40, s33, 12
s_add_u32 s40, s40, 32768
s_mov_b32 m0, s40
s_lshl_b32 s41, s33, 17
s_add_u32 s41, s41, s56
s_add_u32 s41, s41, 1048576
buffer_load_dwordx4 v60, s[12:15], s41 offen offset:0 lds
s_add_u32 s41, s41, 31744
buffer_load_dwordx4 v60, s[12:15], s41 offen offset:1024 lds
s_add_u32 s41, s41, 31744
buffer_load_dwordx4 v60, s[12:15], s41 offen offset:2048 lds
s_add_u32 s41, s41, 31744
buffer_load_dwordx4 v60, s[12:15], s41 offen offset:3072 lds
ds_read_b64_tr_b16 a[24:25], v61 offset:49152
ds_read_b64_tr_b16 a[26:27], v61 offset:49664
ds_read_b64_tr_b16 a[28:29], v61 offset:57344
ds_read_b64_tr_b16 a[30:31], v61 offset:57856
ds_read_b64_tr_b16 a[88:89], v61 offset:49184
ds_read_b64_tr_b16 a[90:91], v61 offset:49696
ds_read_b64_tr_b16 a[92:93], v61 offset:57376
ds_read_b64_tr_b16 a[94:95], v61 offset:57888
s_waitcnt lgkmcnt(0)
s_waitcnt vmcnt(24)
s_barrier
s_lshl_b32 s40, s33, 12
s_add_u32 s40, s40, 49152
s_mov_b32 m0, s40
s_lshl_b32 s41, s33, 17
s_add_u32 s41, s41, s56
s_add_u32 s41, s41, 1572864
buffer_load_dwordx4 v60, s[12:15], s41 offen offset:0 lds
s_add_u32 s41, s41, 31744
buffer_load_dwordx4 v60, s[12:15], s41 offen offset:1024 lds
s_add_u32 s41, s41, 31744
buffer_load_dwordx4 v60, s[12:15], s41 offen offset:2048 lds
s_add_u32 s41, s41, 31744
buffer_load_dwordx4 v60, s[12:15], s41 offen offset:3072 lds
ds_read_b64_tr_b16 a[32:33], v62 offset:0
ds_read_b64_tr_b16 a[34:35], v62 offset:512
ds_read_b64_tr_b16 a[36:37], v62 offset:8192
ds_read_b64_tr_b16 a[38:39], v62 offset:8704
ds_read_b64_tr_b16 a[96:97], v62 offset:32
ds_read_b64_tr_b16 a[98:99], v62 offset:544
ds_read_b64_tr_b16 a[100:101], v62 offset:8224
ds_read_b64_tr_b16 a[102:103], v62 offset:8736
s_waitcnt lgkmcnt(0)
s_waitcnt vmcnt(24)
s_barrier
s_lshl_b32 s40, s33, 12
s_add_u32 s40, s40, 65536
s_mov_b32 m0, s40
s_lshl_b32 s41, s33, 17
s_add_u32 s41, s41, s56
s_add_u32 s41, s41, 2097152
buffer_load_dwordx4 v60, s[12:15], s41 offen offset:0 lds
s_add_u32 s41, s41, 31744
buffer_load_dwordx4 v60, s[12:15], s41 offen offset:1024 lds
s_add_u32 s41, s41, 31744
buffer_load_dwordx4 v60, s[12:15], s41 offen offset:2048 lds
s_add_u32 s41, s41, 31744
buffer_load_dwordx4 v60, s[12:15], s41 offen offset:3072 lds
ds_read_b64_tr_b16 a[40:41], v62 offset:16384
ds_read_b64_tr_b16 a[42:43], v62 offset:16896
ds_read_b64_tr_b16 a[44:45], v62 offset:24576
ds_read_b64_tr_b16 a[46:47], v62 offset:25088
ds_read_b64_tr_b16 a[104:105], v62 offset:16416
ds_read_b64_tr_b16 a[106:107], v62 offset:16928
ds_read_b64_tr_b16 a[108:109], v62 offset:24608
ds_read_b64_tr_b16 a[110:111], v62 offset:25120
s_waitcnt lgkmcnt(0)
s_waitcnt vmcnt(24)
s_barrier
s_lshl_b32 s40, s33, 12
s_add_u32 s40, s40, 81920
s_mov_b32 m0, s40
s_lshl_b32 s41, s33, 17
s_add_u32 s41, s41, s56
s_add_u32 s41, s41, 2621440
buffer_load_dwordx4 v60, s[12:15], s41 offen offset:0 lds
s_add_u32 s41, s41, 31744
buffer_load_dwordx4 v60, s[12:15], s41 offen offset:1024 lds
s_add_u32 s41, s41, 31744
buffer_load_dwordx4 v60, s[12:15], s41 offen offset:2048 lds
s_add_u32 s41, s41, 31744
buffer_load_dwordx4 v60, s[12:15], s41 offen offset:3072 lds
ds_read_b64_tr_b16 a[48:49], v62 offset:32768
ds_read_b64_tr_b16 a[50:51], v62 offset:33280
ds_read_b64_tr_b16 a[52:53], v62 offset:40960
ds_read_b64_tr_b16 a[54:55], v62 offset:41472
ds_read_b64_tr_b16 a[112:113], v62 offset:32800
ds_read_b64_tr_b16 a[114:115], v62 offset:33312
ds_read_b64_tr_b16 a[116:117], v62 offset:40992
ds_read_b64_tr_b16 a[118:119], v62 offset:41504
s_waitcnt lgkmcnt(0)
s_waitcnt vmcnt(24)
s_barrier
s_lshl_b32 s40, s33, 12
s_add_u32 s40, s40, 98304
s_mov_b32 m0, s40
s_lshl_b32 s41, s33, 17
s_add_u32 s41, s41, s56
s_add_u32 s41, s41, 3145728
buffer_load_dwordx4 v60, s[12:15], s41 offen offset:0 lds
s_add_u32 s41, s41, 31744
buffer_load_dwordx4 v60, s[12:15], s41 offen offset:1024 lds
s_add_u32 s41, s41, 31744
buffer_load_dwordx4 v60, s[12:15], s41 offen offset:2048 lds
s_add_u32 s41, s41, 31744
buffer_load_dwordx4 v60, s[12:15], s41 offen offset:3072 lds
ds_read_b64_tr_b16 a[56:57], v62 offset:49152
ds_read_b64_tr_b16 a[58:59], v62 offset:49664
ds_read_b64_tr_b16 a[60:61], v62 offset:57344
ds_read_b64_tr_b16 a[62:63], v62 offset:57856
ds_read_b64_tr_b16 a[120:121], v62 offset:49184
ds_read_b64_tr_b16 a[122:123], v62 offset:49696
ds_read_b64_tr_b16 a[124:125], v62 offset:57376
ds_read_b64_tr_b16 a[126:127], v62 offset:57888
s_waitcnt lgkmcnt(0)
s_waitcnt vmcnt(24)
s_barrier
s_lshl_b32 s40, s33, 12
s_add_u32 s40, s40, 114688
s_mov_b32 m0, s40
s_lshl_b32 s41, s33, 17
s_add_u32 s41, s41, s56
s_add_u32 s41, s41, 3670016
buffer_load_dwordx4 v60, s[12:15], s41 offen offset:0 lds
s_add_u32 s41, s41, 31744
buffer_load_dwordx4 v60, s[12:15], s41 offen offset:1024 lds
s_add_u32 s41, s41, 31744
buffer_load_dwordx4 v60, s[12:15], s41 offen offset:2048 lds
s_add_u32 s41, s41, 31744
buffer_load_dwordx4 v60, s[12:15], s41 offen offset:3072 lds
ds_read_b64_tr_b16 a[128:129], v61 offset:0
ds_read_b64_tr_b16 a[130:131], v61 offset:512
ds_read_b64_tr_b16 a[132:133], v61 offset:8192
ds_read_b64_tr_b16 a[134:135], v61 offset:8704
ds_read_b64_tr_b16 a[192:193], v61 offset:32
ds_read_b64_tr_b16 a[194:195], v61 offset:544
ds_read_b64_tr_b16 a[196:197], v61 offset:8224
ds_read_b64_tr_b16 a[198:199], v61 offset:8736
s_waitcnt lgkmcnt(0)
s_waitcnt vmcnt(24)
s_barrier
s_lshl_b32 s40, s33, 12
s_add_u32 s40, s40, 0
s_mov_b32 m0, s40
s_lshl_b32 s41, s33, 17
s_add_u32 s41, s41, s56
s_add_u32 s41, s41, 0
buffer_load_dwordx4 v60, s[16:19], s41 offen offset:0 lds
s_add_u32 s41, s41, 31744
buffer_load_dwordx4 v60, s[16:19], s41 offen offset:1024 lds
s_add_u32 s41, s41, 31744
buffer_load_dwordx4 v60, s[16:19], s41 offen offset:2048 lds
s_add_u32 s41, s41, 31744
buffer_load_dwordx4 v60, s[16:19], s41 offen offset:3072 lds
ds_read_b64_tr_b16 a[136:137], v61 offset:16384
ds_read_b64_tr_b16 a[138:139], v61 offset:16896
ds_read_b64_tr_b16 a[140:141], v61 offset:24576
ds_read_b64_tr_b16 a[142:143], v61 offset:25088
ds_read_b64_tr_b16 a[200:201], v61 offset:16416
ds_read_b64_tr_b16 a[202:203], v61 offset:16928
ds_read_b64_tr_b16 a[204:205], v61 offset:24608
ds_read_b64_tr_b16 a[206:207], v61 offset:25120
s_waitcnt lgkmcnt(0)
s_waitcnt vmcnt(24)
s_barrier
s_lshl_b32 s40, s33, 12
s_add_u32 s40, s40, 16384
s_mov_b32 m0, s40
s_lshl_b32 s41, s33, 17
s_add_u32 s41, s41, s56
s_add_u32 s41, s41, 524288
buffer_load_dwordx4 v60, s[16:19], s41 offen offset:0 lds
s_add_u32 s41, s41, 31744
buffer_load_dwordx4 v60, s[16:19], s41 offen offset:1024 lds
s_add_u32 s41, s41, 31744
buffer_load_dwordx4 v60, s[16:19], s41 offen offset:2048 lds
s_add_u32 s41, s41, 31744
buffer_load_dwordx4 v60, s[16:19], s41 offen offset:3072 lds
ds_read_b64_tr_b16 a[144:145], v61 offset:32768
ds_read_b64_tr_b16 a[146:147], v61 offset:33280
ds_read_b64_tr_b16 a[148:149], v61 offset:40960
ds_read_b64_tr_b16 a[150:151], v61 offset:41472
ds_read_b64_tr_b16 a[208:209], v61 offset:32800
ds_read_b64_tr_b16 a[210:211], v61 offset:33312
ds_read_b64_tr_b16 a[212:213], v61 offset:40992
ds_read_b64_tr_b16 a[214:215], v61 offset:41504
s_waitcnt lgkmcnt(0)
s_waitcnt vmcnt(24)
s_barrier
s_lshl_b32 s40, s33, 12
s_add_u32 s40, s40, 32768
s_mov_b32 m0, s40
s_lshl_b32 s41, s33, 17
s_add_u32 s41, s41, s56
s_add_u32 s41, s41, 1048576
buffer_load_dwordx4 v60, s[16:19], s41 offen offset:0 lds
s_add_u32 s41, s41, 31744
buffer_load_dwordx4 v60, s[16:19], s41 offen offset:1024 lds
s_add_u32 s41, s41, 31744
buffer_load_dwordx4 v60, s[16:19], s41 offen offset:2048 lds
s_add_u32 s41, s41, 31744
buffer_load_dwordx4 v60, s[16:19], s41 offen offset:3072 lds
ds_read_b64_tr_b16 a[152:153], v61 offset:49152
ds_read_b64_tr_b16 a[154:155], v61 offset:49664
ds_read_b64_tr_b16 a[156:157], v61 offset:57344
ds_read_b64_tr_b16 a[158:159], v61 offset:57856
ds_read_b64_tr_b16 a[216:217], v61 offset:49184
ds_read_b64_tr_b16 a[218:219], v61 offset:49696
ds_read_b64_tr_b16 a[220:221], v61 offset:57376
ds_read_b64_tr_b16 a[222:223], v61 offset:57888
s_waitcnt lgkmcnt(0)
s_waitcnt vmcnt(24)
s_barrier
s_lshl_b32 s40, s33, 12
s_add_u32 s40, s40, 49152
s_mov_b32 m0, s40
s_lshl_b32 s41, s33, 17
s_add_u32 s41, s41, s56
s_add_u32 s41, s41, 1572864
buffer_load_dwordx4 v60, s[16:19], s41 offen offset:0 lds
s_add_u32 s41, s41, 31744
buffer_load_dwordx4 v60, s[16:19], s41 offen offset:1024 lds
s_add_u32 s41, s41, 31744
buffer_load_dwordx4 v60, s[16:19], s41 offen offset:2048 lds
s_add_u32 s41, s41, 31744
buffer_load_dwordx4 v60, s[16:19], s41 offen offset:3072 lds
ds_read_b64_tr_b16 a[160:161], v62 offset:0
ds_read_b64_tr_b16 a[162:163], v62 offset:512
ds_read_b64_tr_b16 a[164:165], v62 offset:8192
ds_read_b64_tr_b16 a[166:167], v62 offset:8704
ds_read_b64_tr_b16 a[224:225], v62 offset:32
ds_read_b64_tr_b16 a[226:227], v62 offset:544
ds_read_b64_tr_b16 a[228:229], v62 offset:8224
ds_read_b64_tr_b16 a[230:231], v62 offset:8736
s_waitcnt lgkmcnt(0)
s_waitcnt vmcnt(24)
s_barrier
s_lshl_b32 s40, s33, 12
s_add_u32 s40, s40, 65536
s_mov_b32 m0, s40
s_lshl_b32 s41, s33, 17
s_add_u32 s41, s41, s56
s_add_u32 s41, s41, 2097152
buffer_load_dwordx4 v60, s[16:19], s41 offen offset:0 lds
s_add_u32 s41, s41, 31744
buffer_load_dwordx4 v60, s[16:19], s41 offen offset:1024 lds
s_add_u32 s41, s41, 31744
buffer_load_dwordx4 v60, s[16:19], s41 offen offset:2048 lds
s_add_u32 s41, s41, 31744
buffer_load_dwordx4 v60, s[16:19], s41 offen offset:3072 lds
ds_read_b64_tr_b16 a[168:169], v62 offset:16384
ds_read_b64_tr_b16 a[170:171], v62 offset:16896
ds_read_b64_tr_b16 a[172:173], v62 offset:24576
ds_read_b64_tr_b16 a[174:175], v62 offset:25088
ds_read_b64_tr_b16 a[232:233], v62 offset:16416
ds_read_b64_tr_b16 a[234:235], v62 offset:16928
ds_read_b64_tr_b16 a[236:237], v62 offset:24608
ds_read_b64_tr_b16 a[238:239], v62 offset:25120
s_waitcnt lgkmcnt(0)
s_waitcnt vmcnt(24)
s_barrier
s_lshl_b32 s40, s33, 12
s_add_u32 s40, s40, 81920
s_mov_b32 m0, s40
s_lshl_b32 s41, s33, 17
s_add_u32 s41, s41, s56
s_add_u32 s41, s41, 2621440
buffer_load_dwordx4 v60, s[16:19], s41 offen offset:0 lds
s_add_u32 s41, s41, 31744
buffer_load_dwordx4 v60, s[16:19], s41 offen offset:1024 lds
s_add_u32 s41, s41, 31744
buffer_load_dwordx4 v60, s[16:19], s41 offen offset:2048 lds
s_add_u32 s41, s41, 31744
buffer_load_dwordx4 v60, s[16:19], s41 offen offset:3072 lds
ds_read_b64_tr_b16 a[176:177], v62 offset:32768
ds_read_b64_tr_b16 a[178:179], v62 offset:33280
ds_read_b64_tr_b16 a[180:181], v62 offset:40960
ds_read_b64_tr_b16 a[182:183], v62 offset:41472
ds_read_b64_tr_b16 a[240:241], v62 offset:32800
ds_read_b64_tr_b16 a[242:243], v62 offset:33312
ds_read_b64_tr_b16 a[244:245], v62 offset:40992
ds_read_b64_tr_b16 a[246:247], v62 offset:41504
s_waitcnt lgkmcnt(0)
s_waitcnt vmcnt(24)
s_barrier
s_lshl_b32 s40, s33, 12
s_add_u32 s40, s40, 98304
s_mov_b32 m0, s40
s_lshl_b32 s41, s33, 17
s_add_u32 s41, s41, s56
s_add_u32 s41, s41, 3145728
buffer_load_dwordx4 v60, s[16:19], s41 offen offset:0 lds
s_add_u32 s41, s41, 31744
buffer_load_dwordx4 v60, s[16:19], s41 offen offset:1024 lds
s_add_u32 s41, s41, 31744
buffer_load_dwordx4 v60, s[16:19], s41 offen offset:2048 lds
s_add_u32 s41, s41, 31744
buffer_load_dwordx4 v60, s[16:19], s41 offen offset:3072 lds
ds_read_b64_tr_b16 a[184:185], v62 offset:49152
ds_read_b64_tr_b16 a[186:187], v62 offset:49664
ds_read_b64_tr_b16 a[188:189], v62 offset:57344
ds_read_b64_tr_b16 a[190:191], v62 offset:57856
ds_read_b64_tr_b16 a[248:249], v62 offset:49184
ds_read_b64_tr_b16 a[250:251], v62 offset:49696
ds_read_b64_tr_b16 a[252:253], v62 offset:57376
ds_read_b64_tr_b16 a[254:255], v62 offset:57888
s_waitcnt lgkmcnt(0)
s_waitcnt vmcnt(24)
s_barrier
s_lshl_b32 s40, s33, 12
s_add_u32 s40, s40, 114688
s_mov_b32 m0, s40
s_lshl_b32 s41, s33, 17
s_add_u32 s41, s41, s56
s_add_u32 s41, s41, 3670016
buffer_load_dwordx4 v60, s[16:19], s41 offen offset:0 lds
s_add_u32 s41, s41, 31744
buffer_load_dwordx4 v60, s[16:19], s41 offen offset:1024 lds
s_add_u32 s41, s41, 31744
buffer_load_dwordx4 v60, s[16:19], s41 offen offset:2048 lds
s_add_u32 s41, s41, 31744
buffer_load_dwordx4 v60, s[16:19], s41 offen offset:3072 lds
ds_read_b64_tr_b16 v[128:129], v61 offset:0
ds_read_b64_tr_b16 v[130:131], v61 offset:512
ds_read_b64_tr_b16 v[132:133], v61 offset:8192
ds_read_b64_tr_b16 v[134:135], v61 offset:8704
ds_read_b64_tr_b16 v[192:193], v61 offset:32
ds_read_b64_tr_b16 v[194:195], v61 offset:544
ds_read_b64_tr_b16 v[196:197], v61 offset:8224
ds_read_b64_tr_b16 v[198:199], v61 offset:8736
s_waitcnt lgkmcnt(0)
s_waitcnt vmcnt(24)
s_barrier
s_lshl_b32 s40, s33, 12
s_add_u32 s40, s40, 0
s_mov_b32 m0, s40
s_lshl_b32 s41, s32, 17
s_lshl_b32 s42, s33, 12
s_add_u32 s41, s41, s42
s_add_u32 s41, s41, 0
buffer_load_dwordx4 v110, s[20:23], s41 offen offset:0 lds
buffer_load_dwordx4 v111, s[20:23], s41 offen offset:1024 lds
buffer_load_dwordx4 v110, s[20:23], s41 offen offset:2048 lds
buffer_load_dwordx4 v111, s[20:23], s41 offen offset:3072 lds
ds_read_b64_tr_b16 v[136:137], v61 offset:16384
ds_read_b64_tr_b16 v[138:139], v61 offset:16896
ds_read_b64_tr_b16 v[140:141], v61 offset:24576
ds_read_b64_tr_b16 v[142:143], v61 offset:25088
ds_read_b64_tr_b16 v[200:201], v61 offset:16416
ds_read_b64_tr_b16 v[202:203], v61 offset:16928
ds_read_b64_tr_b16 v[204:205], v61 offset:24608
ds_read_b64_tr_b16 v[206:207], v61 offset:25120
s_waitcnt lgkmcnt(0)
s_waitcnt vmcnt(24)
s_barrier
s_lshl_b32 s40, s33, 12
s_add_u32 s40, s40, 16384
s_mov_b32 m0, s40
s_lshl_b32 s41, s32, 17
s_lshl_b32 s42, s33, 12
s_add_u32 s41, s41, s42
s_add_u32 s41, s41, 16384
buffer_load_dwordx4 v110, s[20:23], s41 offen offset:0 lds
buffer_load_dwordx4 v111, s[20:23], s41 offen offset:1024 lds
buffer_load_dwordx4 v110, s[20:23], s41 offen offset:2048 lds
buffer_load_dwordx4 v111, s[20:23], s41 offen offset:3072 lds
ds_read_b64_tr_b16 v[144:145], v61 offset:32768
ds_read_b64_tr_b16 v[146:147], v61 offset:33280
ds_read_b64_tr_b16 v[148:149], v61 offset:40960
ds_read_b64_tr_b16 v[150:151], v61 offset:41472
ds_read_b64_tr_b16 v[208:209], v61 offset:32800
ds_read_b64_tr_b16 v[210:211], v61 offset:33312
ds_read_b64_tr_b16 v[212:213], v61 offset:40992
ds_read_b64_tr_b16 v[214:215], v61 offset:41504
s_waitcnt lgkmcnt(0)
s_waitcnt vmcnt(24)
s_barrier
s_lshl_b32 s40, s33, 12
s_add_u32 s40, s40, 32768
s_mov_b32 m0, s40
s_lshl_b32 s41, s32, 17
s_lshl_b32 s42, s33, 12
s_add_u32 s41, s41, s42
s_add_u32 s41, s41, 32768
buffer_load_dwordx4 v110, s[20:23], s41 offen offset:0 lds
buffer_load_dwordx4 v111, s[20:23], s41 offen offset:1024 lds
buffer_load_dwordx4 v110, s[20:23], s41 offen offset:2048 lds
buffer_load_dwordx4 v111, s[20:23], s41 offen offset:3072 lds
ds_read_b64_tr_b16 v[152:153], v61 offset:49152
ds_read_b64_tr_b16 v[154:155], v61 offset:49664
ds_read_b64_tr_b16 v[156:157], v61 offset:57344
ds_read_b64_tr_b16 v[158:159], v61 offset:57856
ds_read_b64_tr_b16 v[216:217], v61 offset:49184
ds_read_b64_tr_b16 v[218:219], v61 offset:49696
ds_read_b64_tr_b16 v[220:221], v61 offset:57376
ds_read_b64_tr_b16 v[222:223], v61 offset:57888
s_waitcnt lgkmcnt(0)
s_waitcnt vmcnt(24)
s_barrier
s_lshl_b32 s40, s33, 12
s_add_u32 s40, s40, 49152
s_mov_b32 m0, s40
s_lshl_b32 s41, s32, 17
s_lshl_b32 s42, s33, 12
s_add_u32 s41, s41, s42
s_add_u32 s41, s41, 49152
buffer_load_dwordx4 v110, s[20:23], s41 offen offset:0 lds
buffer_load_dwordx4 v111, s[20:23], s41 offen offset:1024 lds
buffer_load_dwordx4 v110, s[20:23], s41 offen offset:2048 lds
buffer_load_dwordx4 v111, s[20:23], s41 offen offset:3072 lds
ds_read_b64_tr_b16 v[160:161], v62 offset:0
ds_read_b64_tr_b16 v[162:163], v62 offset:512
ds_read_b64_tr_b16 v[164:165], v62 offset:8192
ds_read_b64_tr_b16 v[166:167], v62 offset:8704
ds_read_b64_tr_b16 v[224:225], v62 offset:32
ds_read_b64_tr_b16 v[226:227], v62 offset:544
ds_read_b64_tr_b16 v[228:229], v62 offset:8224
ds_read_b64_tr_b16 v[230:231], v62 offset:8736
s_waitcnt lgkmcnt(0)
s_waitcnt vmcnt(24)
s_barrier
s_cmp_lg_u32 s33, 0
s_cbranch_scc1 L_dp4
v_lshlrev_b32 v124, 3, v0
s_mov_b64 exec, 0xff
buffer_load_dwordx2 v[120:121], v124, s[28:31], 0 offen offset:128 sc1
s_mov_b64 exec, -1
L_dp4:
s_lshl_b32 s40, s33, 12
s_add_u32 s40, s40, 65536
s_mov_b32 m0, s40
s_lshl_b32 s41, s32, 17
s_lshl_b32 s42, s33, 12
s_add_u32 s41, s41, s42
s_add_u32 s41, s41, 65536
buffer_load_dwordx4 v110, s[20:23], s41 offen offset:0 lds
buffer_load_dwordx4 v111, s[20:23], s41 offen offset:1024 lds
buffer_load_dwordx4 v110, s[20:23], s41 offen offset:2048 lds
buffer_load_dwordx4 v111, s[20:23], s41 offen offset:3072 lds
ds_read_b64_tr_b16 v[168:169], v62 offset:16384
ds_read_b64_tr_b16 v[170:171], v62 offset:16896
ds_read_b64_tr_b16 v[172:173], v62 offset:24576
ds_read_b64_tr_b16 v[174:175], v62 offset:25088
ds_read_b64_tr_b16 v[232:233], v62 offset:16416
ds_read_b64_tr_b16 v[234:235], v62 offset:16928
ds_read_b64_tr_b16 v[236:237], v62 offset:24608
ds_read_b64_tr_b16 v[238:239], v62 offset:25120
s_waitcnt lgkmcnt(0)
s_waitcnt vmcnt(24)
s_barrier
s_lshl_b32 s40, s33, 12
s_add_u32 s40, s40, 81920
s_mov_b32 m0, s40
s_lshl_b32 s41, s32, 17
s_lshl_b32 s42, s33, 12
s_add_u32 s41, s41, s42
s_add_u32 s41, s41, 81920
buffer_load_dwordx4 v110, s[20:23], s41 offen offset:0 lds
buffer_load_dwordx4 v111, s[20:23], s41 offen offset:1024 lds
buffer_load_dwordx4 v110, s[20:23], s41 offen offset:2048 lds
buffer_load_dwordx4 v111, s[20:23], s41 offen offset:3072 lds
ds_read_b64_tr_b16 v[176:177], v62 offset:32768
ds_read_b64_tr_b16 v[178:179], v62 offset:33280
ds_read_b64_tr_b16 v[180:181], v62 offset:40960
ds_read_b64_tr_b16 v[182:183], v62 offset:41472
ds_read_b64_tr_b16 v[240:241], v62 offset:32800
ds_read_b64_tr_b16 v[242:243], v62 offset:33312
ds_read_b64_tr_b16 v[244:245], v62 offset:40992
ds_read_b64_tr_b16 v[246:247], v62 offset:41504
s_waitcnt lgkmcnt(0)
s_waitcnt vmcnt(24)
s_barrier
s_lshl_b32 s40, s33, 12
s_add_u32 s40, s40, 98304
s_mov_b32 m0, s40
s_lshl_b32 s41, s32, 17
s_lshl_b32 s42, s33, 12
s_add_u32 s41, s41, s42
s_add_u32 s41, s41, 98304
buffer_load_dwordx4 v110, s[20:23], s41 offen offset:0 lds
buffer_load_dwordx4 v111, s[20:23], s41 offen offset:1024 lds
buffer_load_dwordx4 v110, s[20:23], s41 offen offset:2048 lds
buffer_load_dwordx4 v111, s[20:23], s41 offen offset:3072 lds
ds_read_b64_tr_b16 v[184:185], v62 offset:49152
ds_read_b64_tr_b16 v[186:187], v62 offset:49664
ds_read_b64_tr_b16 v[188:189], v62 offset:57344
ds_read_b64_tr_b16 v[190:191], v62 offset:57856
ds_read_b64_tr_b16 v[248:249], v62 offset:49184
ds_read_b64_tr_b16 v[250:251], v62 offset:49696
ds_read_b64_tr_b16 v[252:253], v62 offset:57376
ds_read_b64_tr_b16 v[254:255], v62 offset:57888
s_waitcnt lgkmcnt(0)
s_barrier
s_lshl_b32 s40, s33, 11
s_add_u32 s40, s40, 147456
s_lshl_b32 s41, s33, 8
s_mov_b32 m0, s40
s_add_u32 s40, s40, 1024
buffer_load_dwordx4 v65, s[24:27], s41 offen lds
s_add_u32 s41, s41, 128
s_mov_b32 m0, s40
s_add_u32 s40, s40, 1024
buffer_load_dwordx4 v65, s[24:27], s41 offen lds
s_add_u32 s41, s41, 128
s_lshl_b32 s40, s33, 12
s_add_u32 s40, s40, 114688
s_mov_b32 m0, s40
s_lshl_b32 s41, s32, 17
s_lshl_b32 s42, s33, 12
s_add_u32 s41, s41, s42
s_add_u32 s41, s41, 114688
buffer_load_dwordx4 v110, s[20:23], s41 offen offset:0 lds
buffer_load_dwordx4 v111, s[20:23], s41 offen offset:1024 lds
buffer_load_dwordx4 v110, s[20:23], s41 offen offset:2048 lds
buffer_load_dwordx4 v111, s[20:23], s41 offen offset:3072 lds
s_branch L_decide
L_spec_kv:
s_mov_b32 s70, 2
s_load_dwordx2 s[8:9], s[0:1], 24
s_mov_b32 s10, 4194304
s_mov_b32 s11, 0x20000
s_load_dwordx2 s[12:13], s[0:1], 32
s_mov_b32 s14, 4194304
s_mov_b32 s15, 0x20000
v_and_b32 v100, 63, v0
v_and_b32 v101, 15, v0
v_lshrrev_b32 v102, 4, v100
v_lshrrev_b32 v103, 2, v101
v_and_b32 v104, 3, v0
v_lshlrev_b32 v1, 4, v100
v_lshlrev_b32 v2, 13, v102
v_lshl_add_u32 v2, v101, 4, v2
v_lshl_add_u32 v105, v102, 3, v103
v_lshlrev_b32 v105, 8, v105
v_lshl_add_u32 v105, v104, 4, v105
s_lshl_b32 s40, s33, 6
v_add_u32 v4, s40, v105
v_add_u32 v5, 0x10000, v4
v_lshl_add_u32 v105, v102, 3, v103
v_lshlrev_b32 v105, 8, v105
v_lshl_add_u32 v105, v104, 3, v105
s_lshl_b32 s40, s33, 6
v_add_u32 v6, s40, v105
v_add_u32 v7, 0x10000, v6
s_waitcnt lgkmcnt(0)
s_lshl_b32 s40, s33, 12
s_add_u32 s40, s40, 0
s_mov_b32 m0, s40
s_lshl_b32 s41, s33, 17
s_lshl_b32 s42, s32, 8
s_add_u32 s41, s41, s42
s_add_u32 s41, s41, 0
buffer_load_dwordx4 v2, s[8:11], s41 offen offset:0 lds
s_add_u32 s41, s41, 31744
buffer_load_dwordx4 v2, s[8:11], s41 offen offset:1024 lds
s_add_u32 s41, s41, 31744
buffer_load_dwordx4 v2, s[8:11], s41 offen offset:2048 lds
s_add_u32 s41, s41, 31744
buffer_load_dwordx4 v2, s[8:11], s41 offen offset:3072 lds
s_lshl_b32 s40, s33, 12
s_add_u32 s40, s40, 16384
s_mov_b32 m0, s40
s_lshl_b32 s41, s33, 17
s_lshl_b32 s42, s32, 8
s_add_u32 s41, s41, s42
s_add_u32 s41, s41, 524288
buffer_load_dwordx4 v2, s[8:11], s41 offen offset:0 lds
s_add_u32 s41, s41, 31744
buffer_load_dwordx4 v2, s[8:11], s41 offen offset:1024 lds
s_add_u32 s41, s41, 31744
buffer_load_dwordx4 v2, s[8:11], s41 offen offset:2048 lds
s_add_u32 s41, s41, 31744
buffer_load_dwordx4 v2, s[8:11], s41 offen offset:3072 lds
s_lshl_b32 s40, s33, 12
s_add_u32 s40, s40, 32768
s_mov_b32 m0, s40
s_lshl_b32 s41, s33, 17
s_lshl_b32 s42, s32, 8
s_add_u32 s41, s41, s42
s_add_u32 s41, s41, 1048576
buffer_load_dwordx4 v2, s[8:11], s41 offen offset:0 lds
s_add_u32 s41, s41, 31744
buffer_load_dwordx4 v2, s[8:11], s41 offen offset:1024 lds
s_add_u32 s41, s41, 31744
buffer_load_dwordx4 v2, s[8:11], s41 offen offset:2048 lds
s_add_u32 s41, s41, 31744
buffer_load_dwordx4 v2, s[8:11], s41 offen offset:3072 lds
s_lshl_b32 s40, s33, 12
s_add_u32 s40, s40, 49152
s_mov_b32 m0, s40
s_lshl_b32 s41, s33, 17
s_lshl_b32 s42, s32, 8
s_add_u32 s41, s41, s42
s_add_u32 s41, s41, 1572864
buffer_load_dwordx4 v2, s[8:11], s41 offen offset:0 lds
s_add_u32 s41, s41, 31744
buffer_load_dwordx4 v2, s[8:11], s41 offen offset:1024 lds
s_add_u32 s41, s41, 31744
buffer_load_dwordx4 v2, s[8:11], s41 offen offset:2048 lds
s_add_u32 s41, s41, 31744
buffer_load_dwordx4 v2, s[8:11], s41 offen offset:3072 lds
s_lshl_b32 s40, s33, 12
s_add_u32 s40, s40, 65536
s_mov_b32 m0, s40
s_lshl_b32 s41, s33, 17
s_lshl_b32 s42, s32, 8
s_add_u32 s41, s41, s42
s_add_u32 s41, s41, 2097152
buffer_load_dwordx4 v2, s[8:11], s41 offen offset:0 lds
s_add_u32 s41, s41, 31744
buffer_load_dwordx4 v2, s[8:11], s41 offen offset:1024 lds
s_add_u32 s41, s41, 31744
buffer_load_dwordx4 v2, s[8:11], s41 offen offset:2048 lds
s_add_u32 s41, s41, 31744
buffer_load_dwordx4 v2, s[8:11], s41 offen offset:3072 lds
s_lshl_b32 s40, s33, 12
s_add_u32 s40, s40, 81920
s_mov_b32 m0, s40
s_lshl_b32 s41, s33, 17
s_lshl_b32 s42, s32, 8
s_add_u32 s41, s41, s42
s_add_u32 s41, s41, 2621440
buffer_load_dwordx4 v2, s[8:11], s41 offen offset:0 lds
s_add_u32 s41, s41, 31744
buffer_load_dwordx4 v2, s[8:11], s41 offen offset:1024 lds
s_add_u32 s41, s41, 31744
buffer_load_dwordx4 v2, s[8:11], s41 offen offset:2048 lds
s_add_u32 s41, s41, 31744
buffer_load_dwordx4 v2, s[8:11], s41 offen offset:3072 lds
s_lshl_b32 s40, s33, 12
s_add_u32 s40, s40, 98304
s_mov_b32 m0, s40
s_lshl_b32 s41, s33, 17
s_lshl_b32 s42, s32, 8
s_add_u32 s41, s41, s42
s_add_u32 s41, s41, 3145728
buffer_load_dwordx4 v2, s[8:11], s41 offen offset:0 lds
s_add_u32 s41, s41, 31744
buffer_load_dwordx4 v2, s[8:11], s41 offen offset:1024 lds
s_add_u32 s41, s41, 31744
buffer_load_dwordx4 v2, s[8:11], s41 offen offset:2048 lds
s_add_u32 s41, s41, 31744
buffer_load_dwordx4 v2, s[8:11], s41 offen offset:3072 lds
s_waitcnt vmcnt(24)
s_barrier
s_lshl_b32 s40, s33, 12
s_add_u32 s40, s40, 114688
s_mov_b32 m0, s40
s_lshl_b32 s41, s33, 17
s_lshl_b32 s42, s32, 8
s_add_u32 s41, s41, s42
s_add_u32 s41, s41, 3670016
buffer_load_dwordx4 v2, s[8:11], s41 offen offset:0 lds
s_add_u32 s41, s41, 31744
buffer_load_dwordx4 v2, s[8:11], s41 offen offset:1024 lds
s_add_u32 s41, s41, 31744
buffer_load_dwordx4 v2, s[8:11], s41 offen offset:2048 lds
s_add_u32 s41, s41, 31744
buffer_load_dwordx4 v2, s[8:11], s41 offen offset:3072 lds
ds_read_b64_tr_b16 a[0:1], v4 offset:0
ds_read_b64_tr_b16 a[2:3], v4 offset:1024
ds_read_b64_tr_b16 a[64:65], v4 offset:8
ds_read_b64_tr_b16 a[66:67], v4 offset:1032
ds_read_b64_tr_b16 a[4:5], v4 offset:8192
ds_read_b64_tr_b16 a[6:7], v4 offset:9216
ds_read_b64_tr_b16 a[68:69], v4 offset:8200
ds_read_b64_tr_b16 a[70:71], v4 offset:9224
s_waitcnt lgkmcnt(0)
s_waitcnt vmcnt(24)
s_barrier
s_lshl_b32 s40, s33, 12
s_add_u32 s40, s40, 0
s_mov_b32 m0, s40
s_lshl_b32 s41, s33, 17
s_lshl_b32 s42, s32, 8
s_add_u32 s41, s41, s42
s_add_u32 s41, s41, 0
buffer_load_dwordx4 v2, s[12:15], s41 offen offset:0 lds
s_add_u32 s41, s41, 31744
buffer_load_dwordx4 v2, s[12:15], s41 offen offset:1024 lds
s_add_u32 s41, s41, 31744
buffer_load_dwordx4 v2, s[12:15], s41 offen offset:2048 lds
s_add_u32 s41, s41, 31744
buffer_load_dwordx4 v2, s[12:15], s41 offen offset:3072 lds
ds_read_b64_tr_b16 a[8:9], v4 offset:16384
ds_read_b64_tr_b16 a[10:11], v4 offset:17408
ds_read_b64_tr_b16 a[72:73], v4 offset:16392
ds_read_b64_tr_b16 a[74:75], v4 offset:17416
ds_read_b64_tr_b16 a[12:13], v4 offset:24576
ds_read_b64_tr_b16 a[14:15], v4 offset:25600
ds_read_b64_tr_b16 a[76:77], v4 offset:24584
ds_read_b64_tr_b16 a[78:79], v4 offset:25608
s_waitcnt lgkmcnt(0)
s_waitcnt vmcnt(24)
s_barrier
s_lshl_b32 s40, s33, 12
s_add_u32 s40, s40, 16384
s_mov_b32 m0, s40
s_lshl_b32 s41, s33, 17
s_lshl_b32 s42, s32, 8
s_add_u32 s41, s41, s42
s_add_u32 s41, s41, 524288
buffer_load_dwordx4 v2, s[12:15], s41 offen offset:0 lds
s_add_u32 s41, s41, 31744
buffer_load_dwordx4 v2, s[12:15], s41 offen offset:1024 lds
s_add_u32 s41, s41, 31744
buffer_load_dwordx4 v2, s[12:15], s41 offen offset:2048 lds
s_add_u32 s41, s41, 31744
buffer_load_dwordx4 v2, s[12:15], s41 offen offset:3072 lds
ds_read_b64_tr_b16 a[16:17], v4 offset:32768
ds_read_b64_tr_b16 a[18:19], v4 offset:33792
ds_read_b64_tr_b16 a[80:81], v4 offset:32776
ds_read_b64_tr_b16 a[82:83], v4 offset:33800
ds_read_b64_tr_b16 a[20:21], v4 offset:40960
ds_read_b64_tr_b16 a[22:23], v4 offset:41984
ds_read_b64_tr_b16 a[84:85], v4 offset:40968
ds_read_b64_tr_b16 a[86:87], v4 offset:41992
s_waitcnt lgkmcnt(0)
s_waitcnt vmcnt(24)
s_barrier
s_lshl_b32 s40, s33, 12
s_add_u32 s40, s40, 32768
s_mov_b32 m0, s40
s_lshl_b32 s41, s33, 17
s_lshl_b32 s42, s32, 8
s_add_u32 s41, s41, s42
s_add_u32 s41, s41, 1048576
buffer_load_dwordx4 v2, s[12:15], s41 offen offset:0 lds
s_add_u32 s41, s41, 31744
buffer_load_dwordx4 v2, s[12:15], s41 offen offset:1024 lds
s_add_u32 s41, s41, 31744
buffer_load_dwordx4 v2, s[12:15], s41 offen offset:2048 lds
s_add_u32 s41, s41, 31744
buffer_load_dwordx4 v2, s[12:15], s41 offen offset:3072 lds
ds_read_b64_tr_b16 a[24:25], v4 offset:49152
ds_read_b64_tr_b16 a[26:27], v4 offset:50176
ds_read_b64_tr_b16 a[88:89], v4 offset:49160
ds_read_b64_tr_b16 a[90:91], v4 offset:50184
ds_read_b64_tr_b16 a[28:29], v4 offset:57344
ds_read_b64_tr_b16 a[30:31], v4 offset:58368
ds_read_b64_tr_b16 a[92:93], v4 offset:57352
ds_read_b64_tr_b16 a[94:95], v4 offset:58376
s_waitcnt lgkmcnt(0)
s_waitcnt vmcnt(24)
s_barrier
s_lshl_b32 s40, s33, 12
s_add_u32 s40, s40, 49152
s_mov_b32 m0, s40
s_lshl_b32 s41, s33, 17
s_lshl_b32 s42, s32, 8
s_add_u32 s41, s41, s42
s_add_u32 s41, s41, 1572864
buffer_load_dwordx4 v2, s[12:15], s41 offen offset:0 lds
s_add_u32 s41, s41, 31744
buffer_load_dwordx4 v2, s[12:15], s41 offen offset:1024 lds
s_add_u32 s41, s41, 31744
buffer_load_dwordx4 v2, s[12:15], s41 offen offset:2048 lds
s_add_u32 s41, s41, 31744
buffer_load_dwordx4 v2, s[12:15], s41 offen offset:3072 lds
ds_read_b64_tr_b16 a[32:33], v5 offset:0
ds_read_b64_tr_b16 a[34:35], v5 offset:1024
ds_read_b64_tr_b16 a[96:97], v5 offset:8
ds_read_b64_tr_b16 a[98:99], v5 offset:1032
ds_read_b64_tr_b16 a[36:37], v5 offset:8192
ds_read_b64_tr_b16 a[38:39], v5 offset:9216
ds_read_b64_tr_b16 a[100:101], v5 offset:8200
ds_read_b64_tr_b16 a[102:103], v5 offset:9224
s_waitcnt lgkmcnt(0)
s_waitcnt vmcnt(24)
s_barrier
s_lshl_b32 s40, s33, 12
s_add_u32 s40, s40, 65536
s_mov_b32 m0, s40
s_lshl_b32 s41, s33, 17
s_lshl_b32 s42, s32, 8
s_add_u32 s41, s41, s42
s_add_u32 s41, s41, 2097152
buffer_load_dwordx4 v2, s[12:15], s41 offen offset:0 lds
s_add_u32 s41, s41, 31744
buffer_load_dwordx4 v2, s[12:15], s41 offen offset:1024 lds
s_add_u32 s41, s41, 31744
buffer_load_dwordx4 v2, s[12:15], s41 offen offset:2048 lds
s_add_u32 s41, s41, 31744
buffer_load_dwordx4 v2, s[12:15], s41 offen offset:3072 lds
ds_read_b64_tr_b16 a[40:41], v5 offset:16384
ds_read_b64_tr_b16 a[42:43], v5 offset:17408
ds_read_b64_tr_b16 a[104:105], v5 offset:16392
ds_read_b64_tr_b16 a[106:107], v5 offset:17416
ds_read_b64_tr_b16 a[44:45], v5 offset:24576
ds_read_b64_tr_b16 a[46:47], v5 offset:25600
ds_read_b64_tr_b16 a[108:109], v5 offset:24584
ds_read_b64_tr_b16 a[110:111], v5 offset:25608
s_waitcnt lgkmcnt(0)
s_waitcnt vmcnt(24)
s_barrier
s_lshl_b32 s40, s33, 12
s_add_u32 s40, s40, 81920
s_mov_b32 m0, s40
s_lshl_b32 s41, s33, 17
s_lshl_b32 s42, s32, 8
s_add_u32 s41, s41, s42
s_add_u32 s41, s41, 2621440
buffer_load_dwordx4 v2, s[12:15], s41 offen offset:0 lds
s_add_u32 s41, s41, 31744
buffer_load_dwordx4 v2, s[12:15], s41 offen offset:1024 lds
s_add_u32 s41, s41, 31744
buffer_load_dwordx4 v2, s[12:15], s41 offen offset:2048 lds
s_add_u32 s41, s41, 31744
buffer_load_dwordx4 v2, s[12:15], s41 offen offset:3072 lds
ds_read_b64_tr_b16 a[48:49], v5 offset:32768
ds_read_b64_tr_b16 a[50:51], v5 offset:33792
ds_read_b64_tr_b16 a[112:113], v5 offset:32776
ds_read_b64_tr_b16 a[114:115], v5 offset:33800
ds_read_b64_tr_b16 a[52:53], v5 offset:40960
ds_read_b64_tr_b16 a[54:55], v5 offset:41984
ds_read_b64_tr_b16 a[116:117], v5 offset:40968
ds_read_b64_tr_b16 a[118:119], v5 offset:41992
s_waitcnt lgkmcnt(0)
s_waitcnt vmcnt(24)
s_barrier
s_cmp_lg_u32 s33, 0
s_cbranch_scc1 L_dp5
v_lshlrev_b32 v124, 3, v0
s_mov_b64 exec, 0xff
buffer_load_dwordx2 v[120:121], v124, s[28:31], 0 offen offset:128 sc1
s_mov_b64 exec, -1
L_dp5:
s_lshl_b32 s40, s33, 12
s_add_u32 s40, s40, 98304
s_mov_b32 m0, s40
s_lshl_b32 s41, s33, 17
s_lshl_b32 s42, s32, 8
s_add_u32 s41, s41, s42
s_add_u32 s41, s41, 3145728
buffer_load_dwordx4 v2, s[12:15], s41 offen offset:0 lds
s_add_u32 s41, s41, 31744
buffer_load_dwordx4 v2, s[12:15], s41 offen offset:1024 lds
s_add_u32 s41, s41, 31744
buffer_load_dwordx4 v2, s[12:15], s41 offen offset:2048 lds
s_add_u32 s41, s41, 31744
buffer_load_dwordx4 v2, s[12:15], s41 offen offset:3072 lds
ds_read_b64_tr_b16 a[56:57], v5 offset:49152
ds_read_b64_tr_b16 a[58:59], v5 offset:50176
ds_read_b64_tr_b16 a[120:121], v5 offset:49160
ds_read_b64_tr_b16 a[122:123], v5 offset:50184
ds_read_b64_tr_b16 a[60:61], v5 offset:57344
ds_read_b64_tr_b16 a[62:63], v5 offset:58368
ds_read_b64_tr_b16 a[124:125], v5 offset:57352
ds_read_b64_tr_b16 a[126:127], v5 offset:58376
s_waitcnt lgkmcnt(0)
s_waitcnt vmcnt(24)
s_barrier
s_lshl_b32 s40, s33, 12
s_add_u32 s40, s40, 114688
s_mov_b32 m0, s40
s_lshl_b32 s41, s33, 17
s_lshl_b32 s42, s32, 8
s_add_u32 s41, s41, s42
s_add_u32 s41, s41, 3670016
buffer_load_dwordx4 v2, s[12:15], s41 offen offset:0 lds
s_add_u32 s41, s41, 31744
buffer_load_dwordx4 v2, s[12:15], s41 offen offset:1024 lds
s_add_u32 s41, s41, 31744
buffer_load_dwordx4 v2, s[12:15], s41 offen offset:2048 lds
s_add_u32 s41, s41, 31744
buffer_load_dwordx4 v2, s[12:15], s41 offen offset:3072 lds
ds_read_b64_tr_b16 a[128:129], v6 offset:0
ds_read_b64_tr_b16 a[130:131], v6 offset:1024
ds_read_b64_tr_b16 a[192:193], v6 offset:32
ds_read_b64_tr_b16 a[194:195], v6 offset:1056
ds_read_b64_tr_b16 a[132:133], v6 offset:8192
ds_read_b64_tr_b16 a[134:135], v6 offset:9216
ds_read_b64_tr_b16 a[196:197], v6 offset:8224
ds_read_b64_tr_b16 a[198:199], v6 offset:9248
s_waitcnt lgkmcnt(0)
s_waitcnt vmcnt(24)
s_barrier
ds_read_b64_tr_b16 a[136:137], v6 offset:16384
ds_read_b64_tr_b16 a[138:139], v6 offset:17408
ds_read_b64_tr_b16 a[200:201], v6 offset:16416
ds_read_b64_tr_b16 a[202:203], v6 offset:17440
ds_read_b64_tr_b16 a[140:141], v6 offset:24576
ds_read_b64_tr_b16 a[142:143], v6 offset:25600
ds_read_b64_tr_b16 a[204:205], v6 offset:24608
ds_read_b64_tr_b16 a[206:207], v6 offset:25632
s_waitcnt lgkmcnt(0)
s_waitcnt vmcnt(20)
s_barrier
ds_read_b64_tr_b16 a[144:145], v6 offset:32768
ds_read_b64_tr_b16 a[146:147], v6 offset:33792
ds_read_b64_tr_b16 a[208:209], v6 offset:32800
ds_read_b64_tr_b16 a[210:211], v6 offset:33824
ds_read_b64_tr_b16 a[148:149], v6 offset:40960
ds_read_b64_tr_b16 a[150:151], v6 offset:41984
ds_read_b64_tr_b16 a[212:213], v6 offset:40992
ds_read_b64_tr_b16 a[214:215], v6 offset:42016
s_waitcnt lgkmcnt(0)
s_waitcnt vmcnt(16)
s_barrier
ds_read_b64_tr_b16 a[152:153], v6 offset:49152
ds_read_b64_tr_b16 a[154:155], v6 offset:50176
ds_read_b64_tr_b16 a[216:217], v6 offset:49184
ds_read_b64_tr_b16 a[218:219], v6 offset:50208
ds_read_b64_tr_b16 a[156:157], v6 offset:57344
ds_read_b64_tr_b16 a[158:159], v6 offset:58368
ds_read_b64_tr_b16 a[220:221], v6 offset:57376
ds_read_b64_tr_b16 a[222:223], v6 offset:58400
s_waitcnt lgkmcnt(0)
s_waitcnt vmcnt(12)
s_barrier
ds_read_b64_tr_b16 a[160:161], v7 offset:0
ds_read_b64_tr_b16 a[162:163], v7 offset:1024
ds_read_b64_tr_b16 a[224:225], v7 offset:32
ds_read_b64_tr_b16 a[226:227], v7 offset:1056
ds_read_b64_tr_b16 a[164:165], v7 offset:8192
ds_read_b64_tr_b16 a[166:167], v7 offset:9216
ds_read_b64_tr_b16 a[228:229], v7 offset:8224
ds_read_b64_tr_b16 a[230:231], v7 offset:9248
s_waitcnt lgkmcnt(0)
s_waitcnt vmcnt(8)
s_barrier
ds_read_b64_tr_b16 a[168:169], v7 offset:16384
ds_read_b64_tr_b16 a[170:171], v7 offset:17408
ds_read_b64_tr_b16 a[232:233], v7 offset:16416
ds_read_b64_tr_b16 a[234:235], v7 offset:17440
ds_read_b64_tr_b16 a[172:173], v7 offset:24576
ds_read_b64_tr_b16 a[174:175], v7 offset:25600
ds_read_b64_tr_b16 a[236:237], v7 offset:24608
ds_read_b64_tr_b16 a[238:239], v7 offset:25632
s_waitcnt lgkmcnt(0)
s_waitcnt vmcnt(4)
s_barrier
ds_read_b64_tr_b16 a[176:177], v7 offset:32768
ds_read_b64_tr_b16 a[178:179], v7 offset:33792
ds_read_b64_tr_b16 a[240:241], v7 offset:32800
ds_read_b64_tr_b16 a[242:243], v7 offset:33824
ds_read_b64_tr_b16 a[180:181], v7 offset:40960
ds_read_b64_tr_b16 a[182:183], v7 offset:41984
ds_read_b64_tr_b16 a[244:245], v7 offset:40992
ds_read_b64_tr_b16 a[246:247], v7 offset:42016
s_waitcnt lgkmcnt(0)
s_waitcnt vmcnt(0)
s_barrier
ds_read_b64_tr_b16 a[184:185], v7 offset:49152
ds_read_b64_tr_b16 a[186:187], v7 offset:50176
ds_read_b64_tr_b16 a[248:249], v7 offset:49184
ds_read_b64_tr_b16 a[250:251], v7 offset:50208
ds_read_b64_tr_b16 a[188:189], v7 offset:57344
ds_read_b64_tr_b16 a[190:191], v7 offset:58368
ds_read_b64_tr_b16 a[252:253], v7 offset:57376
ds_read_b64_tr_b16 a[254:255], v7 offset:58400
s_waitcnt lgkmcnt(0)
s_barrier
L_decide:
s_cmp_lg_u32 s71, 0
s_cbranch_scc1 L_roles
v_mov_b32 v125, 163824
s_cmp_lg_u32 s33, 0
s_cbranch_scc1 L_dd
v_lshlrev_b32 v124, 3, v0
s_waitcnt vmcnt(0)
v_sad_u8 v123, v126, 0, 0
v_sad_u8 v123, v127, 0, v123
s_nop 0
v_readfirstlane_b32 s99, v123
s_mov_b64 exec, 0xff
v_mov_b32 v126, v120
v_mov_b32 v127, v121
s_branch L_dl2
L_dl:
buffer_load_dwordx2 v[126:127], v124, s[28:31], 0 offen offset:128 sc1
s_add_u32 s51, s51, 1
s_cmp_gt_u32 s51, 300000
s_cbranch_scc1 L_end
s_waitcnt vmcnt(0)
L_dl2:
v_sad_u8 v123, v126, 0, 0
v_sad_u8 v123, v127, 0, v123
s_mov_b32 s41, 0
s_mov_b32 s100, s99
v_readlane_b32 s40, v123, 0
s_add_u32 s41, s41, s40
s_cmp_gt_u32 s63, 0
s_cselect_b32 s40, s40, 0
s_add_u32 s100, s100, s40
v_readlane_b32 s40, v123, 1
s_add_u32 s41, s41, s40
s_cmp_gt_u32 s63, 1
s_cselect_b32 s40, s40, 0
s_add_u32 s100, s100, s40
v_readlane_b32 s40, v123, 2
s_add_u32 s41, s41, s40
s_cmp_gt_u32 s63, 2
s_cselect_b32 s40, s40, 0
s_add_u32 s100, s100, s40
v_readlane_b32 s40, v123, 3
s_add_u32 s41, s41, s40
s_cmp_gt_u32 s63, 3
s_cselect_b32 s40, s40, 0
s_add_u32 s100, s100, s40
v_readlane_b32 s40, v123, 4
s_add_u32 s41, s41, s40
s_cmp_gt_u32 s63, 4
s_cselect_b32 s40, s40, 0
s_add_u32 s100, s100, s40
v_readlane_b32 s40, v123, 5
s_add_u32 s41, s41, s40
s_cmp_gt_u32 s63, 5
s_cselect_b32 s40, s40, 0
s_add_u32 s100, s100, s40
v_readlane_b32 s40, v123, 6
s_add_u32 s41, s41, s40
s_cmp_gt_u32 s63, 6
s_cselect_b32 s40, s40, 0
s_add_u32 s100, s100, s40
v_readlane_b32 s40, v123, 7
s_add_u32 s41, s41, s40
s_cmp_gt_u32 s63, 7
s_cselect_b32 s40, s40, 0
s_add_u32 s100, s100, s40
s_cmp_ge_u32 s41, 256
s_cbranch_scc1 L_dok
s_sleep 2
s_branch L_dl
L_dok:
v_bcnt_u32_b32 v122, v126, 0
v_bcnt_u32_b32 v122, v127, v122
v_cmp_ne_u32 vcc, 32, v123
v_cmp_ne_u32 s[42:43], 1, v122
s_mov_b64 exec, -1
s_cmp_lg_u32 s42, 0
s_cselect_b32 s40, 1, 0
s_cmp_lg_u32 vcc_lo, 0
s_cselect_b32 s40, 2, s40
v_mov_b32 v122, s40
v_mov_b32 v123, s100
v_mov_b32 v124, s99
ds_write_b96 v125, v[122:124]
s_waitcnt lgkmcnt(0)
L_dd:
s_barrier
ds_read_b96 v[122:124], v125
s_waitcnt lgkmcnt(0)
v_readfirstlane_b32 s40, v122
v_readfirstlane_b32 s100, v123
v_readfirstlane_b32 s99, v124
s_mov_b32 s59, 0
s_mov_b32 s71, 1
s_cmp_eq_u32 s40, 0
s_cbranch_scc1 L_roles
s_mov_b32 s32, s99
s_cmp_eq_u32 s40, 1
s_cbranch_scc1 L_redo
s_mov_b32 s59, 1
s_lshr_b32 s58, s100, 5
s_and_b32 s32, s100, 31
L_redo:
s_waitcnt vmcnt(0)
s_barrier
s_branch L_pre
L_roles:
s_cmp_eq_u32 s70, 1
s_cbranch_scc1 L_chain
s_cmp_lg_u32 s70, 2
s_cbranch_scc1 L_notkv
L_kv2:
s_sub_u32 s35, s58, 1
s_mov_b32 s36, 64
s_mov_b32 s37, 0
v_lshrrev_b32 v12, 1, v1
s_mov_b32 s41, 51404800
L_wh6:
buffer_load_dwordx2 v[10:11], v12, s[4:7], s41 offen sc1
s_add_u32 s51, s51, 1
s_cmp_gt_u32 s51, 300000
s_cbranch_scc1 L_end
s_waitcnt vmcnt(0)
v_min_u32 v10, v10, v11
v_cmp_eq_u32 vcc, 0, v10
s_cbranch_vccz L_whd6
s_sleep 4
s_branch L_wh6
L_whd6:
s_lshl_b32 s45, s35, 15
s_lshl_b32 s46, s33, 13
s_add_u32 s45, s45, s46
s_add_u32 s45, s45, 48234496
s_add_u32 s46, s46, s37
s_mov_b32 m0, s46
s_nop 0
buffer_load_dwordx4 v1, s[4:7], s45 offen offset:0 sc1 lds
buffer_load_dwordx4 v1, s[4:7], s45 offen offset:1024 sc1 lds
buffer_load_dwordx4 v1, s[4:7], s45 offen offset:2048 sc1 lds
buffer_load_dwordx4 v1, s[4:7], s45 offen offset:3072 sc1 lds
s_add_u32 s45, s45, 4096
s_add_u32 s46, s46, 4096
s_mov_b32 m0, s46
s_nop 0
buffer_load_dwordx4 v1, s[4:7], s45 offen offset:0 sc1 lds
buffer_load_dwordx4 v1, s[4:7], s45 offen offset:1024 sc1 lds
buffer_load_dwordx4 v1, s[4:7], s45 offen offset:2048 sc1 lds
buffer_load_dwordx4 v1, s[4:7], s45 offen offset:3072 sc1 lds
s_mov_b32 s39, 64
s_waitcnt vmcnt(0)
L_kv_loop:
s_waitcnt vmcnt(4)
s_barrier
v_add_u32 v3, s37, v1
s_mov_b32 s39, s36
s_mov_b32 s36, s35
s_add_u32 s35, s35, 2
s_xor_b32 s37, s37, 32768
s_min_u32 s44, s35, 63
s_mov_b32 s43, s35
s_mov_b32 s35, s44
s_lshl_b32 s45, s35, 15
s_lshl_b32 s46, s33, 13
s_add_u32 s45, s45, s46
s_add_u32 s45, s45, 48234496
s_add_u32 s46, s46, s37
s_mov_b32 m0, s46
s_nop 0
s_mov_b32 s35, s43
ds_read_b128 v[16:19], v3 offset:0
ds_read_b128 v[20:23], v3 offset:16384
ds_read_b128 v[24:27], v3 offset:1024
ds_read_b128 v[28:31], v3 offset:17408
ds_read_b128 v[32:35], v3 offset:2048
ds_read_b128 v[36:39], v3 offset:18432
s_waitcnt lgkmcnt(4)
v_mfma_f32_16x16x32_bf16 v[48:51], a[0:3], v[16:19], 0
v_mfma_f32_16x16x32_bf16 v[52:55], a[64:67], v[16:19], 0
v_mfma_f32_16x16x32_bf16 v[56:59], a[0:3], v[20:23], 0
v_mfma_f32_16x16x32_bf16 v[60:63], a[64:67], v[20:23], 0
v_mfma_f32_16x16x32_bf16 v[64:67], v[16:19], a[128:131], 0
v_mfma_f32_16x16x32_bf16 v[68:71], v[16:19], a[192:195], 0
v_mfma_f32_16x16x32_bf16 v[72:75], v[20:23], a[128:131], 0
v_mfma_f32_16x16x32_bf16 v[76:79], v[20:23], a[192:195], 0
ds_read_b128 v[16:19], v3 offset:3072
ds_read_b128 v[20:23], v3 offset:19456
s_waitcnt lgkmcnt(4)
v_mfma_f32_16x16x32_bf16 v[48:51], a[4:7], v[24:27], v[48:51]
v_mfma_f32_16x16x32_bf16 v[52:55], a[68:71], v[24:27], v[52:55]
v_mfma_f32_16x16x32_bf16 v[56:59], a[4:7], v[28:31], v[56:59]
v_mfma_f32_16x16x32_bf16 v[60:63], a[68:71], v[28:31], v[60:63]
v_mfma_f32_16x16x32_bf16 v[64:67], v[24:27], a[132:135], v[64:67]
v_mfma_f32_16x16x32_bf16 v[68:71], v[24:27], a[196:199], v[68:71]
v_mfma_f32_16x16x32_bf16 v[72:75], v[28:31], a[132:135], v[72:75]
v_mfma_f32_16x16x32_bf16 v[76:79], v[28:31], a[196:199], v[76:79]
ds_read_b128 v[24:27], v3 offset:4096
ds_read_b128 v[28:31], v3 offset:20480
s_waitcnt lgkmcnt(4)
v_mfma_f32_16x16x32_bf16 v[48:51], a[8:11], v[32:35], v[48:51]
v_mfma_f32_16x16x32_bf16 v[52:55], a[72:75], v[32:35], v[52:55]
v_mfma_f32_16x16x32_bf16 v[56:59], a[8:11], v[36:39], v[56:59]
v_mfma_f32_16x16x32_bf16 v[60:63], a[72:75], v[36:39], v[60:63]
v_mfma_f32_16x16x32_bf16 v[64:67], v[32:35], a[136:139], v[64:67]
v_mfma_f32_16x16x32_bf16 v[68:71], v[32:35], a[200:203], v[68:71]
v_mfma_f32_16x16x32_bf16 v[72:75], v[36:39], a[136:139], v[72:75]
v_mfma_f32_16x16x32_bf16 v[76:79], v[36:39], a[200:203], v[76:79]
ds_read_b128 v[32:35], v3 offset:5120
ds_read_b128 v[36:39], v3 offset:21504
s_waitcnt lgkmcnt(4)
v_mfma_f32_16x16x32_bf16 v[48:51], a[12:15], v[16:19], v[48:51]
v_mfma_f32_16x16x32_bf16 v[52:55], a[76:79], v[16:19], v[52:55]
v_mfma_f32_16x16x32_bf16 v[56:59], a[12:15], v[20:23], v[56:59]
v_mfma_f32_16x16x32_bf16 v[60:63], a[76:79], v[20:23], v[60:63]
v_mfma_f32_16x16x32_bf16 v[64:67], v[16:19], a[140:143], v[64:67]
v_mfma_f32_16x16x32_bf16 v[68:71], v[16:19], a[204:207], v[68:71]
v_mfma_f32_16x16x32_bf16 v[72:75], v[20:23], a[140:143], v[72:75]
v_mfma_f32_16x16x32_bf16 v[76:79], v[20:23], a[204:207], v[76:79]
ds_read_b128 v[16:19], v3 offset:6144
ds_read_b128 v[20:23], v3 offset:22528
s_waitcnt lgkmcnt(4)
s_waitcnt vmcnt(0)
s_barrier
s_cmp_lg_u32 s33, 0
s_cbranch_scc1 L_kf7
s_cmp_ge_u32 s39, 64
s_cbranch_scc1 L_kf7
s_lshl_b32 s41, s32, 6
s_add_u32 s41, s41, s39
s_lshl_b32 s41, s41, 2
s_add_u32 s41, s41, 51380224
s_mov_b64 exec, 1
v_mov_b32 v9, 1
buffer_store_dword v9, off, s[4:7], s41 sc1
s_mov_b64 exec, -1
L_kf7:
v_mfma_f32_16x16x32_bf16 v[48:51], a[16:19], v[24:27], v[48:51]
v_mfma_f32_16x16x32_bf16 v[52:55], a[80:83], v[24:27], v[52:55]
v_mfma_f32_16x16x32_bf16 v[56:59], a[16:19], v[28:31], v[56:59]
v_mfma_f32_16x16x32_bf16 v[60:63], a[80:83], v[28:31], v[60:63]
v_mfma_f32_16x16x32_bf16 v[64:67], v[24:27], a[144:147], v[64:67]
v_mfma_f32_16x16x32_bf16 v[68:71], v[24:27], a[208:211], v[68:71]
v_mfma_f32_16x16x32_bf16 v[72:75], v[28:31], a[144:147], v[72:75]
v_mfma_f32_16x16x32_bf16 v[76:79], v[28:31], a[208:211], v[76:79]
ds_read_b128 v[24:27], v3 offset:7168
ds_read_b128 v[28:31], v3 offset:23552
s_waitcnt lgkmcnt(4)
v_mfma_f32_16x16x32_bf16 v[48:51], a[20:23], v[32:35], v[48:51]
v_mfma_f32_16x16x32_bf16 v[52:55], a[84:87], v[32:35], v[52:55]
v_mfma_f32_16x16x32_bf16 v[56:59], a[20:23], v[36:39], v[56:59]
v_mfma_f32_16x16x32_bf16 v[60:63], a[84:87], v[36:39], v[60:63]
buffer_load_dwordx4 v1, s[4:7], s45 offen offset:0 sc1 lds
v_mfma_f32_16x16x32_bf16 v[64:67], v[32:35], a[148:151], v[64:67]
v_mfma_f32_16x16x32_bf16 v[68:71], v[32:35], a[212:215], v[68:71]
v_mfma_f32_16x16x32_bf16 v[72:75], v[36:39], a[148:151], v[72:75]
v_mfma_f32_16x16x32_bf16 v[76:79], v[36:39], a[212:215], v[76:79]
ds_read_b128 v[32:35], v3 offset:8192
ds_read_b128 v[36:39], v3 offset:24576
s_waitcnt lgkmcnt(4)
v_mfma_f32_16x16x32_bf16 v[48:51], a[24:27], v[16:19], v[48:51]
v_mfma_f32_16x16x32_bf16 v[52:55], a[88:91], v[16:19], v[52:55]
v_mfma_f32_16x16x32_bf16 v[56:59], a[24:27], v[20:23], v[56:59]
v_mfma_f32_16x16x32_bf16 v[60:63], a[88:91], v[20:23], v[60:63]
buffer_load_dwordx4 v1, s[4:7], s45 offen offset:1024 sc1 lds
v_mfma_f32_16x16x32_bf16 v[64:67], v[16:19], a[152:155], v[64:67]
v_mfma_f32_16x16x32_bf16 v[68:71], v[16:19], a[216:219], v[68:71]
v_mfma_f32_16x16x32_bf16 v[72:75], v[20:23], a[152:155], v[72:75]
v_mfma_f32_16x16x32_bf16 v[76:79], v[20:23], a[216:219], v[76:79]
ds_read_b128 v[16:19], v3 offset:9216
ds_read_b128 v[20:23], v3 offset:25600
s_waitcnt lgkmcnt(4)
v_mfma_f32_16x16x32_bf16 v[48:51], a[28:31], v[24:27], v[48:51]
v_mfma_f32_16x16x32_bf16 v[52:55], a[92:95], v[24:27], v[52:55]
v_mfma_f32_16x16x32_bf16 v[56:59], a[28:31], v[28:31], v[56:59]
v_mfma_f32_16x16x32_bf16 v[60:63], a[92:95], v[28:31], v[60:63]
buffer_load_dwordx4 v1, s[4:7], s45 offen offset:2048 sc1 lds
v_mfma_f32_16x16x32_bf16 v[64:67], v[24:27], a[156:159], v[64:67]
v_mfma_f32_16x16x32_bf16 v[68:71], v[24:27], a[220:223], v[68:71]
v_mfma_f32_16x16x32_bf16 v[72:75], v[28:31], a[156:159], v[72:75]
v_mfma_f32_16x16x32_bf16 v[76:79], v[28:31], a[220:223], v[76:79]
ds_read_b128 v[24:27], v3 offset:10240
ds_read_b128 v[28:31], v3 offset:26624
s_waitcnt lgkmcnt(4)
v_mfma_f32_16x16x32_bf16 v[48:51], a[32:35], v[32:35], v[48:51]
v_mfma_f32_16x16x32_bf16 v[52:55], a[96:99], v[32:35], v[52:55]
v_mfma_f32_16x16x32_bf16 v[56:59], a[32:35], v[36:39], v[56:59]
v_mfma_f32_16x16x32_bf16 v[60:63], a[96:99], v[36:39], v[60:63]
buffer_load_dwordx4 v1, s[4:7], s45 offen offset:3072 sc1 lds
s_add_u32 s45, s45, 4096
s_add_u32 s46, s46, 4096
s_mov_b32 m0, s46
v_mfma_f32_16x16x32_bf16 v[64:67], v[32:35], a[160:163], v[64:67]
v_mfma_f32_16x16x32_bf16 v[68:71], v[32:35], a[224:227], v[68:71]
v_mfma_f32_16x16x32_bf16 v[72:75], v[36:39], a[160:163], v[72:75]
v_mfma_f32_16x16x32_bf16 v[76:79], v[36:39], a[224:227], v[76:79]
ds_read_b128 v[32:35], v3 offset:11264
ds_read_b128 v[36:39], v3 offset:27648
s_waitcnt lgkmcnt(4)
v_mfma_f32_16x16x32_bf16 v[48:51], a[36:39], v[16:19], v[48:51]
v_mfma_f32_16x16x32_bf16 v[52:55], a[100:103], v[16:19], v[52:55]
v_mfma_f32_16x16x32_bf16 v[56:59], a[36:39], v[20:23], v[56:59]
v_mfma_f32_16x16x32_bf16 v[60:63], a[100:103], v[20:23], v[60:63]
buffer_load_dwordx4 v1, s[4:7], s45 offen offset:0 sc1 lds
v_mfma_f32_16x16x32_bf16 v[64:67], v[16:19], a[164:167], v[64:67]
v_mfma_f32_16x16x32_bf16 v[68:71], v[16:19], a[228:231], v[68:71]
v_mfma_f32_16x16x32_bf16 v[72:75], v[20:23], a[164:167], v[72:75]
v_mfma_f32_16x16x32_bf16 v[76:79], v[20:23], a[228:231], v[76:79]
ds_read_b128 v[16:19], v3 offset:12288
ds_read_b128 v[20:23], v3 offset:28672
s_waitcnt lgkmcnt(4)
v_mfma_f32_16x16x32_bf16 v[48:51], a[40:43], v[24:27], v[48:51]
v_mfma_f32_16x16x32_bf16 v[52:55], a[104:107], v[24:27], v[52:55]
v_mfma_f32_16x16x32_bf16 v[56:59], a[40:43], v[28:31], v[56:59]
v_mfma_f32_16x16x32_bf16 v[60:63], a[104:107], v[28:31], v[60:63]
buffer_load_dwordx4 v1, s[4:7], s45 offen offset:1024 sc1 lds
v_mfma_f32_16x16x32_bf16 v[64:67], v[24:27], a[168:171], v[64:67]
v_mfma_f32_16x16x32_bf16 v[68:71], v[24:27], a[232:235], v[68:71]
v_mfma_f32_16x16x32_bf16 v[72:75], v[28:31], a[168:171], v[72:75]
v_mfma_f32_16x16x32_bf16 v[76:79], v[28:31], a[232:235], v[76:79]
ds_read_b128 v[24:27], v3 offset:13312
ds_read_b128 v[28:31], v3 offset:29696
s_waitcnt lgkmcnt(4)
v_mfma_f32_16x16x32_bf16 v[48:51], a[44:47], v[32:35], v[48:51]
v_mfma_f32_16x16x32_bf16 v[52:55], a[108:111], v[32:35], v[52:55]
v_mfma_f32_16x16x32_bf16 v[56:59], a[44:47], v[36:39], v[56:59]
v_mfma_f32_16x16x32_bf16 v[60:63], a[108:111], v[36:39], v[60:63]
buffer_load_dwordx4 v1, s[4:7], s45 offen offset:2048 sc1 lds
v_mfma_f32_16x16x32_bf16 v[64:67], v[32:35], a[172:175], v[64:67]
v_mfma_f32_16x16x32_bf16 v[68:71], v[32:35], a[236:239], v[68:71]
v_mfma_f32_16x16x32_bf16 v[72:75], v[36:39], a[172:175], v[72:75]
v_mfma_f32_16x16x32_bf16 v[76:79], v[36:39], a[236:239], v[76:79]
ds_read_b128 v[32:35], v3 offset:14336
ds_read_b128 v[36:39], v3 offset:30720
s_waitcnt lgkmcnt(4)
v_mfma_f32_16x16x32_bf16 v[48:51], a[48:51], v[16:19], v[48:51]
v_mfma_f32_16x16x32_bf16 v[52:55], a[112:115], v[16:19], v[52:55]
v_mfma_f32_16x16x32_bf16 v[56:59], a[48:51], v[20:23], v[56:59]
v_mfma_f32_16x16x32_bf16 v[60:63], a[112:115], v[20:23], v[60:63]
buffer_load_dwordx4 v1, s[4:7], s45 offen offset:3072 sc1 lds
v_mfma_f32_16x16x32_bf16 v[64:67], v[16:19], a[176:179], v[64:67]
v_mfma_f32_16x16x32_bf16 v[68:71], v[16:19], a[240:243], v[68:71]
v_mfma_f32_16x16x32_bf16 v[72:75], v[20:23], a[176:179], v[72:75]
v_mfma_f32_16x16x32_bf16 v[76:79], v[20:23], a[240:243], v[76:79]
ds_read_b128 v[16:19], v3 offset:15360
ds_read_b128 v[20:23], v3 offset:31744
s_waitcnt lgkmcnt(4)
v_mfma_f32_16x16x32_bf16 v[48:51], a[52:55], v[24:27], v[48:51]
v_mfma_f32_16x16x32_bf16 v[52:55], a[116:119], v[24:27], v[52:55]
v_mfma_f32_16x16x32_bf16 v[56:59], a[52:55], v[28:31], v[56:59]
v_mfma_f32_16x16x32_bf16 v[60:63], a[116:119], v[28:31], v[60:63]
v_mfma_f32_16x16x32_bf16 v[64:67], v[24:27], a[180:183], v[64:67]
v_mfma_f32_16x16x32_bf16 v[68:71], v[24:27], a[244:247], v[68:71]
v_mfma_f32_16x16x32_bf16 v[72:75], v[28:31], a[180:183], v[72:75]
v_mfma_f32_16x16x32_bf16 v[76:79], v[28:31], a[244:247], v[76:79]
s_waitcnt lgkmcnt(2)
v_mfma_f32_16x16x32_bf16 v[48:51], a[56:59], v[32:35], v[48:51]
v_mfma_f32_16x16x32_bf16 v[52:55], a[120:123], v[32:35], v[52:55]
v_mfma_f32_16x16x32_bf16 v[56:59], a[56:59], v[36:39], v[56:59]
v_mfma_f32_16x16x32_bf16 v[60:63], a[120:123], v[36:39], v[60:63]
v_mfma_f32_16x16x32_bf16 v[64:67], v[32:35], a[184:187], v[64:67]
v_mfma_f32_16x16x32_bf16 v[68:71], v[32:35], a[248:251], v[68:71]
v_mfma_f32_16x16x32_bf16 v[72:75], v[36:39], a[184:187], v[72:75]
v_mfma_f32_16x16x32_bf16 v[76:79], v[36:39], a[248:251], v[76:79]
s_waitcnt lgkmcnt(0)
v_mfma_f32_16x16x32_bf16 v[48:51], a[60:63], v[16:19], v[48:51]
v_mfma_f32_16x16x32_bf16 v[52:55], a[124:127], v[16:19], v[52:55]
v_mfma_f32_16x16x32_bf16 v[56:59], a[60:63], v[20:23], v[56:59]
v_mfma_f32_16x16x32_bf16 v[60:63], a[124:127], v[20:23], v[60:63]
v_mfma_f32_16x16x32_bf16 v[64:67], v[16:19], a[188:191], v[64:67]
v_mfma_f32_16x16x32_bf16 v[68:71], v[16:19], a[252:255], v[68:71]
v_mfma_f32_16x16x32_bf16 v[72:75], v[20:23], a[188:191], v[72:75]
v_mfma_f32_16x16x32_bf16 v[76:79], v[20:23], a[252:255], v[76:79]
s_lshl_b32 s38, s36, 5
s_add_u32 s38, s38, s32
s_lshl_b32 s38, s38, 14
s_lshl_b32 s41, s33, 10
s_add_u32 s42, s38, s41
s_add_u32 s43, s42, 4096
s_add_u32 s44, s42, s41
s_add_u32 s44, s44, 8192
v_cvt_pk_bf16_f32 v80, v48, v49
v_cvt_pk_bf16_f32 v81, v50, v51
v_cvt_pk_bf16_f32 v82, v52, v53
v_cvt_pk_bf16_f32 v83, v54, v55
buffer_store_dwordx4 v[80:83], v1, s[4:7], s42 offen sc1
v_cvt_pk_bf16_f32 v84, v56, v57
v_cvt_pk_bf16_f32 v85, v58, v59
v_cvt_pk_bf16_f32 v86, v60, v61
v_cvt_pk_bf16_f32 v87, v62, v63
buffer_store_dwordx4 v[84:87], v1, s[4:7], s43 offen sc1
v_cvt_pk_bf16_f32 v88, v64, v65
v_cvt_pk_bf16_f32 v89, v66, v67
v_cvt_pk_bf16_f32 v90, v72, v73
v_cvt_pk_bf16_f32 v91, v74, v75
buffer_store_dwordx4 v[88:91], v1, s[4:7], s44 offen offset:0 sc1
v_cvt_pk_bf16_f32 v92, v68, v69
v_cvt_pk_bf16_f32 v93, v70, v71
v_cvt_pk_bf16_f32 v94, v76, v77
v_cvt_pk_bf16_f32 v95, v78, v79
buffer_store_dwordx4 v[92:95], v1, s[4:7], s44 offen offset:1024 sc1
s_cmp_lt_u32 s35, 64
s_cbranch_scc1 L_kv_loop
s_waitcnt vmcnt(0)
s_barrier
s_cmp_lg_u32 s33, 0
s_cbranch_scc1 L_kf8
s_cmp_ge_u32 s36, 64
s_cbranch_scc1 L_kf8
s_lshl_b32 s41, s32, 6
s_add_u32 s41, s41, s36
s_lshl_b32 s41, s41, 2
s_add_u32 s41, s41, 51380224
s_mov_b64 exec, 1
v_mov_b32 v9, 1
buffer_store_dword v9, off, s[4:7], s41 sc1
s_mov_b64 exec, -1
L_kf8:
s_branch L_end
L_notkv:
s_cmp_lg_u32 s70, 3
s_cbranch_scc1 L_notln
s_cmp_lg_u32 s33, 0
s_cbranch_scc1 L_w19
L_wg10:
buffer_load_dword v9, off, s[28:31], 0 offset:0 sc1
s_add_u32 s51, s51, 1
s_cmp_gt_u32 s51, 300000
s_cbranch_scc1 L_end
s_waitcnt vmcnt(0)
v_readfirstlane_b32 s40, v9
s_cmp_ge_u32 s40, 16
s_cbranch_scc1 L_wd10
s_sleep 2
s_branch L_wg10
L_wd10:
L_w19:
s_barrier
v_lshlrev_b32 v7, 4, v3
s_lshl_b32 s42, s33, 8
s_add_u32 s42, s42, 50331648
buffer_load_dwordx4 v[64:67], v7, s[4:7], s42 offen offset:0 sc1
buffer_load_dwordx4 v[80:83], v7, s[4:7], s42 offen offset:1024 sc1
buffer_load_dwordx4 v[68:71], v7, s[4:7], s42 offen offset:64 sc1
buffer_load_dwordx4 v[84:87], v7, s[4:7], s42 offen offset:1088 sc1
buffer_load_dwordx4 v[72:75], v7, s[4:7], s42 offen offset:128 sc1
buffer_load_dwordx4 v[88:91], v7, s[4:7], s42 offen offset:1152 sc1
buffer_load_dwordx4 v[76:79], v7, s[4:7], s42 offen offset:192 sc1
buffer_load_dwordx4 v[92:95], v7, s[4:7], s42 offen offset:1216 sc1
v_mul_f32 v32, v32, v8
v_mul_f32 v33, v33, v8
v_mul_f32 v34, v34, v8
v_mul_f32 v35, v35, v8
v_mul_f32 v36, v36, v8
v_mul_f32 v37, v37, v8
v_mul_f32 v38, v38, v8
v_mul_f32 v39, v39, v8
v_mul_f32 v40, v40, v8
v_mul_f32 v41, v41, v8
v_mul_f32 v42, v42, v8
v_mul_f32 v43, v43, v8
v_mul_f32 v44, v44, v8
v_mul_f32 v45, v45, v8
v_mul_f32 v46, v46, v8
v_mul_f32 v47, v47, v8
v_mul_f32 v48, v48, v8
v_mul_f32 v49, v49, v8
v_mul_f32 v50, v50, v8
v_mul_f32 v51, v51, v8
v_mul_f32 v52, v52, v8
v_mul_f32 v53, v53, v8
v_mul_f32 v54, v54, v8
v_mul_f32 v55, v55, v8
v_mul_f32 v56, v56, v8
v_mul_f32 v57, v57, v8
v_mul_f32 v58, v58, v8
v_mul_f32 v59, v59, v8
v_mul_f32 v60, v60, v8
v_mul_f32 v61, v61, v8
v_mul_f32 v62, v62, v8
v_mul_f32 v63, v63, v8
v_lshlrev_b32 v7, 4, v1
s_lshl_b32 s41, s101, 14
s_lshl_b32 s42, s33, 12
s_add_u32 s41, s41, s42
s_add_u32 s41, s41, 48234496
s_waitcnt vmcnt(0)
v_lshlrev_b32 v10, 16, v64
v_and_b32 v11, 0xffff0000, v64
v_lshlrev_b32 v12, 16, v80
v_and_b32 v13, 0xffff0000, v80
v_fmac_f32 v10, v32, v12
v_fmac_f32 v11, v33, v13
v_cvt_pk_bf16_f32 v16, v10, v11
v_lshlrev_b32 v10, 16, v65
v_and_b32 v11, 0xffff0000, v65
v_lshlrev_b32 v12, 16, v81
v_and_b32 v13, 0xffff0000, v81
v_fmac_f32 v10, v34, v12
v_fmac_f32 v11, v35, v13
v_cvt_pk_bf16_f32 v17, v10, v11
v_lshlrev_b32 v10, 16, v66
v_and_b32 v11, 0xffff0000, v66
v_lshlrev_b32 v12, 16, v82
v_and_b32 v13, 0xffff0000, v82
v_fmac_f32 v10, v36, v12
v_fmac_f32 v11, v37, v13
v_cvt_pk_bf16_f32 v18, v10, v11
v_lshlrev_b32 v10, 16, v67
v_and_b32 v11, 0xffff0000, v67
v_lshlrev_b32 v12, 16, v83
v_and_b32 v13, 0xffff0000, v83
v_fmac_f32 v10, v38, v12
v_fmac_f32 v11, v39, v13
v_cvt_pk_bf16_f32 v19, v10, v11
buffer_store_dwordx4 v[16:19], v7, s[4:7], s41 offen offset:0 sc1
v_lshlrev_b32 v10, 16, v68
v_and_b32 v11, 0xffff0000, v68
v_lshlrev_b32 v12, 16, v84
v_and_b32 v13, 0xffff0000, v84
v_fmac_f32 v10, v40, v12
v_fmac_f32 v11, v41, v13
v_cvt_pk_bf16_f32 v20, v10, v11
v_lshlrev_b32 v10, 16, v69
v_and_b32 v11, 0xffff0000, v69
v_lshlrev_b32 v12, 16, v85
v_and_b32 v13, 0xffff0000, v85
v_fmac_f32 v10, v42, v12
v_fmac_f32 v11, v43, v13
v_cvt_pk_bf16_f32 v21, v10, v11
v_lshlrev_b32 v10, 16, v70
v_and_b32 v11, 0xffff0000, v70
v_lshlrev_b32 v12, 16, v86
v_and_b32 v13, 0xffff0000, v86
v_fmac_f32 v10, v44, v12
v_fmac_f32 v11, v45, v13
v_cvt_pk_bf16_f32 v22, v10, v11
v_lshlrev_b32 v10, 16, v71
v_and_b32 v11, 0xffff0000, v71
v_lshlrev_b32 v12, 16, v87
v_and_b32 v13, 0xffff0000, v87
v_fmac_f32 v10, v46, v12
v_fmac_f32 v11, v47, v13
v_cvt_pk_bf16_f32 v23, v10, v11
buffer_store_dwordx4 v[20:23], v7, s[4:7], s41 offen offset:1024 sc1
v_lshlrev_b32 v10, 16, v72
v_and_b32 v11, 0xffff0000, v72
v_lshlrev_b32 v12, 16, v88
v_and_b32 v13, 0xffff0000, v88
v_fmac_f32 v10, v48, v12
v_fmac_f32 v11, v49, v13
v_cvt_pk_bf16_f32 v24, v10, v11
v_lshlrev_b32 v10, 16, v73
v_and_b32 v11, 0xffff0000, v73
v_lshlrev_b32 v12, 16, v89
v_and_b32 v13, 0xffff0000, v89
v_fmac_f32 v10, v50, v12
v_fmac_f32 v11, v51, v13
v_cvt_pk_bf16_f32 v25, v10, v11
v_lshlrev_b32 v10, 16, v74
v_and_b32 v11, 0xffff0000, v74
v_lshlrev_b32 v12, 16, v90
v_and_b32 v13, 0xffff0000, v90
v_fmac_f32 v10, v52, v12
v_fmac_f32 v11, v53, v13
v_cvt_pk_bf16_f32 v26, v10, v11
v_lshlrev_b32 v10, 16, v75
v_and_b32 v11, 0xffff0000, v75
v_lshlrev_b32 v12, 16, v91
v_and_b32 v13, 0xffff0000, v91
v_fmac_f32 v10, v54, v12
v_fmac_f32 v11, v55, v13
v_cvt_pk_bf16_f32 v27, v10, v11
buffer_store_dwordx4 v[24:27], v7, s[4:7], s41 offen offset:2048 sc1
v_lshlrev_b32 v10, 16, v76
v_and_b32 v11, 0xffff0000, v76
v_lshlrev_b32 v12, 16, v92
v_and_b32 v13, 0xffff0000, v92
v_fmac_f32 v10, v56, v12
v_fmac_f32 v11, v57, v13
v_cvt_pk_bf16_f32 v28, v10, v11
v_lshlrev_b32 v10, 16, v77
v_and_b32 v11, 0xffff0000, v77
v_lshlrev_b32 v12, 16, v93
v_and_b32 v13, 0xffff0000, v93
v_fmac_f32 v10, v58, v12
v_fmac_f32 v11, v59, v13
v_cvt_pk_bf16_f32 v29, v10, v11
v_lshlrev_b32 v10, 16, v78
v_and_b32 v11, 0xffff0000, v78
v_lshlrev_b32 v12, 16, v94
v_and_b32 v13, 0xffff0000, v94
v_fmac_f32 v10, v60, v12
v_fmac_f32 v11, v61, v13
v_cvt_pk_bf16_f32 v30, v10, v11
v_lshlrev_b32 v10, 16, v79
v_and_b32 v11, 0xffff0000, v79
v_lshlrev_b32 v12, 16, v95
v_and_b32 v13, 0xffff0000, v95
v_fmac_f32 v10, v62, v12
v_fmac_f32 v11, v63, v13
v_cvt_pk_bf16_f32 v31, v10, v11
buffer_store_dwordx4 v[28:31], v7, s[4:7], s41 offen offset:3072 sc1
s_waitcnt vmcnt(0)
s_barrier
s_cmp_lg_u32 s33, 0
s_cbranch_scc1 L_lf11
s_lshl_b32 s40, s101, 2
s_add_u32 s40, s40, 51404800
v_mov_b32 v9, 1
buffer_store_dword v9, off, s[4:7], s40 sc1
L_lf11:
s_branch L_postrole
L_notln:
s_cmp_lg_u32 s70, 4
s_cbranch_scc1 L_postrole
s_cmp_lg_u32 s33, 0
s_cbranch_scc1 L_mt12
v_lshlrev_b32 v6, 1, v0
s_lshl_b32 s41, s101, 7
s_add_u32 s41, s41, 50331648
buffer_store_short v16, v6, s[4:7], s41 offen sc1
s_waitcnt vmcnt(0)
s_cmp_lt_u32 s101, 16
s_cselect_b32 s41, 0, 4
s_mov_b64 exec, 1
v_mov_b32 v6, 1
buffer_atomic_add v6, off, s[28:31], s41
s_mov_b64 exec, -1
L_mt12:
s_cmp_ge_u32 s101, 16
s_cbranch_scc1 L_postrole
s_add_u32 s101, s101, 32
s_load_dwordx2 s[8:9], s[0:1], 96
s_mov_b32 s10, 1024
s_mov_b32 s11, 0x20000
s_load_dwordx2 s[12:13], s[0:1], 104
s_mov_b32 s14, 3145728
s_mov_b32 s15, 0x20000
s_waitcnt lgkmcnt(0)
v_lshlrev_b32 v1, 2, v0
buffer_load_dword v2, v1, s[8:11], 0 offen
v_lshrrev_b32 v3, 3, v0
v_mul_u32_u24 v3, 6144, v3
v_and_b32 v4, 7, v0
v_lshl_add_u32 v3, v4, 4, v3
s_lshl_b32 s41, s101, 7
buffer_load_dwordx4 v[32:35], v3, s[12:15], s41 offen
s_add_u32 s41, s41, 196608
buffer_load_dwordx4 v[36:39], v3, s[12:15], s41 offen
s_add_u32 s41, s41, 196608
buffer_load_dwordx4 v[40:43], v3, s[12:15], s41 offen
s_add_u32 s41, s41, 196608
buffer_load_dwordx4 v[44:47], v3, s[12:15], s41 offen
s_add_u32 s41, s41, 196608
buffer_load_dwordx4 v[48:51], v3, s[12:15], s41 offen
s_add_u32 s41, s41, 196608
buffer_load_dwordx4 v[52:55], v3, s[12:15], s41 offen
s_add_u32 s41, s41, 196608
buffer_load_dwordx4 v[56:59], v3, s[12:15], s41 offen
s_add_u32 s41, s41, 196608
buffer_load_dwordx4 v[60:63], v3, s[12:15], s41 offen
s_add_u32 s41, s41, 196608
buffer_load_dwordx4 v[64:67], v3, s[12:15], s41 offen
s_add_u32 s41, s41, 196608
buffer_load_dwordx4 v[68:71], v3, s[12:15], s41 offen
s_add_u32 s41, s41, 196608
buffer_load_dwordx4 v[72:75], v3, s[12:15], s41 offen
s_add_u32 s41, s41, 196608
buffer_load_dwordx4 v[76:79], v3, s[12:15], s41 offen
s_add_u32 s41, s41, 196608
buffer_load_dwordx4 v[80:83], v3, s[12:15], s41 offen
s_add_u32 s41, s41, 196608
buffer_load_dwordx4 v[84:87], v3, s[12:15], s41 offen
s_add_u32 s41, s41, 196608
buffer_load_dwordx4 v[88:91], v3, s[12:15], s41 offen
s_add_u32 s41, s41, 196608
buffer_load_dwordx4 v[92:95], v3, s[12:15], s41 offen
s_waitcnt vmcnt(16)
v_lshlrev_b32 v4, 16, v2
v_and_b32 v5, 0xffff0000, v2
v_mul_f32 v6, 0xbfb8aa3b, v4
v_exp_f32 v6, v6
s_nop 0
v_add_f32 v6, 1.0, v6
v_rcp_f32 v6, v6
s_nop 0
v_mul_f32 v4, v4, v6
v_mul_f32 v7, 0xbfb8aa3b, v5
v_exp_f32 v7, v7
s_nop 0
v_add_f32 v7, 1.0, v7
v_rcp_f32 v7, v7
s_nop 0
v_mul_f32 v5, v5, v7
v_cvt_pk_bf16_f32 v2, v4, v5
v_lshlrev_b32 v4, 16, v2
v_and_b32 v5, 0xffff0000, v2
v_lshlrev_b32 v6, 3, v0
ds_write_b64 v6, v[4:5]
s_waitcnt lgkmcnt(0)
s_barrier
v_lshrrev_b32 v6, 3, v0
v_lshlrev_b32 v6, 2, v6
ds_read_b32 v16, v6 offset:0
ds_read_b32 v17, v6 offset:128
ds_read_b32 v18, v6 offset:256
ds_read_b32 v19, v6 offset:384
ds_read_b32 v20, v6 offset:512
ds_read_b32 v21, v6 offset:640
ds_read_b32 v22, v6 offset:768
ds_read_b32 v23, v6 offset:896
ds_read_b32 v24, v6 offset:1024
ds_read_b32 v25, v6 offset:1152
ds_read_b32 v26, v6 offset:1280
ds_read_b32 v27, v6 offset:1408
ds_read_b32 v28, v6 offset:1536
ds_read_b32 v29, v6 offset:1664
ds_read_b32 v30, v6 offset:1792
ds_read_b32 v31, v6 offset:1920
v_mov_b32 v8, 0
v_mov_b32 v9, 0
v_mov_b32 v10, 0
v_mov_b32 v11, 0
v_mov_b32 v12, 0
v_mov_b32 v13, 0
v_mov_b32 v14, 0
v_mov_b32 v15, 0
s_waitcnt lgkmcnt(0)
s_waitcnt vmcnt(15)
v_lshlrev_b32 v4, 16, v32
v_and_b32 v5, 0xffff0000, v32
v_fmac_f32 v8, v4, v16
v_fmac_f32 v9, v5, v16
v_lshlrev_b32 v4, 16, v33
v_and_b32 v5, 0xffff0000, v33
v_fmac_f32 v10, v4, v16
v_fmac_f32 v11, v5, v16
v_lshlrev_b32 v4, 16, v34
v_and_b32 v5, 0xffff0000, v34
v_fmac_f32 v12, v4, v16
v_fmac_f32 v13, v5, v16
v_lshlrev_b32 v4, 16, v35
v_and_b32 v5, 0xffff0000, v35
v_fmac_f32 v14, v4, v16
v_fmac_f32 v15, v5, v16
s_waitcnt vmcnt(14)
v_lshlrev_b32 v4, 16, v36
v_and_b32 v5, 0xffff0000, v36
v_fmac_f32 v8, v4, v17
v_fmac_f32 v9, v5, v17
v_lshlrev_b32 v4, 16, v37
v_and_b32 v5, 0xffff0000, v37
v_fmac_f32 v10, v4, v17
v_fmac_f32 v11, v5, v17
v_lshlrev_b32 v4, 16, v38
v_and_b32 v5, 0xffff0000, v38
v_fmac_f32 v12, v4, v17
v_fmac_f32 v13, v5, v17
v_lshlrev_b32 v4, 16, v39
v_and_b32 v5, 0xffff0000, v39
v_fmac_f32 v14, v4, v17
v_fmac_f32 v15, v5, v17
s_waitcnt vmcnt(13)
v_lshlrev_b32 v4, 16, v40
v_and_b32 v5, 0xffff0000, v40
v_fmac_f32 v8, v4, v18
v_fmac_f32 v9, v5, v18
v_lshlrev_b32 v4, 16, v41
v_and_b32 v5, 0xffff0000, v41
v_fmac_f32 v10, v4, v18
v_fmac_f32 v11, v5, v18
v_lshlrev_b32 v4, 16, v42
v_and_b32 v5, 0xffff0000, v42
v_fmac_f32 v12, v4, v18
v_fmac_f32 v13, v5, v18
v_lshlrev_b32 v4, 16, v43
v_and_b32 v5, 0xffff0000, v43
v_fmac_f32 v14, v4, v18
v_fmac_f32 v15, v5, v18
s_waitcnt vmcnt(12)
v_lshlrev_b32 v4, 16, v44
v_and_b32 v5, 0xffff0000, v44
v_fmac_f32 v8, v4, v19
v_fmac_f32 v9, v5, v19
v_lshlrev_b32 v4, 16, v45
v_and_b32 v5, 0xffff0000, v45
v_fmac_f32 v10, v4, v19
v_fmac_f32 v11, v5, v19
v_lshlrev_b32 v4, 16, v46
v_and_b32 v5, 0xffff0000, v46
v_fmac_f32 v12, v4, v19
v_fmac_f32 v13, v5, v19
v_lshlrev_b32 v4, 16, v47
v_and_b32 v5, 0xffff0000, v47
v_fmac_f32 v14, v4, v19
v_fmac_f32 v15, v5, v19
s_waitcnt vmcnt(11)
v_lshlrev_b32 v4, 16, v48
v_and_b32 v5, 0xffff0000, v48
v_fmac_f32 v8, v4, v20
v_fmac_f32 v9, v5, v20
v_lshlrev_b32 v4, 16, v49
v_and_b32 v5, 0xffff0000, v49
v_fmac_f32 v10, v4, v20
v_fmac_f32 v11, v5, v20
v_lshlrev_b32 v4, 16, v50
v_and_b32 v5, 0xffff0000, v50
v_fmac_f32 v12, v4, v20
v_fmac_f32 v13, v5, v20
v_lshlrev_b32 v4, 16, v51
v_and_b32 v5, 0xffff0000, v51
v_fmac_f32 v14, v4, v20
v_fmac_f32 v15, v5, v20
s_waitcnt vmcnt(10)
v_lshlrev_b32 v4, 16, v52
v_and_b32 v5, 0xffff0000, v52
v_fmac_f32 v8, v4, v21
v_fmac_f32 v9, v5, v21
v_lshlrev_b32 v4, 16, v53
v_and_b32 v5, 0xffff0000, v53
v_fmac_f32 v10, v4, v21
v_fmac_f32 v11, v5, v21
v_lshlrev_b32 v4, 16, v54
v_and_b32 v5, 0xffff0000, v54
v_fmac_f32 v12, v4, v21
v_fmac_f32 v13, v5, v21
v_lshlrev_b32 v4, 16, v55
v_and_b32 v5, 0xffff0000, v55
v_fmac_f32 v14, v4, v21
v_fmac_f32 v15, v5, v21
s_waitcnt vmcnt(9)
v_lshlrev_b32 v4, 16, v56
v_and_b32 v5, 0xffff0000, v56
v_fmac_f32 v8, v4, v22
v_fmac_f32 v9, v5, v22
v_lshlrev_b32 v4, 16, v57
v_and_b32 v5, 0xffff0000, v57
v_fmac_f32 v10, v4, v22
v_fmac_f32 v11, v5, v22
v_lshlrev_b32 v4, 16, v58
v_and_b32 v5, 0xffff0000, v58
v_fmac_f32 v12, v4, v22
v_fmac_f32 v13, v5, v22
v_lshlrev_b32 v4, 16, v59
v_and_b32 v5, 0xffff0000, v59
v_fmac_f32 v14, v4, v22
v_fmac_f32 v15, v5, v22
s_waitcnt vmcnt(8)
v_lshlrev_b32 v4, 16, v60
v_and_b32 v5, 0xffff0000, v60
v_fmac_f32 v8, v4, v23
v_fmac_f32 v9, v5, v23
v_lshlrev_b32 v4, 16, v61
v_and_b32 v5, 0xffff0000, v61
v_fmac_f32 v10, v4, v23
v_fmac_f32 v11, v5, v23
v_lshlrev_b32 v4, 16, v62
v_and_b32 v5, 0xffff0000, v62
v_fmac_f32 v12, v4, v23
v_fmac_f32 v13, v5, v23
v_lshlrev_b32 v4, 16, v63
v_and_b32 v5, 0xffff0000, v63
v_fmac_f32 v14, v4, v23
v_fmac_f32 v15, v5, v23
s_waitcnt vmcnt(7)
v_lshlrev_b32 v4, 16, v64
v_and_b32 v5, 0xffff0000, v64
v_fmac_f32 v8, v4, v24
v_fmac_f32 v9, v5, v24
v_lshlrev_b32 v4, 16, v65
v_and_b32 v5, 0xffff0000, v65
v_fmac_f32 v10, v4, v24
v_fmac_f32 v11, v5, v24
v_lshlrev_b32 v4, 16, v66
v_and_b32 v5, 0xffff0000, v66
v_fmac_f32 v12, v4, v24
v_fmac_f32 v13, v5, v24
v_lshlrev_b32 v4, 16, v67
v_and_b32 v5, 0xffff0000, v67
v_fmac_f32 v14, v4, v24
v_fmac_f32 v15, v5, v24
s_waitcnt vmcnt(6)
v_lshlrev_b32 v4, 16, v68
v_and_b32 v5, 0xffff0000, v68
v_fmac_f32 v8, v4, v25
v_fmac_f32 v9, v5, v25
v_lshlrev_b32 v4, 16, v69
v_and_b32 v5, 0xffff0000, v69
v_fmac_f32 v10, v4, v25
v_fmac_f32 v11, v5, v25
v_lshlrev_b32 v4, 16, v70
v_and_b32 v5, 0xffff0000, v70
v_fmac_f32 v12, v4, v25
v_fmac_f32 v13, v5, v25
v_lshlrev_b32 v4, 16, v71
v_and_b32 v5, 0xffff0000, v71
v_fmac_f32 v14, v4, v25
v_fmac_f32 v15, v5, v25
s_waitcnt vmcnt(5)
v_lshlrev_b32 v4, 16, v72
v_and_b32 v5, 0xffff0000, v72
v_fmac_f32 v8, v4, v26
v_fmac_f32 v9, v5, v26
v_lshlrev_b32 v4, 16, v73
v_and_b32 v5, 0xffff0000, v73
v_fmac_f32 v10, v4, v26
v_fmac_f32 v11, v5, v26
v_lshlrev_b32 v4, 16, v74
v_and_b32 v5, 0xffff0000, v74
v_fmac_f32 v12, v4, v26
v_fmac_f32 v13, v5, v26
v_lshlrev_b32 v4, 16, v75
v_and_b32 v5, 0xffff0000, v75
v_fmac_f32 v14, v4, v26
v_fmac_f32 v15, v5, v26
s_waitcnt vmcnt(4)
v_lshlrev_b32 v4, 16, v76
v_and_b32 v5, 0xffff0000, v76
v_fmac_f32 v8, v4, v27
v_fmac_f32 v9, v5, v27
v_lshlrev_b32 v4, 16, v77
v_and_b32 v5, 0xffff0000, v77
v_fmac_f32 v10, v4, v27
v_fmac_f32 v11, v5, v27
v_lshlrev_b32 v4, 16, v78
v_and_b32 v5, 0xffff0000, v78
v_fmac_f32 v12, v4, v27
v_fmac_f32 v13, v5, v27
v_lshlrev_b32 v4, 16, v79
v_and_b32 v5, 0xffff0000, v79
v_fmac_f32 v14, v4, v27
v_fmac_f32 v15, v5, v27
s_waitcnt vmcnt(3)
v_lshlrev_b32 v4, 16, v80
v_and_b32 v5, 0xffff0000, v80
v_fmac_f32 v8, v4, v28
v_fmac_f32 v9, v5, v28
v_lshlrev_b32 v4, 16, v81
v_and_b32 v5, 0xffff0000, v81
v_fmac_f32 v10, v4, v28
v_fmac_f32 v11, v5, v28
v_lshlrev_b32 v4, 16, v82
v_and_b32 v5, 0xffff0000, v82
v_fmac_f32 v12, v4, v28
v_fmac_f32 v13, v5, v28
v_lshlrev_b32 v4, 16, v83
v_and_b32 v5, 0xffff0000, v83
v_fmac_f32 v14, v4, v28
v_fmac_f32 v15, v5, v28
s_waitcnt vmcnt(2)
v_lshlrev_b32 v4, 16, v84
v_and_b32 v5, 0xffff0000, v84
v_fmac_f32 v8, v4, v29
v_fmac_f32 v9, v5, v29
v_lshlrev_b32 v4, 16, v85
v_and_b32 v5, 0xffff0000, v85
v_fmac_f32 v10, v4, v29
v_fmac_f32 v11, v5, v29
v_lshlrev_b32 v4, 16, v86
v_and_b32 v5, 0xffff0000, v86
v_fmac_f32 v12, v4, v29
v_fmac_f32 v13, v5, v29
v_lshlrev_b32 v4, 16, v87
v_and_b32 v5, 0xffff0000, v87
v_fmac_f32 v14, v4, v29
v_fmac_f32 v15, v5, v29
s_waitcnt vmcnt(1)
v_lshlrev_b32 v4, 16, v88
v_and_b32 v5, 0xffff0000, v88
v_fmac_f32 v8, v4, v30
v_fmac_f32 v9, v5, v30
v_lshlrev_b32 v4, 16, v89
v_and_b32 v5, 0xffff0000, v89
v_fmac_f32 v10, v4, v30
v_fmac_f32 v11, v5, v30
v_lshlrev_b32 v4, 16, v90
v_and_b32 v5, 0xffff0000, v90
v_fmac_f32 v12, v4, v30
v_fmac_f32 v13, v5, v30
v_lshlrev_b32 v4, 16, v91
v_and_b32 v5, 0xffff0000, v91
v_fmac_f32 v14, v4, v30
v_fmac_f32 v15, v5, v30
s_waitcnt vmcnt(0)
v_lshlrev_b32 v4, 16, v92
v_and_b32 v5, 0xffff0000, v92
v_fmac_f32 v8, v4, v31
v_fmac_f32 v9, v5, v31
v_lshlrev_b32 v4, 16, v93
v_and_b32 v5, 0xffff0000, v93
v_fmac_f32 v10, v4, v31
v_fmac_f32 v11, v5, v31
v_lshlrev_b32 v4, 16, v94
v_and_b32 v5, 0xffff0000, v94
v_fmac_f32 v12, v4, v31
v_fmac_f32 v13, v5, v31
v_lshlrev_b32 v4, 16, v95
v_and_b32 v5, 0xffff0000, v95
v_fmac_f32 v14, v4, v31
v_fmac_f32 v15, v5, v31
v_lshlrev_b32 v6, 5, v0
ds_write_b128 v6, v[8:11] offset:4096
ds_write_b128 v6, v[12:15] offset:4112
s_waitcnt lgkmcnt(0)
s_barrier
s_cmp_lg_u32 s33, 0
s_cbranch_scc1 L_mt13
ds_read_b32 v16, v1 offset:4096
ds_read_b32 v17, v1 offset:4352
ds_read_b32 v18, v1 offset:4608
ds_read_b32 v19, v1 offset:4864
ds_read_b32 v20, v1 offset:5120
ds_read_b32 v21, v1 offset:5376
ds_read_b32 v22, v1 offset:5632
ds_read_b32 v23, v1 offset:5888
s_waitcnt lgkmcnt(0)
ds_read_b32 v24, v1 offset:6144
ds_read_b32 v25, v1 offset:6400
ds_read_b32 v26, v1 offset:6656
ds_read_b32 v27, v1 offset:6912
ds_read_b32 v28, v1 offset:7168
ds_read_b32 v29, v1 offset:7424
ds_read_b32 v30, v1 offset:7680
ds_read_b32 v31, v1 offset:7936
s_waitcnt lgkmcnt(0)
ds_read_b32 v32, v1 offset:8192
ds_read_b32 v33, v1 offset:8448
ds_read_b32 v34, v1 offset:8704
ds_read_b32 v35, v1 offset:8960
ds_read_b32 v36, v1 offset:9216
ds_read_b32 v37, v1 offset:9472
ds_read_b32 v38, v1 offset:9728
ds_read_b32 v39, v1 offset:9984
s_waitcnt lgkmcnt(0)
ds_read_b32 v40, v1 offset:10240
ds_read_b32 v41, v1 offset:10496
ds_read_b32 v42, v1 offset:10752
ds_read_b32 v43, v1 offset:11008
ds_read_b32 v44, v1 offset:11264
ds_read_b32 v45, v1 offset:11520
ds_read_b32 v46, v1 offset:11776
ds_read_b32 v47, v1 offset:12032
s_waitcnt lgkmcnt(0)
v_add_f32 v16, v16, v17
v_add_f32 v16, v16, v18
v_add_f32 v16, v16, v19
v_add_f32 v16, v16, v20
v_add_f32 v16, v16, v21
v_add_f32 v16, v16, v22
v_add_f32 v16, v16, v23
v_add_f32 v16, v16, v24
v_add_f32 v16, v16, v25
v_add_f32 v16, v16, v26
v_add_f32 v16, v16, v27
v_add_f32 v16, v16, v28
v_add_f32 v16, v16, v29
v_add_f32 v16, v16, v30
v_add_f32 v16, v16, v31
v_add_f32 v16, v16, v32
v_add_f32 v16, v16, v33
v_add_f32 v16, v16, v34
v_add_f32 v16, v16, v35
v_add_f32 v16, v16, v36
v_add_f32 v16, v16, v37
v_add_f32 v16, v16, v38
v_add_f32 v16, v16, v39
v_add_f32 v16, v16, v40
v_add_f32 v16, v16, v41
v_add_f32 v16, v16, v42
v_add_f32 v16, v16, v43
v_add_f32 v16, v16, v44
v_add_f32 v16, v16, v45
v_add_f32 v16, v16, v46
v_add_f32 v16, v16, v47
v_cvt_pk_bf16_f32 v16, v16, v16
s_lshr_b32 s41, s101, 3
s_cmp_eq_u32 s41, 1
s_cselect_b32 s42, 1.0, 0
s_cmp_eq_u32 s41, 4
s_cselect_b32 s42, 1.0, s42
v_lshlrev_b32 v16, 16, v16
v_add_f32 v16, s42, v16
v_cvt_pk_bf16_f32 v16, v16, v16
L_mt13:
s_barrier
s_cmp_lg_u32 s33, 0
s_cbranch_scc1 L_mt14
v_lshlrev_b32 v6, 1, v0
s_lshl_b32 s41, s101, 7
s_add_u32 s41, s41, 50331648
buffer_store_short v16, v6, s[4:7], s41 offen sc1
s_waitcnt vmcnt(0)
s_cmp_lt_u32 s101, 16
s_cselect_b32 s41, 0, 4
s_mov_b64 exec, 1
v_mov_b32 v6, 1
buffer_atomic_add v6, off, s[28:31], s41
s_mov_b64 exec, -1
L_mt14:
L_postrole:
s_mov_b32 s70, 0
s_waitcnt vmcnt(0)
s_barrier
s_load_dwordx2 s[8:9], s[0:1], 16
s_mov_b32 s10, 4194304
s_mov_b32 s11, 0x20000
s_load_dwordx2 s[12:13], s[0:1], 40
s_mov_b32 s14, 4194304
s_mov_b32 s15, 0x20000
s_load_dwordx2 s[16:17], s[0:1], 64
s_mov_b32 s18, 1835008
s_mov_b32 s19, 0x20000
s_load_dwordx2 s[20:21], s[0:1], 80
s_mov_b32 s22, 1835008
s_mov_b32 s23, 0x20000
s_load_dwordx2 s[24:25], s[0:1], 0
s_mov_b32 s26, 2097152
s_mov_b32 s27, 0x20000
s_load_dwordx2 s[60:61], s[0:1], 112
s_mov_b32 s62, 2097152
s_mov_b32 s63, 0x20000
v_and_b32 v100, 63, v0
v_and_b32 v101, 15, v0
v_lshrrev_b32 v102, 4, v100
v_lshrrev_b32 v103, 2, v101
v_and_b32 v104, 3, v0
v_lshlrev_b32 v1, 4, v100
v_add_u32 v2, 0x10000, v1
v_lshlrev_b32 v108, 13, v102
v_lshl_add_u32 v108, v101, 4, v108
v_lshrrev_b32 v105, 3, v100
v_mul_u32_u24 v105, 3584, v105
v_and_b32 v106, 7, v100
v_lshl_add_u32 v109, v106, 4, v105
v_lshl_add_u32 v105, v102, 3, v103
v_lshlrev_b32 v105, 8, v105
v_lshl_add_u32 v105, v104, 4, v105
s_lshl_b32 s40, s33, 6
v_add_u32 v110, s40, v105
v_add_u32 v111, 0x10000, v110
v_lshl_add_u32 v105, v102, 2, v103
v_lshlrev_b32 v105, 10, v105
v_lshl_add_u32 v105, v104, 4, v105
s_lshl_b32 s40, s33, 8
v_add_u32 v112, s40, v105
v_add_u32 v113, 0x10000, v112
v_lshl_add_u32 v105, v102, 3, v103
v_lshlrev_b32 v105, 7, v105
v_lshl_add_u32 v105, v104, 3, v105
s_lshl_b32 s40, s33, 5
v_add_u32 v114, s40, v105
v_add_u32 v115, 0x10000, v114
v_mul_u32_u24 v105, 32768, v101
v_lshl_add_u32 v3, v102, 4, v105
v_lshlrev_b32 v105, 10, v102
v_lshl_add_u32 v4, v101, 4, v105
v_lshlrev_b32 v105, 10, v103
v_lshl_add_u32 v105, v104, 8, v105
v_lshl_add_u32 v5, v102, 3, v105
v_lshlrev_b32 v105, 4, v101
v_lshl_add_u32 v6, v102, 3, v105
s_lshr_b32 s40, s33, 1
s_lshl_b32 s41, s40, 10
s_and_b32 s42, s33, 1
s_lshl_b32 s43, s42, 3
s_add_u32 s41, s41, s43
s_add_u32 s41, s41, 106496
v_add_u32 v7, s41, v1
s_lshl_b32 s43, s42, 12
v_add_u32 v8, s43, v1
s_lshl_b32 s44, s40, 12
v_add_u32 v9, s44, v1
v_lshrrev_b32 v105, 1, v1
s_lshl_b32 s44, s40, 10
v_add_u32 v10, s44, v105
s_lshl_b32 s44, s40, 11
s_add_u32 s44, s44, s43
v_add_u32 v11, s44, v2
s_lshl_b32 s43, s42, 4
v_lshlrev_b32 v105, 2, v102
v_sub_u32 v105, v101, v105
v_add_u32 v105, s43, v105
v_mov_b32 v106, 0xf149f2ca
v_cmp_gt_i32 vcc, 0, v105
s_nop 1
v_cndmask_b32 v44, 0, v106, vcc
v_cmp_gt_i32 vcc, 1, v105
s_nop 1
v_cndmask_b32 v45, 0, v106, vcc
v_cmp_gt_i32 vcc, 2, v105
s_nop 1
v_cndmask_b32 v46, 0, v106, vcc
v_cmp_gt_i32 vcc, 3, v105
s_nop 1
v_cndmask_b32 v47, 0, v106, vcc
v_cmp_gt_i32 vcc, 16, v105
s_nop 1
v_cndmask_b32 v48, 0, v106, vcc
v_cmp_gt_i32 vcc, 17, v105
s_nop 1
v_cndmask_b32 v49, 0, v106, vcc
v_cmp_gt_i32 vcc, 18, v105
s_nop 1
v_cndmask_b32 v50, 0, v106, vcc
v_cmp_gt_i32 vcc, 19, v105
s_nop 1
v_cndmask_b32 v51, 0, v106, vcc
v_mov_b32 v40, 0x3f803f80
v_mov_b32 v41, 0x3f803f80
v_mov_b32 v42, 0x3f803f80
v_mov_b32 v43, 0x3f803f80
v_mov_b32 v52, 0
v_mov_b32 v53, 0
v_mov_b32 v54, 0
v_mov_b32 v55, 0
v_mov_b32 v105, 0x3f80
v_mov_b32 v106, 0x3f800000
v_mov_b32 v36, 0
v_cmp_eq_u32 vcc, 0, v101
s_nop 1
v_cndmask_b32 v36, v36, v105, vcc
v_cmp_eq_u32 vcc, 1, v101
s_nop 1
v_cndmask_b32 v36, v36, v106, vcc
v_mov_b32 v37, 0
v_cmp_eq_u32 vcc, 2, v101
s_nop 1
v_cndmask_b32 v37, v37, v105, vcc
v_cmp_eq_u32 vcc, 3, v101
s_nop 1
v_cndmask_b32 v37, v37, v106, vcc
v_mov_b32 v38, 0
v_cmp_eq_u32 vcc, 4, v101
s_nop 1
v_cndmask_b32 v38, v38, v105, vcc
v_cmp_eq_u32 vcc, 5, v101
s_nop 1
v_cndmask_b32 v38, v38, v106, vcc
v_mov_b32 v39, 0
v_cmp_eq_u32 vcc, 6, v101
s_nop 1
v_cndmask_b32 v39, v39, v105, vcc
v_cmp_eq_u32 vcc, 7, v101
s_nop 1
v_cndmask_b32 v39, v39, v106, vcc
s_mov_b32 s38, -1
s_mov_b32 s39, 0
s_mov_b32 s46, 0x3e0293ee
s_sub_u32 s35, s58, 3
s_add_u32 s73, s58, 64
s_cmp_le_u32 s58, 2
s_cselect_b32 s35, s73, s35
s_lshl_b32 s36, s58, 22
s_add_u32 s36, s36, 67108864
s_mul_i32 s40, s32, 32768
s_lshl_b32 s41, s33, 8
s_add_u32 s47, s40, s41
s_add_u32 s47, s47, s36
s_add_u32 s48, s47, 1310720
s_lshl_b32 s40, s32, 10
s_add_u32 s50, s40, s41
s_add_u32 s50, s50, s36
s_lshr_b32 s40, s32, 4
s_lshl_b32 s40, s40, 14
s_lshl_b32 s41, s33, 12
s_add_u32 s49, s40, s41
s_and_b32 s40, s32, 15
s_lshl_b32 s40, s40, 4
s_add_u32 s49, s49, s40
s_add_u32 s49, s49, s36
s_add_u32 s49, s49, 2621440
s_waitcnt lgkmcnt(0)
s_cmp_lg_u32 s59, 0
s_cbranch_scc1 L_pi_s
s_add_u32 s76, s36, 3145728
s_lshl_b32 s41, s32, 7
s_add_u32 s41, s41, s76
buffer_store_dword v52, off, s[4:7], s41
s_add_u32 s41, s41, 4096
buffer_store_dword v52, off, s[4:7], s41
s_add_u32 s41, s41, 4096
buffer_store_dword v52, off, s[4:7], s41
s_add_u32 s41, s41, 4096
s_waitcnt vmcnt(0)
s_barrier
s_lshl_b32 s41, s58, 2
s_cmp_lg_u32 s33, 0
s_cbranch_scc1 L_da15
s_mov_b64 exec, 1
v_mov_b32 v62, 1
buffer_atomic_add v62, off, s[28:31], s41 offset:64
s_mov_b64 exec, -1
L_da15:
s_branch L_pi_d
L_pi_s:
s_add_u32 s76, s36, 3145728
s_lshl_b32 s41, s32, 7
s_add_u32 s41, s41, s76
buffer_store_dword v52, off, s[4:7], s41 sc1
s_add_u32 s41, s41, 4096
buffer_store_dword v52, off, s[4:7], s41 sc1
s_add_u32 s41, s41, 4096
buffer_store_dword v52, off, s[4:7], s41 sc1
s_add_u32 s41, s41, 4096
s_waitcnt vmcnt(0)
s_barrier
s_lshl_b32 s41, s58, 2
s_cmp_lg_u32 s33, 0
s_cbranch_scc1 L_da16
s_mov_b64 exec, 1
v_mov_b32 v62, 1
buffer_atomic_add v62, off, s[28:31], s41 offset:64
s_mov_b64 exec, -1
L_da16:
L_pi_d:
s_min_u32 s37, s32, 27
s_lshl_b32 s43, s32, 8
s_add_u32 s43, s43, 51380224
s_cmp_lg_u32 s33, 0
s_cbranch_scc1 L_w117
L_wg18:
buffer_load_dword v62, off, s[4:7], s43 offset:8 sc1
s_add_u32 s51, s51, 1
s_cmp_gt_u32 s51, 300000
s_cbranch_scc1 L_end
s_waitcnt vmcnt(0)
v_readfirstlane_b32 s40, v62
s_cmp_ge_u32 s40, 1
s_cbranch_scc1 L_wd18
s_sleep 8
s_branch L_wg18
L_wd18:
L_w117:
s_barrier
s_lshl_b32 s40, s33, 12
s_add_u32 s40, s40, 0
s_mov_b32 m0, s40
s_lshl_b32 s41, s33, 17
s_lshl_b32 s42, s32, 8
s_add_u32 s41, s41, s42
s_add_u32 s41, s41, 0
buffer_load_dwordx4 v108, s[8:11], s41 offen offset:0 lds
s_add_u32 s41, s41, 31744
buffer_load_dwordx4 v108, s[8:11], s41 offen offset:1024 lds
s_add_u32 s41, s41, 31744
buffer_load_dwordx4 v108, s[8:11], s41 offen offset:2048 lds
s_add_u32 s41, s41, 31744
buffer_load_dwordx4 v108, s[8:11], s41 offen offset:3072 lds
s_lshl_b32 s40, s33, 12
s_add_u32 s40, s40, 16384
s_mov_b32 m0, s40
s_lshl_b32 s41, s33, 17
s_lshl_b32 s42, s32, 8
s_add_u32 s41, s41, s42
s_add_u32 s41, s41, 524288
buffer_load_dwordx4 v108, s[8:11], s41 offen offset:0 lds
s_add_u32 s41, s41, 31744
buffer_load_dwordx4 v108, s[8:11], s41 offen offset:1024 lds
s_add_u32 s41, s41, 31744
buffer_load_dwordx4 v108, s[8:11], s41 offen offset:2048 lds
s_add_u32 s41, s41, 31744
buffer_load_dwordx4 v108, s[8:11], s41 offen offset:3072 lds
s_lshl_b32 s40, s33, 12
s_add_u32 s40, s40, 32768
s_mov_b32 m0, s40
s_lshl_b32 s41, s33, 17
s_lshl_b32 s42, s32, 8
s_add_u32 s41, s41, s42
s_add_u32 s41, s41, 1048576
buffer_load_dwordx4 v108, s[8:11], s41 offen offset:0 lds
s_add_u32 s41, s41, 31744
buffer_load_dwordx4 v108, s[8:11], s41 offen offset:1024 lds
s_add_u32 s41, s41, 31744
buffer_load_dwordx4 v108, s[8:11], s41 offen offset:2048 lds
s_add_u32 s41, s41, 31744
buffer_load_dwordx4 v108, s[8:11], s41 offen offset:3072 lds
s_waitcnt vmcnt(8)
s_barrier
s_lshl_b32 s40, s33, 12
s_add_u32 s40, s40, 49152
s_mov_b32 m0, s40
s_lshl_b32 s41, s33, 17
s_lshl_b32 s42, s32, 8
s_add_u32 s41, s41, s42
s_add_u32 s41, s41, 1572864
buffer_load_dwordx4 v108, s[8:11], s41 offen offset:0 lds
s_add_u32 s41, s41, 31744
buffer_load_dwordx4 v108, s[8:11], s41 offen offset:1024 lds
s_add_u32 s41, s41, 31744
buffer_load_dwordx4 v108, s[8:11], s41 offen offset:2048 lds
s_add_u32 s41, s41, 31744
buffer_load_dwordx4 v108, s[8:11], s41 offen offset:3072 lds
ds_read_b64_tr_b16 a[0:1], v110 offset:0
ds_read_b64_tr_b16 a[2:3], v110 offset:1024
ds_read_b64_tr_b16 a[64:65], v110 offset:8
ds_read_b64_tr_b16 a[66:67], v110 offset:1032
ds_read_b64_tr_b16 a[4:5], v110 offset:8192
ds_read_b64_tr_b16 a[6:7], v110 offset:9216
ds_read_b64_tr_b16 a[68:69], v110 offset:8200
ds_read_b64_tr_b16 a[70:71], v110 offset:9224
s_waitcnt lgkmcnt(0)
s_waitcnt vmcnt(8)
s_barrier
s_lshl_b32 s40, s33, 12
s_add_u32 s40, s40, 0
s_mov_b32 m0, s40
s_lshl_b32 s41, s33, 17
s_lshl_b32 s42, s32, 8
s_add_u32 s41, s41, s42
s_add_u32 s41, s41, 2097152
buffer_load_dwordx4 v108, s[8:11], s41 offen offset:0 lds
s_add_u32 s41, s41, 31744
buffer_load_dwordx4 v108, s[8:11], s41 offen offset:1024 lds
s_add_u32 s41, s41, 31744
buffer_load_dwordx4 v108, s[8:11], s41 offen offset:2048 lds
s_add_u32 s41, s41, 31744
buffer_load_dwordx4 v108, s[8:11], s41 offen offset:3072 lds
ds_read_b64_tr_b16 a[8:9], v110 offset:16384
ds_read_b64_tr_b16 a[10:11], v110 offset:17408
ds_read_b64_tr_b16 a[72:73], v110 offset:16392
ds_read_b64_tr_b16 a[74:75], v110 offset:17416
ds_read_b64_tr_b16 a[12:13], v110 offset:24576
ds_read_b64_tr_b16 a[14:15], v110 offset:25600
ds_read_b64_tr_b16 a[76:77], v110 offset:24584
ds_read_b64_tr_b16 a[78:79], v110 offset:25608
s_waitcnt lgkmcnt(0)
s_waitcnt vmcnt(8)
s_barrier
s_lshl_b32 s40, s33, 12
s_add_u32 s40, s40, 16384
s_mov_b32 m0, s40
s_lshl_b32 s41, s33, 17
s_lshl_b32 s42, s32, 8
s_add_u32 s41, s41, s42
s_add_u32 s41, s41, 2621440
buffer_load_dwordx4 v108, s[8:11], s41 offen offset:0 lds
s_add_u32 s41, s41, 31744
buffer_load_dwordx4 v108, s[8:11], s41 offen offset:1024 lds
s_add_u32 s41, s41, 31744
buffer_load_dwordx4 v108, s[8:11], s41 offen offset:2048 lds
s_add_u32 s41, s41, 31744
buffer_load_dwordx4 v108, s[8:11], s41 offen offset:3072 lds
ds_read_b64_tr_b16 a[16:17], v110 offset:32768
ds_read_b64_tr_b16 a[18:19], v110 offset:33792
ds_read_b64_tr_b16 a[80:81], v110 offset:32776
ds_read_b64_tr_b16 a[82:83], v110 offset:33800
ds_read_b64_tr_b16 a[20:21], v110 offset:40960
ds_read_b64_tr_b16 a[22:23], v110 offset:41984
ds_read_b64_tr_b16 a[84:85], v110 offset:40968
ds_read_b64_tr_b16 a[86:87], v110 offset:41992
s_waitcnt lgkmcnt(0)
s_waitcnt vmcnt(8)
s_barrier
s_lshl_b32 s40, s33, 12
s_add_u32 s40, s40, 32768
s_mov_b32 m0, s40
s_lshl_b32 s41, s33, 17
s_lshl_b32 s42, s32, 8
s_add_u32 s41, s41, s42
s_add_u32 s41, s41, 3145728
buffer_load_dwordx4 v108, s[8:11], s41 offen offset:0 lds
s_add_u32 s41, s41, 31744
buffer_load_dwordx4 v108, s[8:11], s41 offen offset:1024 lds
s_add_u32 s41, s41, 31744
buffer_load_dwordx4 v108, s[8:11], s41 offen offset:2048 lds
s_add_u32 s41, s41, 31744
buffer_load_dwordx4 v108, s[8:11], s41 offen offset:3072 lds
ds_read_b64_tr_b16 a[24:25], v110 offset:49152
ds_read_b64_tr_b16 a[26:27], v110 offset:50176
ds_read_b64_tr_b16 a[88:89], v110 offset:49160
ds_read_b64_tr_b16 a[90:91], v110 offset:50184
ds_read_b64_tr_b16 a[28:29], v110 offset:57344
ds_read_b64_tr_b16 a[30:31], v110 offset:58368
ds_read_b64_tr_b16 a[92:93], v110 offset:57352
ds_read_b64_tr_b16 a[94:95], v110 offset:58376
s_waitcnt lgkmcnt(0)
s_waitcnt vmcnt(8)
s_barrier
s_lshl_b32 s40, s33, 12
s_add_u32 s40, s40, 49152
s_mov_b32 m0, s40
s_lshl_b32 s41, s33, 17
s_lshl_b32 s42, s32, 8
s_add_u32 s41, s41, s42
s_add_u32 s41, s41, 3670016
buffer_load_dwordx4 v108, s[8:11], s41 offen offset:0 lds
s_add_u32 s41, s41, 31744
buffer_load_dwordx4 v108, s[8:11], s41 offen offset:1024 lds
s_add_u32 s41, s41, 31744
buffer_load_dwordx4 v108, s[8:11], s41 offen offset:2048 lds
s_add_u32 s41, s41, 31744
buffer_load_dwordx4 v108, s[8:11], s41 offen offset:3072 lds
ds_read_b64_tr_b16 a[32:33], v110 offset:0
ds_read_b64_tr_b16 a[34:35], v110 offset:1024
ds_read_b64_tr_b16 a[96:97], v110 offset:8
ds_read_b64_tr_b16 a[98:99], v110 offset:1032
ds_read_b64_tr_b16 a[36:37], v110 offset:8192
ds_read_b64_tr_b16 a[38:39], v110 offset:9216
ds_read_b64_tr_b16 a[100:101], v110 offset:8200
ds_read_b64_tr_b16 a[102:103], v110 offset:9224
s_waitcnt lgkmcnt(0)
s_waitcnt vmcnt(8)
s_barrier
s_lshl_b32 s43, s32, 17
s_lshl_b32 s40, s33, 12
s_add_u32 s40, s40, 0
s_mov_b32 m0, s40
s_lshl_b32 s42, s33, 12
s_add_u32 s41, s43, s42
s_add_u32 s41, s41, 0
buffer_load_dwordx4 v1, s[12:15], s41 offen offset:0 lds
buffer_load_dwordx4 v1, s[12:15], s41 offen offset:1024 lds
buffer_load_dwordx4 v1, s[12:15], s41 offen offset:2048 lds
buffer_load_dwordx4 v1, s[12:15], s41 offen offset:3072 lds
ds_read_b64_tr_b16 a[40:41], v110 offset:16384
ds_read_b64_tr_b16 a[42:43], v110 offset:17408
ds_read_b64_tr_b16 a[104:105], v110 offset:16392
ds_read_b64_tr_b16 a[106:107], v110 offset:17416
ds_read_b64_tr_b16 a[44:45], v110 offset:24576
ds_read_b64_tr_b16 a[46:47], v110 offset:25600
ds_read_b64_tr_b16 a[108:109], v110 offset:24584
ds_read_b64_tr_b16 a[110:111], v110 offset:25608
s_waitcnt lgkmcnt(0)
s_waitcnt vmcnt(8)
s_barrier
s_lshl_b32 s43, s32, 17
s_lshl_b32 s40, s33, 12
s_add_u32 s40, s40, 16384
s_mov_b32 m0, s40
s_lshl_b32 s42, s33, 12
s_add_u32 s41, s43, s42
s_add_u32 s41, s41, 16384
buffer_load_dwordx4 v1, s[12:15], s41 offen offset:0 lds
buffer_load_dwordx4 v1, s[12:15], s41 offen offset:1024 lds
buffer_load_dwordx4 v1, s[12:15], s41 offen offset:2048 lds
buffer_load_dwordx4 v1, s[12:15], s41 offen offset:3072 lds
ds_read_b64_tr_b16 a[48:49], v110 offset:32768
ds_read_b64_tr_b16 a[50:51], v110 offset:33792
ds_read_b64_tr_b16 a[112:113], v110 offset:32776
ds_read_b64_tr_b16 a[114:115], v110 offset:33800
ds_read_b64_tr_b16 a[52:53], v110 offset:40960
ds_read_b64_tr_b16 a[54:55], v110 offset:41984
ds_read_b64_tr_b16 a[116:117], v110 offset:40968
ds_read_b64_tr_b16 a[118:119], v110 offset:41992
s_waitcnt lgkmcnt(0)
s_waitcnt vmcnt(8)
s_barrier
s_lshl_b32 s43, s32, 17
s_lshl_b32 s40, s33, 12
s_add_u32 s40, s40, 32768
s_mov_b32 m0, s40
s_lshl_b32 s42, s33, 12
s_add_u32 s41, s43, s42
s_add_u32 s41, s41, 32768
buffer_load_dwordx4 v1, s[12:15], s41 offen offset:0 lds
buffer_load_dwordx4 v1, s[12:15], s41 offen offset:1024 lds
buffer_load_dwordx4 v1, s[12:15], s41 offen offset:2048 lds
buffer_load_dwordx4 v1, s[12:15], s41 offen offset:3072 lds
ds_read_b64_tr_b16 a[56:57], v110 offset:49152
ds_read_b64_tr_b16 a[58:59], v110 offset:50176
ds_read_b64_tr_b16 a[120:121], v110 offset:49160
ds_read_b64_tr_b16 a[122:123], v110 offset:50184
ds_read_b64_tr_b16 a[60:61], v110 offset:57344
ds_read_b64_tr_b16 a[62:63], v110 offset:58368
ds_read_b64_tr_b16 a[124:125], v110 offset:57352
ds_read_b64_tr_b16 a[126:127], v110 offset:58376
s_waitcnt lgkmcnt(0)
s_waitcnt vmcnt(8)
s_barrier
s_lshl_b32 s43, s32, 17
s_lshl_b32 s40, s33, 12
s_add_u32 s40, s40, 49152
s_mov_b32 m0, s40
s_lshl_b32 s42, s33, 12
s_add_u32 s41, s43, s42
s_add_u32 s41, s41, 49152
buffer_load_dwordx4 v1, s[12:15], s41 offen offset:0 lds
buffer_load_dwordx4 v1, s[12:15], s41 offen offset:1024 lds
buffer_load_dwordx4 v1, s[12:15], s41 offen offset:2048 lds
buffer_load_dwordx4 v1, s[12:15], s41 offen offset:3072 lds
ds_read_b64_tr_b16 a[128:129], v112 offset:0
ds_read_b64_tr_b16 a[144:145], v112 offset:8
ds_read_b64_tr_b16 a[160:161], v112 offset:64
ds_read_b64_tr_b16 a[176:177], v112 offset:72
ds_read_b64_tr_b16 a[192:193], v112 offset:128
ds_read_b64_tr_b16 a[208:209], v112 offset:136
ds_read_b64_tr_b16 a[224:225], v112 offset:192
ds_read_b64_tr_b16 a[240:241], v112 offset:200
s_waitcnt lgkmcnt(0)
s_waitcnt vmcnt(8)
s_barrier
s_lshl_b32 s43, s32, 17
s_lshl_b32 s40, s33, 12
s_add_u32 s40, s40, 0
s_mov_b32 m0, s40
s_lshl_b32 s42, s33, 12
s_add_u32 s41, s43, s42
s_add_u32 s41, s41, 65536
buffer_load_dwordx4 v1, s[12:15], s41 offen offset:0 lds
buffer_load_dwordx4 v1, s[12:15], s41 offen offset:1024 lds
buffer_load_dwordx4 v1, s[12:15], s41 offen offset:2048 lds
buffer_load_dwordx4 v1, s[12:15], s41 offen offset:3072 lds
ds_read_b64_tr_b16 a[130:131], v112 offset:16384
ds_read_b64_tr_b16 a[146:147], v112 offset:16392
ds_read_b64_tr_b16 a[162:163], v112 offset:16448
ds_read_b64_tr_b16 a[178:179], v112 offset:16456
ds_read_b64_tr_b16 a[194:195], v112 offset:16512
ds_read_b64_tr_b16 a[210:211], v112 offset:16520
ds_read_b64_tr_b16 a[226:227], v112 offset:16576
ds_read_b64_tr_b16 a[242:243], v112 offset:16584
s_waitcnt lgkmcnt(0)
s_waitcnt vmcnt(8)
s_barrier
s_lshl_b32 s43, s32, 17
s_lshl_b32 s40, s33, 12
s_add_u32 s40, s40, 16384
s_mov_b32 m0, s40
s_lshl_b32 s42, s33, 12
s_add_u32 s41, s43, s42
s_add_u32 s41, s41, 81920
buffer_load_dwordx4 v1, s[12:15], s41 offen offset:0 lds
buffer_load_dwordx4 v1, s[12:15], s41 offen offset:1024 lds
buffer_load_dwordx4 v1, s[12:15], s41 offen offset:2048 lds
buffer_load_dwordx4 v1, s[12:15], s41 offen offset:3072 lds
ds_read_b64_tr_b16 a[132:133], v112 offset:32768
ds_read_b64_tr_b16 a[148:149], v112 offset:32776
ds_read_b64_tr_b16 a[164:165], v112 offset:32832
ds_read_b64_tr_b16 a[180:181], v112 offset:32840
ds_read_b64_tr_b16 a[196:197], v112 offset:32896
ds_read_b64_tr_b16 a[212:213], v112 offset:32904
ds_read_b64_tr_b16 a[228:229], v112 offset:32960
ds_read_b64_tr_b16 a[244:245], v112 offset:32968
s_waitcnt lgkmcnt(0)
s_waitcnt vmcnt(8)
s_barrier
s_lshl_b32 s43, s32, 17
s_lshl_b32 s40, s33, 12
s_add_u32 s40, s40, 32768
s_mov_b32 m0, s40
s_lshl_b32 s42, s33, 12
s_add_u32 s41, s43, s42
s_add_u32 s41, s41, 98304
buffer_load_dwordx4 v1, s[12:15], s41 offen offset:0 lds
buffer_load_dwordx4 v1, s[12:15], s41 offen offset:1024 lds
buffer_load_dwordx4 v1, s[12:15], s41 offen offset:2048 lds
buffer_load_dwordx4 v1, s[12:15], s41 offen offset:3072 lds
ds_read_b64_tr_b16 a[134:135], v112 offset:49152
ds_read_b64_tr_b16 a[150:151], v112 offset:49160
ds_read_b64_tr_b16 a[166:167], v112 offset:49216
ds_read_b64_tr_b16 a[182:183], v112 offset:49224
ds_read_b64_tr_b16 a[198:199], v112 offset:49280
ds_read_b64_tr_b16 a[214:215], v112 offset:49288
ds_read_b64_tr_b16 a[230:231], v112 offset:49344
ds_read_b64_tr_b16 a[246:247], v112 offset:49352
s_waitcnt lgkmcnt(0)
s_waitcnt vmcnt(8)
s_barrier
s_lshl_b32 s43, s32, 17
s_lshl_b32 s40, s33, 12
s_add_u32 s40, s40, 49152
s_mov_b32 m0, s40
s_lshl_b32 s42, s33, 12
s_add_u32 s41, s43, s42
s_add_u32 s41, s41, 114688
buffer_load_dwordx4 v1, s[12:15], s41 offen offset:0 lds
buffer_load_dwordx4 v1, s[12:15], s41 offen offset:1024 lds
buffer_load_dwordx4 v1, s[12:15], s41 offen offset:2048 lds
buffer_load_dwordx4 v1, s[12:15], s41 offen offset:3072 lds
ds_read_b64_tr_b16 a[136:137], v112 offset:0
ds_read_b64_tr_b16 a[152:153], v112 offset:8
ds_read_b64_tr_b16 a[168:169], v112 offset:64
ds_read_b64_tr_b16 a[184:185], v112 offset:72
ds_read_b64_tr_b16 a[200:201], v112 offset:128
ds_read_b64_tr_b16 a[216:217], v112 offset:136
ds_read_b64_tr_b16 a[232:233], v112 offset:192
ds_read_b64_tr_b16 a[248:249], v112 offset:200
s_waitcnt lgkmcnt(0)
s_waitcnt vmcnt(8)
s_barrier
s_lshl_b32 s40, s33, 12
s_add_u32 s40, s40, 0
s_mov_b32 m0, s40
s_mul_i32 s41, s33, 114688
s_lshl_b32 s42, s37, 7
s_add_u32 s41, s41, s42
s_add_u32 s41, s41, 0
buffer_load_dwordx4 v109, s[16:19], s41 offen offset:0 lds
s_add_u32 s41, s41, 27648
buffer_load_dwordx4 v109, s[16:19], s41 offen offset:1024 lds
s_add_u32 s41, s41, 27648
buffer_load_dwordx4 v109, s[16:19], s41 offen offset:2048 lds
s_add_u32 s41, s41, 27648
buffer_load_dwordx4 v109, s[16:19], s41 offen offset:3072 lds
ds_read_b64_tr_b16 a[138:139], v112 offset:16384
ds_read_b64_tr_b16 a[154:155], v112 offset:16392
ds_read_b64_tr_b16 a[170:171], v112 offset:16448
ds_read_b64_tr_b16 a[186:187], v112 offset:16456
ds_read_b64_tr_b16 a[202:203], v112 offset:16512
ds_read_b64_tr_b16 a[218:219], v112 offset:16520
ds_read_b64_tr_b16 a[234:235], v112 offset:16576
ds_read_b64_tr_b16 a[250:251], v112 offset:16584
s_waitcnt lgkmcnt(0)
s_waitcnt vmcnt(8)
s_barrier
s_lshl_b32 s40, s33, 12
s_add_u32 s40, s40, 16384
s_mov_b32 m0, s40
s_mul_i32 s41, s33, 114688
s_lshl_b32 s42, s37, 7
s_add_u32 s41, s41, s42
s_add_u32 s41, s41, 458752
buffer_load_dwordx4 v109, s[16:19], s41 offen offset:0 lds
s_add_u32 s41, s41, 27648
buffer_load_dwordx4 v109, s[16:19], s41 offen offset:1024 lds
s_add_u32 s41, s41, 27648
buffer_load_dwordx4 v109, s[16:19], s41 offen offset:2048 lds
s_add_u32 s41, s41, 27648
buffer_load_dwordx4 v109, s[16:19], s41 offen offset:3072 lds
ds_read_b64_tr_b16 a[140:141], v112 offset:32768
ds_read_b64_tr_b16 a[156:157], v112 offset:32776
ds_read_b64_tr_b16 a[172:173], v112 offset:32832
ds_read_b64_tr_b16 a[188:189], v112 offset:32840
ds_read_b64_tr_b16 a[204:205], v112 offset:32896
ds_read_b64_tr_b16 a[220:221], v112 offset:32904
ds_read_b64_tr_b16 a[236:237], v112 offset:32960
ds_read_b64_tr_b16 a[252:253], v112 offset:32968
s_waitcnt lgkmcnt(0)
s_waitcnt vmcnt(8)
s_barrier
s_lshl_b32 s40, s33, 12
s_add_u32 s40, s40, 32768
s_mov_b32 m0, s40
s_mul_i32 s41, s33, 114688
s_lshl_b32 s42, s37, 7
s_add_u32 s41, s41, s42
s_add_u32 s41, s41, 917504
buffer_load_dwordx4 v109, s[16:19], s41 offen offset:0 lds
s_add_u32 s41, s41, 27648
buffer_load_dwordx4 v109, s[16:19], s41 offen offset:1024 lds
s_add_u32 s41, s41, 27648
buffer_load_dwordx4 v109, s[16:19], s41 offen offset:2048 lds
s_add_u32 s41, s41, 27648
buffer_load_dwordx4 v109, s[16:19], s41 offen offset:3072 lds
ds_read_b64_tr_b16 a[142:143], v112 offset:49152
ds_read_b64_tr_b16 a[158:159], v112 offset:49160
ds_read_b64_tr_b16 a[174:175], v112 offset:49216
ds_read_b64_tr_b16 a[190:191], v112 offset:49224
ds_read_b64_tr_b16 a[206:207], v112 offset:49280
ds_read_b64_tr_b16 a[222:223], v112 offset:49288
ds_read_b64_tr_b16 a[238:239], v112 offset:49344
ds_read_b64_tr_b16 a[254:255], v112 offset:49352
s_waitcnt lgkmcnt(0)
s_waitcnt vmcnt(8)
s_barrier
s_lshl_b32 s40, s33, 12
s_add_u32 s40, s40, 49152
s_mov_b32 m0, s40
s_mul_i32 s41, s33, 114688
s_lshl_b32 s42, s37, 7
s_add_u32 s41, s41, s42
s_add_u32 s41, s41, 1376256
buffer_load_dwordx4 v109, s[16:19], s41 offen offset:0 lds
s_add_u32 s41, s41, 27648
buffer_load_dwordx4 v109, s[16:19], s41 offen offset:1024 lds
s_add_u32 s41, s41, 27648
buffer_load_dwordx4 v109, s[16:19], s41 offen offset:2048 lds
s_add_u32 s41, s41, 27648
buffer_load_dwordx4 v109, s[16:19], s41 offen offset:3072 lds
ds_read_b64_tr_b16 v[128:129], v114 offset:0
ds_read_b64_tr_b16 v[130:131], v114 offset:512
ds_read_b64_tr_b16 v[132:133], v114 offset:4096
ds_read_b64_tr_b16 v[134:135], v114 offset:4608
ds_read_b64_tr_b16 v[136:137], v114 offset:8192
ds_read_b64_tr_b16 v[138:139], v114 offset:8704
ds_read_b64_tr_b16 v[140:141], v114 offset:12288
ds_read_b64_tr_b16 v[142:143], v114 offset:12800
s_waitcnt lgkmcnt(0)
s_waitcnt vmcnt(8)
s_barrier
s_lshl_b32 s43, s37, 16
s_lshl_b32 s40, s33, 12
s_add_u32 s40, s40, 0
s_mov_b32 m0, s40
s_lshl_b32 s42, s33, 12
s_add_u32 s41, s43, s42
s_add_u32 s41, s41, 0
buffer_load_dwordx4 v1, s[20:23], s41 offen offset:0 lds
buffer_load_dwordx4 v1, s[20:23], s41 offen offset:1024 lds
buffer_load_dwordx4 v1, s[20:23], s41 offen offset:2048 lds
buffer_load_dwordx4 v1, s[20:23], s41 offen offset:3072 lds
ds_read_b64_tr_b16 v[144:145], v114 offset:16384
ds_read_b64_tr_b16 v[146:147], v114 offset:16896
ds_read_b64_tr_b16 v[148:149], v114 offset:20480
ds_read_b64_tr_b16 v[150:151], v114 offset:20992
ds_read_b64_tr_b16 v[152:153], v114 offset:24576
ds_read_b64_tr_b16 v[154:155], v114 offset:25088
ds_read_b64_tr_b16 v[156:157], v114 offset:28672
ds_read_b64_tr_b16 v[158:159], v114 offset:29184
s_waitcnt lgkmcnt(0)
s_waitcnt vmcnt(8)
s_barrier
s_lshl_b32 s43, s37, 16
s_lshl_b32 s40, s33, 12
s_add_u32 s40, s40, 16384
s_mov_b32 m0, s40
s_lshl_b32 s42, s33, 12
s_add_u32 s41, s43, s42
s_add_u32 s41, s41, 16384
buffer_load_dwordx4 v1, s[20:23], s41 offen offset:0 lds
buffer_load_dwordx4 v1, s[20:23], s41 offen offset:1024 lds
buffer_load_dwordx4 v1, s[20:23], s41 offen offset:2048 lds
buffer_load_dwordx4 v1, s[20:23], s41 offen offset:3072 lds
ds_read_b64_tr_b16 v[160:161], v114 offset:32768
ds_read_b64_tr_b16 v[162:163], v114 offset:33280
ds_read_b64_tr_b16 v[164:165], v114 offset:36864
ds_read_b64_tr_b16 v[166:167], v114 offset:37376
ds_read_b64_tr_b16 v[168:169], v114 offset:40960
ds_read_b64_tr_b16 v[170:171], v114 offset:41472
ds_read_b64_tr_b16 v[172:173], v114 offset:45056
ds_read_b64_tr_b16 v[174:175], v114 offset:45568
s_waitcnt lgkmcnt(0)
s_waitcnt vmcnt(8)
s_barrier
s_lshl_b32 s43, s37, 16
s_lshl_b32 s40, s33, 12
s_add_u32 s40, s40, 32768
s_mov_b32 m0, s40
s_lshl_b32 s42, s33, 12
s_add_u32 s41, s43, s42
s_add_u32 s41, s41, 32768
buffer_load_dwordx4 v1, s[20:23], s41 offen offset:0 lds
buffer_load_dwordx4 v1, s[20:23], s41 offen offset:1024 lds
buffer_load_dwordx4 v1, s[20:23], s41 offen offset:2048 lds
buffer_load_dwordx4 v1, s[20:23], s41 offen offset:3072 lds
ds_read_b64_tr_b16 v[176:177], v114 offset:49152
ds_read_b64_tr_b16 v[178:179], v114 offset:49664
ds_read_b64_tr_b16 v[180:181], v114 offset:53248
ds_read_b64_tr_b16 v[182:183], v114 offset:53760
ds_read_b64_tr_b16 v[184:185], v114 offset:57344
ds_read_b64_tr_b16 v[186:187], v114 offset:57856
ds_read_b64_tr_b16 v[188:189], v114 offset:61440
ds_read_b64_tr_b16 v[190:191], v114 offset:61952
s_waitcnt lgkmcnt(0)
s_waitcnt vmcnt(8)
s_barrier
s_lshl_b32 s43, s37, 16
s_lshl_b32 s40, s33, 12
s_add_u32 s40, s40, 49152
s_mov_b32 m0, s40
s_lshl_b32 s42, s33, 12
s_add_u32 s41, s43, s42
s_add_u32 s41, s41, 49152
buffer_load_dwordx4 v1, s[20:23], s41 offen offset:0 lds
buffer_load_dwordx4 v1, s[20:23], s41 offen offset:1024 lds
buffer_load_dwordx4 v1, s[20:23], s41 offen offset:2048 lds
buffer_load_dwordx4 v1, s[20:23], s41 offen offset:3072 lds
ds_read_b64_tr_b16 v[192:193], v112 offset:0
ds_read_b64_tr_b16 v[200:201], v112 offset:8
ds_read_b64_tr_b16 v[208:209], v112 offset:64
ds_read_b64_tr_b16 v[216:217], v112 offset:72
ds_read_b64_tr_b16 v[224:225], v112 offset:128
ds_read_b64_tr_b16 v[232:233], v112 offset:136
ds_read_b64_tr_b16 v[240:241], v112 offset:192
ds_read_b64_tr_b16 v[248:249], v112 offset:200
s_waitcnt lgkmcnt(0)
s_waitcnt vmcnt(8)
s_barrier
ds_read_b64_tr_b16 v[194:195], v112 offset:16384
ds_read_b64_tr_b16 v[202:203], v112 offset:16392
ds_read_b64_tr_b16 v[210:211], v112 offset:16448
ds_read_b64_tr_b16 v[218:219], v112 offset:16456
ds_read_b64_tr_b16 v[226:227], v112 offset:16512
ds_read_b64_tr_b16 v[234:235], v112 offset:16520
ds_read_b64_tr_b16 v[242:243], v112 offset:16576
ds_read_b64_tr_b16 v[250:251], v112 offset:16584
s_waitcnt lgkmcnt(0)
s_waitcnt vmcnt(4)
s_barrier
ds_read_b64_tr_b16 v[196:197], v112 offset:32768
ds_read_b64_tr_b16 v[204:205], v112 offset:32776
ds_read_b64_tr_b16 v[212:213], v112 offset:32832
ds_read_b64_tr_b16 v[220:221], v112 offset:32840
ds_read_b64_tr_b16 v[228:229], v112 offset:32896
ds_read_b64_tr_b16 v[236:237], v112 offset:32904
ds_read_b64_tr_b16 v[244:245], v112 offset:32960
ds_read_b64_tr_b16 v[252:253], v112 offset:32968
s_waitcnt lgkmcnt(0)
s_waitcnt vmcnt(0)
s_barrier
ds_read_b64_tr_b16 v[198:199], v112 offset:49152
ds_read_b64_tr_b16 v[206:207], v112 offset:49160
ds_read_b64_tr_b16 v[214:215], v112 offset:49216
ds_read_b64_tr_b16 v[222:223], v112 offset:49224
ds_read_b64_tr_b16 v[230:231], v112 offset:49280
ds_read_b64_tr_b16 v[238:239], v112 offset:49288
ds_read_b64_tr_b16 v[246:247], v112 offset:49344
ds_read_b64_tr_b16 v[254:255], v112 offset:49352
s_waitcnt lgkmcnt(0)
s_barrier
s_load_dwordx2 s[64:65], s[0:1], 72
s_mov_b32 s66, 3584
s_mov_b32 s67, 0x20000
s_load_dwordx2 s[8:9], s[0:1], 88
s_mov_b32 s10, 1024
s_mov_b32 s11, 0x20000
s_cmp_lg_u32 s33, 0
s_cbranch_scc1 L_w119
L_wg20:
buffer_load_dword v62, off, s[28:31], 0 offset:4 sc1
s_add_u32 s51, s51, 1
s_cmp_gt_u32 s51, 300000
s_cbranch_scc1 L_end
s_waitcnt vmcnt(0)
v_readfirstlane_b32 s40, v62
s_cmp_ge_u32 s40, 32
s_cbranch_scc1 L_wd20
s_sleep 4
s_branch L_wg20
L_wd20:
L_w119:
s_barrier
s_waitcnt lgkmcnt(0)
s_lshl_b32 s41, s33, 8
s_add_u32 s42, s41, 50331648
buffer_load_dwordx2 v[62:63], v6, s[4:7], s42 offen offset:2048 sc1
s_add_u32 s43, s42, 4096
buffer_load_dwordx2 v[64:65], v6, s[4:7], s43 offen sc1
buffer_load_dwordx2 v[66:67], v6, s[4:7], s42 offen offset:3072 sc1
buffer_load_dwordx2 v[68:69], v6, s[4:7], s43 offen offset:1024 sc1
buffer_load_dwordx2 v[70:71], v6, s[8:11], s41 offen
v_lshlrev_b32 v74, 3, v102
s_lshl_b32 s41, s37, 7
s_lshl_b32 s42, s33, 5
s_add_u32 s41, s41, s42
buffer_load_dwordx2 v[72:73], v74, s[64:67], s41 offen
s_waitcnt vmcnt(0)
v_lshlrev_b32 v12, 16, v62
v_and_b32 v13, 0xffff0000, v62
v_lshlrev_b32 v14, 16, v63
v_and_b32 v15, 0xffff0000, v63
v_lshlrev_b32 v16, 16, v64
v_and_b32 v17, 0xffff0000, v64
v_lshlrev_b32 v18, 16, v65
v_and_b32 v19, 0xffff0000, v65
v_lshlrev_b32 v20, 16, v66
v_and_b32 v21, 0xffff0000, v66
v_lshlrev_b32 v22, 16, v67
v_and_b32 v23, 0xffff0000, v67
v_lshlrev_b32 v24, 16, v68
v_and_b32 v25, 0xffff0000, v68
v_lshlrev_b32 v26, 16, v69
v_and_b32 v27, 0xffff0000, v69
v_lshlrev_b32 v28, 16, v70
v_and_b32 v29, 0xffff0000, v70
v_lshlrev_b32 v30, 16, v71
v_and_b32 v31, 0xffff0000, v71
v_lshlrev_b32 v32, 16, v72
v_and_b32 v33, 0xffff0000, v72
v_lshlrev_b32 v34, 16, v73
v_and_b32 v35, 0xffff0000, v73
s_cmp_lg_u32 s59, 0
s_cbranch_scc1 L_pl_s
s_lshl_b32 s41, s58, 2
s_cmp_lg_u32 s33, 0
s_cbranch_scc1 L_w121
L_wg22:
buffer_load_dword v62, off, s[28:31], s41 offset:64 sc1
s_add_u32 s51, s51, 1
s_cmp_gt_u32 s51, 300000
s_cbranch_scc1 L_end
s_waitcnt vmcnt(0)
v_readfirstlane_b32 s40, v62
s_cmp_ge_u32 s40, 32
s_cbranch_scc1 L_wd22
s_sleep 4
s_branch L_wg22
L_wd22:
L_w121:
s_barrier
s_mov_b32 s45, 0
v_lshrrev_b32 v64, 1, v1
s_mov_b32 s41, 51404800
L_wh23:
buffer_load_dwordx2 v[62:63], v64, s[4:7], s41 offen sc1
s_add_u32 s51, s51, 1
s_cmp_gt_u32 s51, 300000
s_cbranch_scc1 L_end
s_waitcnt vmcnt(0)
v_min_u32 v62, v62, v63
v_cmp_eq_u32 vcc, 0, v62
s_cbranch_vccz L_whd23
s_sleep 4
s_branch L_wh23
L_whd23:
s_lshl_b32 s56, s35, 15
s_lshl_b32 s57, s33, 13
s_add_u32 s56, s56, s57
s_add_u32 s56, s56, 48234496
s_add_u32 s68, s56, 4096
s_add_u32 s69, s57, 4096
s_mov_b32 m0, s57
s_nop 0
buffer_load_dwordx4 v1, s[4:7], s56 offen offset:0 sc1 lds
buffer_load_dwordx4 v1, s[4:7], s56 offen offset:1024 sc1 lds
buffer_load_dwordx4 v1, s[4:7], s56 offen offset:2048 sc1 lds
buffer_load_dwordx4 v1, s[4:7], s56 offen offset:3072 sc1 lds
s_mov_b32 m0, s69
s_nop 0
buffer_load_dwordx4 v1, s[4:7], s68 offen offset:0 sc1 lds
buffer_load_dwordx4 v1, s[4:7], s68 offen offset:1024 sc1 lds
buffer_load_dwordx4 v1, s[4:7], s68 offen offset:2048 sc1 lds
buffer_load_dwordx4 v1, s[4:7], s68 offen offset:3072 sc1 lds
s_lshl_b32 s74, s35, 5
s_add_u32 s75, s74, s32
s_lshl_b32 s74, s75, 10
s_lshl_b32 s41, s33, 8
s_add_u32 s74, s74, s41
s_cmp_gt_u32 s45, s35
s_cbranch_scc1 L_kr24
s_lshl_b32 s43, s32, 8
s_add_u32 s43, s43, 51380224
v_lshrrev_b32 v64, 2, v1
L_krl24:
buffer_load_dword v63, v64, s[4:7], s43 offen sc1
s_add_u32 s51, s51, 1
s_cmp_gt_u32 s51, 300000
s_cbranch_scc1 L_end
s_waitcnt vmcnt(0)
v_cmp_eq_u32 vcc, 0, v63
s_ff1_i32_b64 s45, vcc
s_min_u32 s45, s45, 64
s_cmp_gt_u32 s45, s35
s_cbranch_scc0 L_krl24
L_kr24:
s_waitcnt vmcnt(0)
s_lshl_b32 s41, s75, 14
s_lshl_b32 s42, s33, 12
s_add_u32 s41, s41, s42
s_add_u32 s57, s42, 32768
s_mov_b32 s56, s41
buffer_load_dwordx2 v[60:61], v6, s[24:27], s74 offen
s_barrier
ds_read_b128 v[62:65], v1 offset:0
ds_read_b128 v[66:69], v1 offset:16384
ds_read_b128 v[70:73], v1 offset:1024
ds_read_b128 v[74:77], v1 offset:17408
ds_read_b128 v[78:81], v1 offset:2048
ds_read_b128 v[82:85], v1 offset:18432
s_waitcnt lgkmcnt(4)
v_mfma_f32_16x16x32_bf16 v[86:89], a[0:3], v[62:65], 0
v_mfma_f32_16x16x32_bf16 v[90:93], a[64:67], v[62:65], 0
v_mfma_f32_16x16x32_bf16 v[94:97], a[0:3], v[66:69], 0
v_mfma_f32_16x16x32_bf16 v[98:101], a[64:67], v[66:69], 0
ds_read_b128 v[62:65], v1 offset:3072
ds_read_b128 v[66:69], v1 offset:19456
s_waitcnt lgkmcnt(4)
v_mfma_f32_16x16x32_bf16 v[86:89], a[4:7], v[70:73], v[86:89]
v_mfma_f32_16x16x32_bf16 v[90:93], a[68:71], v[70:73], v[90:93]
v_mfma_f32_16x16x32_bf16 v[94:97], a[4:7], v[74:77], v[94:97]
v_mfma_f32_16x16x32_bf16 v[98:101], a[68:71], v[74:77], v[98:101]
s_mov_b32 m0, s57
s_nop 0
buffer_load_dwordx4 v1, s[4:7], s56 offen offset:0 sc1 lds
ds_read_b128 v[70:73], v1 offset:4096
ds_read_b128 v[74:77], v1 offset:20480
s_waitcnt lgkmcnt(4)
v_mfma_f32_16x16x32_bf16 v[86:89], a[8:11], v[78:81], v[86:89]
v_mfma_f32_16x16x32_bf16 v[90:93], a[72:75], v[78:81], v[90:93]
v_mfma_f32_16x16x32_bf16 v[94:97], a[8:11], v[82:85], v[94:97]
v_mfma_f32_16x16x32_bf16 v[98:101], a[72:75], v[82:85], v[98:101]
ds_read_b128 v[78:81], v1 offset:5120
ds_read_b128 v[82:85], v1 offset:21504
s_waitcnt lgkmcnt(4)
v_mfma_f32_16x16x32_bf16 v[86:89], a[12:15], v[62:65], v[86:89]
v_mfma_f32_16x16x32_bf16 v[90:93], a[76:79], v[62:65], v[90:93]
v_mfma_f32_16x16x32_bf16 v[94:97], a[12:15], v[66:69], v[94:97]
v_mfma_f32_16x16x32_bf16 v[98:101], a[76:79], v[66:69], v[98:101]
ds_read_b128 v[62:65], v1 offset:6144
ds_read_b128 v[66:69], v1 offset:22528
s_waitcnt lgkmcnt(4)
v_mfma_f32_16x16x32_bf16 v[86:89], a[16:19], v[70:73], v[86:89]
v_mfma_f32_16x16x32_bf16 v[90:93], a[80:83], v[70:73], v[90:93]
v_mfma_f32_16x16x32_bf16 v[94:97], a[16:19], v[74:77], v[94:97]
v_mfma_f32_16x16x32_bf16 v[98:101], a[80:83], v[74:77], v[98:101]
buffer_load_dwordx4 v1, s[4:7], s56 offen offset:1024 sc1 lds
ds_read_b128 v[70:73], v1 offset:7168
ds_read_b128 v[74:77], v1 offset:23552
s_waitcnt lgkmcnt(4)
v_mfma_f32_16x16x32_bf16 v[86:89], a[20:23], v[78:81], v[86:89]
v_mfma_f32_16x16x32_bf16 v[90:93], a[84:87], v[78:81], v[90:93]
v_mfma_f32_16x16x32_bf16 v[94:97], a[20:23], v[82:85], v[94:97]
v_mfma_f32_16x16x32_bf16 v[98:101], a[84:87], v[82:85], v[98:101]
ds_read_b128 v[78:81], v1 offset:8192
ds_read_b128 v[82:85], v1 offset:24576
s_waitcnt lgkmcnt(4)
v_mfma_f32_16x16x32_bf16 v[86:89], a[24:27], v[62:65], v[86:89]
v_mfma_f32_16x16x32_bf16 v[90:93], a[88:91], v[62:65], v[90:93]
v_mfma_f32_16x16x32_bf16 v[94:97], a[24:27], v[66:69], v[94:97]
v_mfma_f32_16x16x32_bf16 v[98:101], a[88:91], v[66:69], v[98:101]
ds_read_b128 v[62:65], v1 offset:9216
ds_read_b128 v[66:69], v1 offset:25600
s_waitcnt lgkmcnt(4)
v_mfma_f32_16x16x32_bf16 v[86:89], a[28:31], v[70:73], v[86:89]
v_mfma_f32_16x16x32_bf16 v[90:93], a[92:95], v[70:73], v[90:93]
v_mfma_f32_16x16x32_bf16 v[94:97], a[28:31], v[74:77], v[94:97]
v_mfma_f32_16x16x32_bf16 v[98:101], a[92:95], v[74:77], v[98:101]
buffer_load_dwordx4 v1, s[4:7], s56 offen offset:2048 sc1 lds
ds_read_b128 v[70:73], v1 offset:10240
ds_read_b128 v[74:77], v1 offset:26624
s_waitcnt lgkmcnt(4)
v_mfma_f32_16x16x32_bf16 v[86:89], a[32:35], v[78:81], v[86:89]
v_mfma_f32_16x16x32_bf16 v[90:93], a[96:99], v[78:81], v[90:93]
v_mfma_f32_16x16x32_bf16 v[94:97], a[32:35], v[82:85], v[94:97]
v_mfma_f32_16x16x32_bf16 v[98:101], a[96:99], v[82:85], v[98:101]
ds_read_b128 v[78:81], v1 offset:11264
ds_read_b128 v[82:85], v1 offset:27648
s_waitcnt lgkmcnt(4)
v_mfma_f32_16x16x32_bf16 v[86:89], a[36:39], v[62:65], v[86:89]
v_mfma_f32_16x16x32_bf16 v[90:93], a[100:103], v[62:65], v[90:93]
v_mfma_f32_16x16x32_bf16 v[94:97], a[36:39], v[66:69], v[94:97]
v_mfma_f32_16x16x32_bf16 v[98:101], a[100:103], v[66:69], v[98:101]
ds_read_b128 v[62:65], v1 offset:12288
ds_read_b128 v[66:69], v1 offset:28672
s_waitcnt lgkmcnt(4)
v_mfma_f32_16x16x32_bf16 v[86:89], a[40:43], v[70:73], v[86:89]
v_mfma_f32_16x16x32_bf16 v[90:93], a[104:107], v[70:73], v[90:93]
v_mfma_f32_16x16x32_bf16 v[94:97], a[40:43], v[74:77], v[94:97]
v_mfma_f32_16x16x32_bf16 v[98:101], a[104:107], v[74:77], v[98:101]
buffer_load_dwordx4 v1, s[4:7], s56 offen offset:3072 sc1 lds
ds_read_b128 v[70:73], v1 offset:13312
ds_read_b128 v[74:77], v1 offset:29696
s_waitcnt lgkmcnt(4)
v_mfma_f32_16x16x32_bf16 v[86:89], a[44:47], v[78:81], v[86:89]
v_mfma_f32_16x16x32_bf16 v[90:93], a[108:111], v[78:81], v[90:93]
v_mfma_f32_16x16x32_bf16 v[94:97], a[44:47], v[82:85], v[94:97]
v_mfma_f32_16x16x32_bf16 v[98:101], a[108:111], v[82:85], v[98:101]
ds_read_b128 v[78:81], v1 offset:14336
ds_read_b128 v[82:85], v1 offset:30720
s_waitcnt lgkmcnt(4)
v_mfma_f32_16x16x32_bf16 v[86:89], a[48:51], v[62:65], v[86:89]
v_mfma_f32_16x16x32_bf16 v[90:93], a[112:115], v[62:65], v[90:93]
v_mfma_f32_16x16x32_bf16 v[94:97], a[48:51], v[66:69], v[94:97]
v_mfma_f32_16x16x32_bf16 v[98:101], a[112:115], v[66:69], v[98:101]
ds_read_b128 v[62:65], v1 offset:15360
ds_read_b128 v[66:69], v1 offset:31744
s_waitcnt lgkmcnt(4)
v_mfma_f32_16x16x32_bf16 v[86:89], a[52:55], v[70:73], v[86:89]
v_mfma_f32_16x16x32_bf16 v[90:93], a[116:119], v[70:73], v[90:93]
v_mfma_f32_16x16x32_bf16 v[94:97], a[52:55], v[74:77], v[94:97]
v_mfma_f32_16x16x32_bf16 v[98:101], a[116:119], v[74:77], v[98:101]
s_waitcnt lgkmcnt(2)
v_mfma_f32_16x16x32_bf16 v[86:89], a[56:59], v[78:81], v[86:89]
v_mfma_f32_16x16x32_bf16 v[90:93], a[120:123], v[78:81], v[90:93]
v_mfma_f32_16x16x32_bf16 v[94:97], a[56:59], v[82:85], v[94:97]
v_mfma_f32_16x16x32_bf16 v[98:101], a[120:123], v[82:85], v[98:101]
s_waitcnt lgkmcnt(0)
v_mfma_f32_16x16x32_bf16 v[86:89], a[60:63], v[62:65], v[86:89]
v_mfma_f32_16x16x32_bf16 v[90:93], a[124:127], v[62:65], v[90:93]
v_mfma_f32_16x16x32_bf16 v[94:97], a[60:63], v[66:69], v[94:97]
v_mfma_f32_16x16x32_bf16 v[98:101], a[124:127], v[66:69], v[98:101]
s_lshl_b32 s41, s33, 10
v_add_u32 v62, s41, v1
v_cvt_pk_bf16_f32 v86, v86, v87
v_cvt_pk_bf16_f32 v87, v88, v89
v_cvt_pk_bf16_f32 v88, v90, v91
v_cvt_pk_bf16_f32 v89, v92, v93
ds_write_b128 v62, v[86:89] offset:57344
v_cvt_pk_bf16_f32 v94, v94, v95
v_cvt_pk_bf16_f32 v95, v96, v97
v_cvt_pk_bf16_f32 v96, v98, v99
v_cvt_pk_bf16_f32 v97, v100, v101
ds_write_b128 v62, v[94:97] offset:61440
L_post_f:
s_add_u32 s72, s35, 5
s_cmp_lt_u32 s72, 65
s_cselect_b32 s72, s72, s73
s_add_u32 s41, s35, 7
s_cmp_ge_u32 s35, 65
s_cselect_b32 s72, s41, s72
s_mov_b32 s52, s74
s_add_u32 s77, s35, 1
s_mov_b32 s53, s75
s_lshl_b32 s43, s32, 7
s_add_u32 s43, s43, s35
s_lshl_b32 s43, s43, 2
s_add_u32 s43, s43, 51388420
L_wg25:
buffer_load_dword v63, off, s[4:7], s43 offset:0 sc1
s_add_u32 s51, s51, 1
s_cmp_gt_u32 s51, 300000
s_cbranch_scc1 L_end
s_waitcnt vmcnt(0)
v_readfirstlane_b32 s40, v63
s_cmp_ge_u32 s40, 1
s_cbranch_scc1 L_wd25
s_sleep 4
s_branch L_wg25
L_wd25:
s_lshl_b32 s41, s53, 12
s_lshl_b32 s42, s33, 10
s_add_u32 s41, s41, s42
s_add_u32 s41, s41, 33554432
s_add_u32 s42, s42, 49152
s_mov_b32 s56, s41
s_mov_b32 s57, s42
s_mov_b32 m0, s57
s_nop 0
buffer_load_dwordx4 v1, s[4:7], s56 offen offset:0 sc1 lds
s_and_b32 s42, s33, 1
s_lshl_b32 s42, s42, 10
s_lshl_b32 s41, s53, 11
s_add_u32 s41, s41, s42
s_add_u32 s41, s41, 41943040
s_add_u32 s42, s42, 53248
s_mov_b32 s56, s41
s_mov_b32 s57, s42
s_mov_b32 m0, s57
s_nop 0
buffer_load_dwordx4 v1, s[4:7], s56 offen offset:0 sc1 lds
s_waitcnt vmcnt(0) lgkmcnt(0)
s_barrier
s_min_u32 s44, s72, 63
s_lshl_b32 s56, s44, 15
s_lshl_b32 s57, s33, 13
s_add_u32 s56, s56, s57
s_add_u32 s56, s56, 48234496
s_add_u32 s68, s56, 4096
s_add_u32 s69, s57, 4096
s_cmp_ge_u32 s72, 64
ds_read_b128 v[62:65], v8 offset:57344
ds_read_b128 v[66:69], v8 offset:58368
ds_read_b128 v[70:73], v8 offset:59392
ds_read_b128 v[74:77], v8 offset:60416
ds_read_b128 v[78:81], v1 offset:49152
ds_read_b128 v[82:85], v1 offset:50176
ds_read_b128 v[86:89], v1 offset:51200
ds_read_b128 v[90:93], v1 offset:52224
ds_read_b128 v[94:97], v1 offset:32768
ds_read_b128 v[98:101], v1 offset:33792
ds_read_b128 v[102:105], v1 offset:34816
ds_read_b128 v[106:109], v1 offset:35840
s_cbranch_scc1 L_nx26
s_mov_b32 m0, s57
s_nop 0
buffer_load_dwordx4 v1, s[4:7], s56 offen offset:0 sc1 lds
L_nx26:
s_waitcnt lgkmcnt(4)
v_mfma_f32_16x16x32_bf16 v[118:121], v[78:81], v[62:65], 0
v_mfma_f32_16x16x32_bf16 v[118:121], v[82:85], v[66:69], v[118:121]
v_mfma_f32_16x16x32_bf16 v[118:121], v[86:89], v[70:73], v[118:121]
v_mfma_f32_16x16x32_bf16 v[118:121], v[90:93], v[74:77], v[118:121]
ds_read_b128 v[78:81], v1 offset:36864
ds_read_b128 v[82:85], v1 offset:37888
ds_read_b128 v[86:89], v1 offset:38912
ds_read_b128 v[90:93], v1 offset:39936
s_waitcnt lgkmcnt(4)
v_mfma_f32_16x16x32_bf16 v[110:113], v[94:97], v[62:65], v[44:47]
v_mfma_f32_16x16x32_bf16 v[110:113], v[98:101], v[66:69], v[110:113]
s_cbranch_scc1 L_nx27
buffer_load_dwordx4 v1, s[4:7], s56 offen offset:1024 sc1 lds
L_nx27:
v_mfma_f32_16x16x32_bf16 v[110:113], v[102:105], v[70:73], v[110:113]
v_mfma_f32_16x16x32_bf16 v[110:113], v[106:109], v[74:77], v[110:113]
ds_read_b128 v[94:97], v9 offset:40960
ds_read_b128 v[98:101], v9 offset:41984
ds_read_b128 v[102:105], v9 offset:43008
ds_read_b128 v[106:109], v9 offset:44032
ds_read_b64 v[124:125], v10 offset:53248
ds_read_b64 v[126:127], v10 offset:53760
s_waitcnt lgkmcnt(6)
v_mfma_f32_16x16x32_bf16 v[114:117], v[78:81], v[62:65], v[48:51]
v_mfma_f32_16x16x32_bf16 v[114:117], v[82:85], v[66:69], v[114:117]
v_mfma_f32_16x16x32_bf16 v[114:117], v[86:89], v[70:73], v[114:117]
s_cbranch_scc1 L_nx28
buffer_load_dwordx4 v1, s[4:7], s56 offen offset:2048 sc1 lds
L_nx28:
v_mfma_f32_16x16x32_bf16 v[114:117], v[90:93], v[74:77], v[114:117]
v_max3_f32 v122, v118, v119, v110
v_max3_f32 v122, v122, v111, v112
s_nop 5
v_max3_f32 v122, v122, v113, v114
v_max3_f32 v122, v122, v115, v116
v_max_f32 v122, v122, v117
v_mov_b32 v123, v122
s_nop 1
v_permlane16_swap_b32 v122, v123
v_max_f32 v122, v122, v123
v_mov_b32 v123, v122
s_nop 1
v_permlane32_swap_b32 v122, v123
v_max_f32 v122, v122, v123
s_cbranch_scc1 L_nx29
buffer_load_dwordx4 v1, s[4:7], s56 offen offset:3072 sc1 lds
L_nx29:
v_mul_f32 v122, s46, v122
v_fma_f32 v110, v110, s46, -v122
v_fma_f32 v111, v111, s46, -v122
v_fma_f32 v112, v112, s46, -v122
v_fma_f32 v113, v113, s46, -v122
v_fma_f32 v114, v114, s46, -v122
v_fma_f32 v115, v115, s46, -v122
v_fma_f32 v116, v116, s46, -v122
v_fma_f32 v117, v117, s46, -v122
v_fma_f32 v118, v118, s46, -v122
v_fma_f32 v119, v119, s46, -v122
v_exp_f32 v110, v110
s_cbranch_scc1 L_nx30
s_mov_b32 m0, s69
s_nop 0
buffer_load_dwordx4 v1, s[4:7], s68 offen offset:0 sc1 lds
L_nx30:
v_exp_f32 v111, v111
v_exp_f32 v112, v112
v_exp_f32 v113, v113
v_exp_f32 v114, v114
v_exp_f32 v115, v115
v_exp_f32 v116, v116
v_exp_f32 v117, v117
v_exp_f32 v118, v118
v_exp_f32 v119, v119
v_cvt_pk_bf16_f32 v62, v110, v111
v_cvt_pk_bf16_f32 v63, v112, v113
v_cvt_pk_bf16_f32 v64, v114, v115
s_cbranch_scc1 L_nx31
buffer_load_dwordx4 v1, s[4:7], s68 offen offset:1024 sc1 lds
L_nx31:
v_cvt_pk_bf16_f32 v65, v116, v117
v_cvt_pk_bf16_f32 v52, v118, v119
v_cvt_pk_bf16_f32 v55, v118, v119
s_waitcnt lgkmcnt(0)
v_mfma_f32_16x16x32_bf16 v[66:69], v[40:43], v[62:65], 0
v_mfma_f32_16x16x32_bf16 v[78:81], v[94:97], v[62:65], 0
v_mfma_f32_16x16x32_bf16 v[82:85], v[98:101], v[62:65], 0
v_mfma_f32_16x16x32_bf16 v[86:89], v[102:105], v[62:65], 0
v_mfma_f32_16x16x32_bf16 v[90:93], v[106:109], v[62:65], 0
v_mfma_f32_16x16x16_bf16 v[66:69], v[40:41], v[52:53], v[66:69]
v_mfma_f32_16x16x16_bf16 v[78:81], v[124:125], v[52:53], v[78:81]
v_mfma_f32_16x16x16_bf16 v[82:85], v[124:125], v[54:55], v[82:85]
s_cbranch_scc1 L_nx32
buffer_load_dwordx4 v1, s[4:7], s68 offen offset:2048 sc1 lds
L_nx32:
v_mfma_f32_16x16x16_bf16 v[86:89], v[126:127], v[52:53], v[86:89]
v_mfma_f32_16x16x16_bf16 v[90:93], v[126:127], v[54:55], v[90:93]
v_rcp_f32 v122, v66
s_nop 0
v_mul_f32 v78, v78, v122
v_mul_f32 v79, v79, v122
v_mul_f32 v80, v80, v122
v_mul_f32 v81, v81, v122
v_mul_f32 v82, v82, v122
v_mul_f32 v83, v83, v122
v_mul_f32 v84, v84, v122
v_mul_f32 v85, v85, v122
v_mul_f32 v86, v86, v122
s_cbranch_scc1 L_nx33
buffer_load_dwordx4 v1, s[4:7], s68 offen offset:3072 sc1 lds
L_nx33:
v_mul_f32 v87, v87, v122
v_mul_f32 v88, v88, v122
v_mul_f32 v89, v89, v122
v_mul_f32 v90, v90, v122
v_mul_f32 v91, v91, v122
v_mul_f32 v92, v92, v122
v_mul_f32 v93, v93, v122
v_cvt_pk_bf16_f32 v78, v78, v79
v_cvt_pk_bf16_f32 v79, v80, v81
v_cvt_pk_bf16_f32 v80, v82, v83
v_cvt_pk_bf16_f32 v81, v84, v85
ds_write_b128 v11, v[78:81] offset:0
v_cvt_pk_bf16_f32 v86, v86, v87
v_cvt_pk_bf16_f32 v87, v88, v89
v_cvt_pk_bf16_f32 v88, v90, v91
v_cvt_pk_bf16_f32 v89, v92, v93
ds_write_b128 v11, v[86:89] offset:1024
s_waitcnt lgkmcnt(0)
s_barrier
ds_read_b128 v[62:65], v2 offset:0
ds_read_b128 v[66:69], v2 offset:1024
ds_read_b128 v[70:73], v2 offset:2048
ds_read_b128 v[74:77], v2 offset:3072
ds_read_b128 v[78:81], v2 offset:4096
ds_read_b128 v[82:85], v2 offset:5120
ds_read_b128 v[86:89], v2 offset:6144
ds_read_b128 v[90:93], v2 offset:7168
s_waitcnt lgkmcnt(0)
s_add_u32 s43, s50, 524288
v_mfma_f32_16x16x32_bf16 v[96:99], a[128:131], v[62:65], 0
v_mfma_f32_16x16x32_bf16 v[100:103], a[144:147], v[62:65], 0
v_mfma_f32_16x16x32_bf16 v[104:107], a[128:131], v[78:81], 0
v_mfma_f32_16x16x32_bf16 v[108:111], a[144:147], v[78:81], 0
v_mfma_f32_16x16x32_bf16 v[96:99], a[132:135], v[66:69], v[96:99]
v_mfma_f32_16x16x32_bf16 v[100:103], a[148:151], v[66:69], v[100:103]
v_mfma_f32_16x16x32_bf16 v[104:107], a[132:135], v[82:85], v[104:107]
v_mfma_f32_16x16x32_bf16 v[108:111], a[148:151], v[82:85], v[108:111]
v_mfma_f32_16x16x32_bf16 v[96:99], a[136:139], v[70:73], v[96:99]
v_mfma_f32_16x16x32_bf16 v[100:103], a[152:155], v[70:73], v[100:103]
v_mfma_f32_16x16x32_bf16 v[104:107], a[136:139], v[86:89], v[104:107]
v_mfma_f32_16x16x32_bf16 v[108:111], a[152:155], v[86:89], v[108:111]
v_mfma_f32_16x16x32_bf16 v[96:99], a[140:143], v[74:77], v[96:99]
v_mfma_f32_16x16x32_bf16 v[100:103], a[156:159], v[74:77], v[100:103]
v_mfma_f32_16x16x32_bf16 v[104:107], a[140:143], v[90:93], v[104:107]
v_mfma_f32_16x16x32_bf16 v[108:111], a[156:159], v[90:93], v[108:111]
v_mfma_f32_16x16x32_bf16 v[112:115], a[160:163], v[62:65], 0
v_mfma_f32_16x16x32_bf16 v[116:119], a[176:179], v[62:65], 0
v_mfma_f32_16x16x32_bf16 v[120:123], a[160:163], v[78:81], 0
v_cvt_pk_bf16_f32 v96, v96, v97
v_cvt_pk_bf16_f32 v97, v98, v99
v_mfma_f32_16x16x32_bf16 v[124:127], a[176:179], v[78:81], 0
v_cvt_pk_bf16_f32 v98, v100, v101
v_cvt_pk_bf16_f32 v99, v102, v103
v_mfma_f32_16x16x32_bf16 v[112:115], a[164:167], v[66:69], v[112:115]
buffer_store_dwordx4 v[96:99], v3, s[4:7], s50 offen offset:0
v_cvt_pk_bf16_f32 v104, v104, v105
v_mfma_f32_16x16x32_bf16 v[116:119], a[180:183], v[66:69], v[116:119]
v_cvt_pk_bf16_f32 v105, v106, v107
v_cvt_pk_bf16_f32 v106, v108, v109
v_mfma_f32_16x16x32_bf16 v[120:123], a[164:167], v[82:85], v[120:123]
v_cvt_pk_bf16_f32 v107, v110, v111
buffer_store_dwordx4 v[104:107], v3, s[4:7], s43 offen offset:0
v_mfma_f32_16x16x32_bf16 v[124:127], a[180:183], v[82:85], v[124:127]
v_mfma_f32_16x16x32_bf16 v[112:115], a[168:171], v[70:73], v[112:115]
v_mfma_f32_16x16x32_bf16 v[116:119], a[184:187], v[70:73], v[116:119]
v_mfma_f32_16x16x32_bf16 v[120:123], a[168:171], v[86:89], v[120:123]
v_mfma_f32_16x16x32_bf16 v[124:127], a[184:187], v[86:89], v[124:127]
v_mfma_f32_16x16x32_bf16 v[112:115], a[172:175], v[74:77], v[112:115]
v_mfma_f32_16x16x32_bf16 v[116:119], a[188:191], v[74:77], v[116:119]
v_mfma_f32_16x16x32_bf16 v[120:123], a[172:175], v[90:93], v[120:123]
v_mfma_f32_16x16x32_bf16 v[124:127], a[188:191], v[90:93], v[124:127]
v_mfma_f32_16x16x32_bf16 v[96:99], a[192:195], v[62:65], 0
v_mfma_f32_16x16x32_bf16 v[100:103], a[208:211], v[62:65], 0
v_mfma_f32_16x16x32_bf16 v[104:107], a[192:195], v[78:81], 0
v_cvt_pk_bf16_f32 v112, v112, v113
v_cvt_pk_bf16_f32 v113, v114, v115
v_mfma_f32_16x16x32_bf16 v[108:111], a[208:211], v[78:81], 0
v_cvt_pk_bf16_f32 v114, v116, v117
v_cvt_pk_bf16_f32 v115, v118, v119
v_mfma_f32_16x16x32_bf16 v[96:99], a[196:199], v[66:69], v[96:99]
buffer_store_dwordx4 v[112:115], v3, s[4:7], s50 offen offset:64
v_cvt_pk_bf16_f32 v120, v120, v121
v_mfma_f32_16x16x32_bf16 v[100:103], a[212:215], v[66:69], v[100:103]
v_cvt_pk_bf16_f32 v121, v122, v123
v_cvt_pk_bf16_f32 v122, v124, v125
v_mfma_f32_16x16x32_bf16 v[104:107], a[196:199], v[82:85], v[104:107]
v_cvt_pk_bf16_f32 v123, v126, v127
buffer_store_dwordx4 v[120:123], v3, s[4:7], s43 offen offset:64
v_mfma_f32_16x16x32_bf16 v[108:111], a[212:215], v[82:85], v[108:111]
v_mfma_f32_16x16x32_bf16 v[96:99], a[200:203], v[70:73], v[96:99]
v_mfma_f32_16x16x32_bf16 v[100:103], a[216:219], v[70:73], v[100:103]
v_mfma_f32_16x16x32_bf16 v[104:107], a[200:203], v[86:89], v[104:107]
v_mfma_f32_16x16x32_bf16 v[108:111], a[216:219], v[86:89], v[108:111]
v_mfma_f32_16x16x32_bf16 v[96:99], a[204:207], v[74:77], v[96:99]
v_mfma_f32_16x16x32_bf16 v[100:103], a[220:223], v[74:77], v[100:103]
v_mfma_f32_16x16x32_bf16 v[104:107], a[204:207], v[90:93], v[104:107]
v_mfma_f32_16x16x32_bf16 v[108:111], a[220:223], v[90:93], v[108:111]
v_mfma_f32_16x16x32_bf16 v[112:115], a[224:227], v[62:65], 0
v_mfma_f32_16x16x32_bf16 v[116:119], a[240:243], v[62:65], 0
v_mfma_f32_16x16x32_bf16 v[120:123], a[224:227], v[78:81], 0
v_cvt_pk_bf16_f32 v96, v96, v97
v_cvt_pk_bf16_f32 v97, v98, v99
v_mfma_f32_16x16x32_bf16 v[124:127], a[240:243], v[78:81], 0
v_cvt_pk_bf16_f32 v98, v100, v101
v_cvt_pk_bf16_f32 v99, v102, v103
v_mfma_f32_16x16x32_bf16 v[112:115], a[228:231], v[66:69], v[112:115]
buffer_store_dwordx4 v[96:99], v3, s[4:7], s50 offen offset:128
v_cvt_pk_bf16_f32 v104, v104, v105
v_mfma_f32_16x16x32_bf16 v[116:119], a[244:247], v[66:69], v[116:119]
v_cvt_pk_bf16_f32 v105, v106, v107
v_cvt_pk_bf16_f32 v106, v108, v109
v_mfma_f32_16x16x32_bf16 v[120:123], a[228:231], v[82:85], v[120:123]
v_cvt_pk_bf16_f32 v107, v110, v111
buffer_store_dwordx4 v[104:107], v3, s[4:7], s43 offen offset:128
v_mfma_f32_16x16x32_bf16 v[124:127], a[244:247], v[82:85], v[124:127]
v_mfma_f32_16x16x32_bf16 v[112:115], a[232:235], v[70:73], v[112:115]
v_mfma_f32_16x16x32_bf16 v[116:119], a[248:251], v[70:73], v[116:119]
v_mfma_f32_16x16x32_bf16 v[120:123], a[232:235], v[86:89], v[120:123]
v_mfma_f32_16x16x32_bf16 v[124:127], a[248:251], v[86:89], v[124:127]
v_mfma_f32_16x16x32_bf16 v[112:115], a[236:239], v[74:77], v[112:115]
v_mfma_f32_16x16x32_bf16 v[116:119], a[252:255], v[74:77], v[116:119]
v_mfma_f32_16x16x32_bf16 v[120:123], a[236:239], v[90:93], v[120:123]
v_mfma_f32_16x16x32_bf16 v[124:127], a[252:255], v[90:93], v[124:127]
v_cvt_pk_bf16_f32 v112, v112, v113
v_cvt_pk_bf16_f32 v113, v114, v115
v_cvt_pk_bf16_f32 v114, v116, v117
v_cvt_pk_bf16_f32 v115, v118, v119
buffer_store_dwordx4 v[112:115], v3, s[4:7], s50 offen offset:192
v_cvt_pk_bf16_f32 v120, v120, v121
v_cvt_pk_bf16_f32 v121, v122, v123
s_nop 0
v_cvt_pk_bf16_f32 v122, v124, v125
v_cvt_pk_bf16_f32 v123, v126, v127
buffer_store_dwordx4 v[120:123], v3, s[4:7], s43 offen offset:192
s_waitcnt vmcnt(0)
s_barrier
s_cmp_lg_u32 s33, 0
s_cbranch_scc1 L_pb34
s_lshl_b32 s41, s32, 7
s_add_u32 s41, s41, s76
s_add_u32 s41, s41, 0
v_mov_b32 v62, s77
buffer_store_dword v62, off, s[4:7], s41
L_pb34:
s_cmp_lg_u32 s33, 0
s_cbranch_scc1 L_aw35
v_lshlrev_b32 v63, 3, v1
s_add_u32 s41, s76, 0
s_mov_b64 exec, 0xffffffff
L_awl35:
buffer_load_dword v62, v63, s[4:7], s41 offen sc1
s_add_u32 s51, s51, 1
s_cmp_gt_u32 s51, 300000
s_cbranch_scc1 L_end
s_waitcnt vmcnt(0)
v_cmp_ne_u32 vcc, s77, v62
s_cbranch_vccz L_awd35
s_sleep 1
s_branch L_awl35
L_awd35:
s_mov_b64 exec, -1
L_aw35:
s_barrier
s_mov_b32 s41, s47
buffer_load_dwordx4 v[62:65], v4, s[4:7], s41 offen sc1
s_add_u32 s41, s41, 4096
buffer_load_dwordx4 v[66:69], v4, s[4:7], s41 offen sc1
s_add_u32 s41, s41, 4096
buffer_load_dwordx4 v[70:73], v4, s[4:7], s41 offen sc1
s_add_u32 s41, s41, 4096
buffer_load_dwordx4 v[74:77], v4, s[4:7], s41 offen sc1
s_add_u32 s41, s41, 4096
buffer_load_dwordx4 v[78:81], v4, s[4:7], s41 offen sc1
s_add_u32 s41, s41, 4096
buffer_load_dwordx4 v[82:85], v4, s[4:7], s41 offen sc1
s_add_u32 s41, s41, 4096
buffer_load_dwordx4 v[86:89], v4, s[4:7], s41 offen sc1
s_add_u32 s41, s41, 4096
buffer_load_dwordx4 v[90:93], v4, s[4:7], s41 offen sc1
s_waitcnt vmcnt(7)
v_mfma_f32_16x16x32_bf16 v[96:99], v[36:39], v[62:65], 0
s_waitcnt vmcnt(6)
v_mfma_f32_16x16x32_bf16 v[96:99], v[36:39], v[66:69], v[96:99]
s_waitcnt vmcnt(5)
v_mfma_f32_16x16x32_bf16 v[96:99], v[36:39], v[70:73], v[96:99]
s_waitcnt vmcnt(4)
v_mfma_f32_16x16x32_bf16 v[96:99], v[36:39], v[74:77], v[96:99]
s_waitcnt vmcnt(3)
v_mfma_f32_16x16x32_bf16 v[96:99], v[36:39], v[78:81], v[96:99]
s_waitcnt vmcnt(2)
v_mfma_f32_16x16x32_bf16 v[96:99], v[36:39], v[82:85], v[96:99]
s_waitcnt vmcnt(1)
v_mfma_f32_16x16x32_bf16 v[96:99], v[36:39], v[86:89], v[96:99]
s_waitcnt vmcnt(0)
v_mfma_f32_16x16x32_bf16 v[96:99], v[36:39], v[90:93], v[96:99]
s_mov_b64 exec, s[38:39]
s_nop 6
v_cvt_pk_bf16_f32 v96, v96, v97
v_cvt_pk_bf16_f32 v97, v98, v99
v_lshlrev_b32 v62, 16, v96
v_and_b32 v63, 0xffff0000, v96
v_lshlrev_b32 v56, 16, v60
v_and_b32 v57, 0xffff0000, v60
v_lshlrev_b32 v64, 16, v97
v_and_b32 v65, 0xffff0000, v97
v_lshlrev_b32 v58, 16, v61
v_and_b32 v59, 0xffff0000, v61
v_fmac_f32 v56, v62, v12
v_fmac_f32 v57, v63, v13
v_fmac_f32 v58, v64, v14
v_fmac_f32 v59, v65, v15
v_cvt_pk_bf16_f32 v96, v56, v57
v_cvt_pk_bf16_f32 v97, v58, v59
v_lshlrev_b32 v56, 16, v96
v_and_b32 v57, 0xffff0000, v96
v_lshlrev_b32 v58, 16, v97
v_and_b32 v59, 0xffff0000, v97
v_add_f32 v70, v56, v57
v_add_f32 v70, v70, v58
v_add_f32 v70, v70, v59
s_nop 1
v_add_f32_dpp v70, v70, v70 quad_perm:[1,0,3,2] row_mask:0xf bank_mask:0xf
s_nop 1
v_add_f32_dpp v70, v70, v70 quad_perm:[2,3,0,1] row_mask:0xf bank_mask:0xf
s_nop 1
v_add_f32_dpp v70, v70, v70 row_half_mirror row_mask:0xf bank_mask:0xf
s_nop 1
v_add_f32_dpp v70, v70, v70 row_mirror row_mask:0xf bank_mask:0xf
v_mov_b32 v72, v70
s_mov_b64 exec, -1
s_nop 0
v_permlane16_swap_b32 v70, v72
s_mov_b64 exec, s[38:39]
v_add_f32 v70, v70, v72
s_lshl_b32 s41, s33, 2
s_add_u32 s41, s41, 110592
v_mov_b32 v72, s41
ds_write_b32 v72, v70
s_waitcnt vmcnt(0) lgkmcnt(0)
s_barrier
v_mov_b32 v72, 110592
ds_read_b128 v[74:77], v72
s_waitcnt lgkmcnt(0)
v_add_f32 v74, v74, v75
v_add_f32 v76, v76, v77
v_add_f32 v70, v74, v76
v_mul_f32 v70, 0x3b000000, v70
v_sub_f32 v62, v56, v70
v_sub_f32 v63, v57, v70
v_sub_f32 v64, v58, v70
v_sub_f32 v65, v59, v70
v_mul_f32 v70, v62, v62
v_fmac_f32 v70, v63, v63
v_fmac_f32 v70, v64, v64
v_fmac_f32 v70, v65, v65
s_nop 1
v_add_f32_dpp v70, v70, v70 quad_perm:[1,0,3,2] row_mask:0xf bank_mask:0xf
s_nop 1
v_add_f32_dpp v70, v70, v70 quad_perm:[2,3,0,1] row_mask:0xf bank_mask:0xf
s_nop 1
v_add_f32_dpp v70, v70, v70 row_half_mirror row_mask:0xf bank_mask:0xf
s_nop 1
v_add_f32_dpp v70, v70, v70 row_mirror row_mask:0xf bank_mask:0xf
v_mov_b32 v72, v70
s_mov_b64 exec, -1
s_nop 0
v_permlane16_swap_b32 v70, v72
s_mov_b64 exec, s[38:39]
v_add_f32 v70, v70, v72
s_lshl_b32 s41, s33, 2
s_add_u32 s41, s41, 110608
v_mov_b32 v72, s41
ds_write_b32 v72, v70
s_waitcnt vmcnt(0) lgkmcnt(0)
s_barrier
v_mov_b32 v72, 110608
ds_read_b128 v[74:77], v72
s_waitcnt lgkmcnt(0)
v_add_f32 v74, v74, v75
v_add_f32 v76, v76, v77
v_add_f32 v70, v74, v76
v_mov_b32 v71, 0x3727c5ac
v_fmac_f32 v71, 0x3b000000, v70
v_rsq_f32 v70, v71
s_nop 0
v_mul_f32 v62, v62, v70
v_mul_f32 v63, v63, v70
v_mul_f32 v64, v64, v70
v_mul_f32 v65, v65, v70
v_fma_f32 v62, v62, v16, v20
v_fma_f32 v63, v63, v17, v21
v_fma_f32 v64, v64, v18, v22
v_fma_f32 v65, v65, v19, v23
v_cvt_pk_bf16_f32 v96, v62, v63
v_cvt_pk_bf16_f32 v97, v64, v65
buffer_store_dwordx2 v[96:97], v5, s[4:7], s49 offen
s_mov_b64 exec, -1
s_waitcnt vmcnt(0)
s_barrier
s_cmp_lg_u32 s33, 0
s_cbranch_scc1 L_pb36
s_lshl_b32 s41, s32, 7
s_add_u32 s41, s41, s76
s_add_u32 s41, s41, 4096
v_mov_b32 v62, s77
buffer_store_dword v62, off, s[4:7], s41
L_pb36:
s_cmp_ge_u32 s32, 28
s_cbranch_scc1 L_nomlp_f
s_lshl_b32 s57, s33, 13
s_add_u32 s56, s57, s36
s_add_u32 s56, s56, 2621440
s_add_u32 s68, s56, 4096
s_add_u32 s57, s57, 73728
s_add_u32 s69, s57, 4096
s_cmp_lg_u32 s33, 0
s_cbranch_scc1 L_aw37
v_lshlrev_b32 v63, 3, v1
s_add_u32 s41, s76, 4096
s_mov_b64 exec, 0xffffffff
L_awl37:
buffer_load_dword v62, v63, s[4:7], s41 offen sc1
s_add_u32 s51, s51, 1
s_cmp_gt_u32 s51, 300000
s_cbranch_scc1 L_end
s_waitcnt vmcnt(0)
v_cmp_ne_u32 vcc, s77, v62
s_cbranch_vccz L_awd37
s_sleep 1
s_branch L_awl37
L_awd37:
s_mov_b64 exec, -1
L_aw37:
s_barrier
s_mov_b32 m0, s57
s_nop 0
buffer_load_dwordx4 v1, s[4:7], s56 offen offset:0 sc1 lds
buffer_load_dwordx4 v1, s[4:7], s56 offen offset:1024 sc1 lds
buffer_load_dwordx4 v1, s[4:7], s56 offen offset:2048 sc1 lds
buffer_load_dwordx4 v1, s[4:7], s56 offen offset:3072 sc1 lds
s_mov_b32 m0, s69
s_nop 0
buffer_load_dwordx4 v1, s[4:7], s68 offen offset:0 sc1 lds
buffer_load_dwordx4 v1, s[4:7], s68 offen offset:1024 sc1 lds
buffer_load_dwordx4 v1, s[4:7], s68 offen offset:2048 sc1 lds
buffer_load_dwordx4 v1, s[4:7], s68 offen offset:3072 sc1 lds
s_waitcnt vmcnt(0)
s_barrier
ds_read_b128 v[62:65], v2 offset:8192
ds_read_b128 v[66:69], v2 offset:24576
ds_read_b128 v[70:73], v2 offset:9216
ds_read_b128 v[74:77], v2 offset:25600
ds_read_b128 v[78:81], v2 offset:10240
ds_read_b128 v[82:85], v2 offset:26624
s_waitcnt lgkmcnt(4)
v_mfma_f32_16x16x32_bf16 v[86:89], v[128:131], v[62:65], v[32:35]
v_mfma_f32_16x16x32_bf16 v[90:93], v[128:131], v[66:69], v[32:35]
ds_read_b128 v[62:65], v2 offset:11264
ds_read_b128 v[66:69], v2 offset:27648
s_waitcnt lgkmcnt(4)
v_mfma_f32_16x16x32_bf16 v[86:89], v[132:135], v[70:73], v[86:89]
v_mfma_f32_16x16x32_bf16 v[90:93], v[132:135], v[74:77], v[90:93]
ds_read_b128 v[70:73], v2 offset:12288
ds_read_b128 v[74:77], v2 offset:28672
s_waitcnt lgkmcnt(4)
v_mfma_f32_16x16x32_bf16 v[86:89], v[136:139], v[78:81], v[86:89]
v_mfma_f32_16x16x32_bf16 v[90:93], v[136:139], v[82:85], v[90:93]
ds_read_b128 v[78:81], v2 offset:13312
ds_read_b128 v[82:85], v2 offset:29696
s_waitcnt lgkmcnt(4)
v_mfma_f32_16x16x32_bf16 v[86:89], v[140:143], v[62:65], v[86:89]
v_mfma_f32_16x16x32_bf16 v[90:93], v[140:143], v[66:69], v[90:93]
ds_read_b128 v[62:65], v2 offset:14336
ds_read_b128 v[66:69], v2 offset:30720
s_waitcnt lgkmcnt(4)
v_mfma_f32_16x16x32_bf16 v[86:89], v[144:147], v[70:73], v[86:89]
v_mfma_f32_16x16x32_bf16 v[90:93], v[144:147], v[74:77], v[90:93]
ds_read_b128 v[70:73], v2 offset:15360
ds_read_b128 v[74:77], v2 offset:31744
s_waitcnt lgkmcnt(4)
v_mfma_f32_16x16x32_bf16 v[86:89], v[148:151], v[78:81], v[86:89]
v_mfma_f32_16x16x32_bf16 v[90:93], v[148:151], v[82:85], v[90:93]
ds_read_b128 v[78:81], v2 offset:16384
ds_read_b128 v[82:85], v2 offset:32768
s_waitcnt lgkmcnt(4)
v_mfma_f32_16x16x32_bf16 v[86:89], v[152:155], v[62:65], v[86:89]
v_mfma_f32_16x16x32_bf16 v[90:93], v[152:155], v[66:69], v[90:93]
ds_read_b128 v[62:65], v2 offset:17408
ds_read_b128 v[66:69], v2 offset:33792
s_waitcnt lgkmcnt(4)
v_mfma_f32_16x16x32_bf16 v[86:89], v[156:159], v[70:73], v[86:89]
v_mfma_f32_16x16x32_bf16 v[90:93], v[156:159], v[74:77], v[90:93]
ds_read_b128 v[70:73], v2 offset:18432
ds_read_b128 v[74:77], v2 offset:34816
s_waitcnt lgkmcnt(4)
v_mfma_f32_16x16x32_bf16 v[86:89], v[160:163], v[78:81], v[86:89]
v_mfma_f32_16x16x32_bf16 v[90:93], v[160:163], v[82:85], v[90:93]
ds_read_b128 v[78:81], v2 offset:19456
ds_read_b128 v[82:85], v2 offset:35840
s_waitcnt lgkmcnt(4)
v_mfma_f32_16x16x32_bf16 v[86:89], v[164:167], v[62:65], v[86:89]
v_mfma_f32_16x16x32_bf16 v[90:93], v[164:167], v[66:69], v[90:93]
ds_read_b128 v[62:65], v2 offset:20480
ds_read_b128 v[66:69], v2 offset:36864
s_waitcnt lgkmcnt(4)
v_mfma_f32_16x16x32_bf16 v[86:89], v[168:171], v[70:73], v[86:89]
v_mfma_f32_16x16x32_bf16 v[90:93], v[168:171], v[74:77], v[90:93]
ds_read_b128 v[70:73], v2 offset:21504
ds_read_b128 v[74:77], v2 offset:37888
s_waitcnt lgkmcnt(4)
v_mfma_f32_16x16x32_bf16 v[86:89], v[172:175], v[78:81], v[86:89]
v_mfma_f32_16x16x32_bf16 v[90:93], v[172:175], v[82:85], v[90:93]
ds_read_b128 v[78:81], v2 offset:22528
ds_read_b128 v[82:85], v2 offset:38912
s_waitcnt lgkmcnt(4)
v_mfma_f32_16x16x32_bf16 v[86:89], v[176:179], v[62:65], v[86:89]
v_mfma_f32_16x16x32_bf16 v[90:93], v[176:179], v[66:69], v[90:93]
ds_read_b128 v[62:65], v2 offset:23552
ds_read_b128 v[66:69], v2 offset:39936
s_waitcnt lgkmcnt(4)
v_mfma_f32_16x16x32_bf16 v[86:89], v[180:183], v[70:73], v[86:89]
v_mfma_f32_16x16x32_bf16 v[90:93], v[180:183], v[74:77], v[90:93]
s_waitcnt lgkmcnt(2)
v_mfma_f32_16x16x32_bf16 v[86:89], v[184:187], v[78:81], v[86:89]
v_mfma_f32_16x16x32_bf16 v[90:93], v[184:187], v[82:85], v[90:93]
s_waitcnt lgkmcnt(0)
v_mfma_f32_16x16x32_bf16 v[86:89], v[188:191], v[62:65], v[86:89]
v_mfma_f32_16x16x32_bf16 v[90:93], v[188:191], v[66:69], v[90:93]
s_mov_b32 s41, 0xbdd2d3e8
v_mov_b32 v102, 0xc0135761
s_nop 2
v_mul_f32 v94, v86, v86
v_mul_f32 v95, v87, v87
v_mul_f32 v96, v88, v88
v_mul_f32 v97, v89, v89
v_mul_f32 v98, v90, v90
v_mul_f32 v99, v91, v91
v_mul_f32 v100, v92, v92
v_mul_f32 v101, v93, v93
v_fma_f32 v94, v94, s41, v102
v_fma_f32 v95, v95, s41, v102
v_fma_f32 v96, v96, s41, v102
v_fma_f32 v97, v97, s41, v102
v_fma_f32 v98, v98, s41, v102
v_fma_f32 v99, v99, s41, v102
v_fma_f32 v100, v100, s41, v102
v_fma_f32 v101, v101, s41, v102
v_mul_f32 v94, v94, v86
v_mul_f32 v95, v95, v87
v_mul_f32 v96, v96, v88
v_mul_f32 v97, v97, v89
v_mul_f32 v98, v98, v90
v_mul_f32 v99, v99, v91
v_mul_f32 v100, v100, v92
v_mul_f32 v101, v101, v93
v_exp_f32 v94, v94
v_exp_f32 v95, v95
v_exp_f32 v96, v96
v_exp_f32 v97, v97
v_exp_f32 v98, v98
v_exp_f32 v99, v99
v_exp_f32 v100, v100
v_exp_f32 v101, v101
v_add_f32 v94, 1.0, v94
v_add_f32 v95, 1.0, v95
v_add_f32 v96, 1.0, v96
v_add_f32 v97, 1.0, v97
v_add_f32 v98, 1.0, v98
v_add_f32 v99, 1.0, v99
v_add_f32 v100, 1.0, v100
v_add_f32 v101, 1.0, v101
v_rcp_f32 v94, v94
v_rcp_f32 v95, v95
v_rcp_f32 v96, v96
v_rcp_f32 v97, v97
v_rcp_f32 v98, v98
v_rcp_f32 v99, v99
v_rcp_f32 v100, v100
v_rcp_f32 v101, v101
v_mul_f32 v86, v86, v94
v_mul_f32 v87, v87, v95
v_mul_f32 v88, v88, v96
v_mul_f32 v89, v89, v97
v_mul_f32 v90, v90, v98
v_mul_f32 v91, v91, v99
v_mul_f32 v92, v92, v100
v_mul_f32 v93, v93, v101
v_cvt_pk_bf16_f32 v86, v86, v87
v_cvt_pk_bf16_f32 v87, v88, v89
ds_write_b64 v7, v[86:87] offset:0
v_cvt_pk_bf16_f32 v90, v90, v91
v_cvt_pk_bf16_f32 v91, v92, v93
ds_write_b64 v7, v[90:91] offset:2048
s_waitcnt lgkmcnt(0)
s_barrier
ds_read_b128 v[62:65], v2 offset:40960
ds_read_b128 v[66:69], v2 offset:41984
ds_read_b128 v[70:73], v2 offset:43008
ds_read_b128 v[74:77], v2 offset:44032
s_add_u32 s44, s50, 1310720
s_waitcnt lgkmcnt(0)
s_add_u32 s43, s44, 524288
v_mfma_f32_16x16x32_bf16 v[96:99], v[192:195], v[62:65], 0
v_mfma_f32_16x16x32_bf16 v[100:103], v[200:203], v[62:65], 0
v_mfma_f32_16x16x32_bf16 v[104:107], v[192:195], v[70:73], 0
v_mfma_f32_16x16x32_bf16 v[108:111], v[200:203], v[70:73], 0
v_mfma_f32_16x16x32_bf16 v[96:99], v[196:199], v[66:69], v[96:99]
v_mfma_f32_16x16x32_bf16 v[100:103], v[204:207], v[66:69], v[100:103]
v_mfma_f32_16x16x32_bf16 v[104:107], v[196:199], v[74:77], v[104:107]
v_mfma_f32_16x16x32_bf16 v[108:111], v[204:207], v[74:77], v[108:111]
v_mfma_f32_16x16x32_bf16 v[112:115], v[208:211], v[62:65], 0
v_mfma_f32_16x16x32_bf16 v[116:119], v[216:219], v[62:65], 0
v_mfma_f32_16x16x32_bf16 v[120:123], v[208:211], v[70:73], 0
v_cvt_pk_bf16_f32 v96, v96, v97
v_cvt_pk_bf16_f32 v97, v98, v99
v_mfma_f32_16x16x32_bf16 v[124:127], v[216:219], v[70:73], 0
v_cvt_pk_bf16_f32 v98, v100, v101
v_cvt_pk_bf16_f32 v99, v102, v103
v_mfma_f32_16x16x32_bf16 v[112:115], v[212:215], v[66:69], v[112:115]
buffer_store_dwordx4 v[96:99], v3, s[4:7], s44 offen offset:0
v_cvt_pk_bf16_f32 v104, v104, v105
v_mfma_f32_16x16x32_bf16 v[116:119], v[220:223], v[66:69], v[116:119]
v_cvt_pk_bf16_f32 v105, v106, v107
v_cvt_pk_bf16_f32 v106, v108, v109
v_mfma_f32_16x16x32_bf16 v[120:123], v[212:215], v[74:77], v[120:123]
v_cvt_pk_bf16_f32 v107, v110, v111
buffer_store_dwordx4 v[104:107], v3, s[4:7], s43 offen offset:0
v_mfma_f32_16x16x32_bf16 v[124:127], v[220:223], v[74:77], v[124:127]
v_mfma_f32_16x16x32_bf16 v[96:99], v[224:227], v[62:65], 0
v_mfma_f32_16x16x32_bf16 v[100:103], v[232:235], v[62:65], 0
v_mfma_f32_16x16x32_bf16 v[104:107], v[224:227], v[70:73], 0
v_cvt_pk_bf16_f32 v112, v112, v113
v_cvt_pk_bf16_f32 v113, v114, v115
v_mfma_f32_16x16x32_bf16 v[108:111], v[232:235], v[70:73], 0
v_cvt_pk_bf16_f32 v114, v116, v117
v_cvt_pk_bf16_f32 v115, v118, v119
v_mfma_f32_16x16x32_bf16 v[96:99], v[228:231], v[66:69], v[96:99]
buffer_store_dwordx4 v[112:115], v3, s[4:7], s44 offen offset:64
v_cvt_pk_bf16_f32 v120, v120, v121
v_mfma_f32_16x16x32_bf16 v[100:103], v[236:239], v[66:69], v[100:103]
v_cvt_pk_bf16_f32 v121, v122, v123
v_cvt_pk_bf16_f32 v122, v124, v125
v_mfma_f32_16x16x32_bf16 v[104:107], v[228:231], v[74:77], v[104:107]
v_cvt_pk_bf16_f32 v123, v126, v127
buffer_store_dwordx4 v[120:123], v3, s[4:7], s43 offen offset:64
v_mfma_f32_16x16x32_bf16 v[108:111], v[236:239], v[74:77], v[108:111]
v_mfma_f32_16x16x32_bf16 v[112:115], v[240:243], v[62:65], 0
v_mfma_f32_16x16x32_bf16 v[116:119], v[248:251], v[62:65], 0
v_mfma_f32_16x16x32_bf16 v[120:123], v[240:243], v[70:73], 0
v_cvt_pk_bf16_f32 v96, v96, v97
v_cvt_pk_bf16_f32 v97, v98, v99
v_mfma_f32_16x16x32_bf16 v[124:127], v[248:251], v[70:73], 0
v_cvt_pk_bf16_f32 v98, v100, v101
v_cvt_pk_bf16_f32 v99, v102, v103
v_mfma_f32_16x16x32_bf16 v[112:115], v[244:247], v[66:69], v[112:115]
buffer_store_dwordx4 v[96:99], v3, s[4:7], s44 offen offset:128
v_cvt_pk_bf16_f32 v104, v104, v105
v_mfma_f32_16x16x32_bf16 v[116:119], v[252:255], v[66:69], v[116:119]
v_cvt_pk_bf16_f32 v105, v106, v107
v_cvt_pk_bf16_f32 v106, v108, v109
v_mfma_f32_16x16x32_bf16 v[120:123], v[244:247], v[74:77], v[120:123]
v_cvt_pk_bf16_f32 v107, v110, v111
buffer_store_dwordx4 v[104:107], v3, s[4:7], s43 offen offset:128
v_mfma_f32_16x16x32_bf16 v[124:127], v[252:255], v[74:77], v[124:127]
v_cvt_pk_bf16_f32 v112, v112, v113
v_cvt_pk_bf16_f32 v113, v114, v115
v_cvt_pk_bf16_f32 v114, v116, v117
v_cvt_pk_bf16_f32 v115, v118, v119
buffer_store_dwordx4 v[112:115], v3, s[4:7], s44 offen offset:192
v_cvt_pk_bf16_f32 v120, v120, v121
v_cvt_pk_bf16_f32 v121, v122, v123
s_nop 0
v_cvt_pk_bf16_f32 v122, v124, v125
v_cvt_pk_bf16_f32 v123, v126, v127
buffer_store_dwordx4 v[120:123], v3, s[4:7], s43 offen offset:192
s_waitcnt vmcnt(0)
s_barrier
s_cmp_lg_u32 s33, 0
s_cbranch_scc1 L_pb38
s_lshl_b32 s41, s32, 7
s_add_u32 s41, s41, s76
s_add_u32 s41, s41, 8192
v_mov_b32 v62, s77
buffer_store_dword v62, off, s[4:7], s41
L_pb38:
L_nomlp_f:
L_mlpd_f:
s_cmp_ge_u32 s72, 64
s_cbranch_scc1 L_noq_f
s_lshl_b32 s74, s72, 5
s_add_u32 s75, s74, s32
s_lshl_b32 s74, s75, 10
s_lshl_b32 s41, s33, 8
s_add_u32 s74, s74, s41
s_cmp_gt_u32 s45, s72
s_cbranch_scc1 L_kr39
s_lshl_b32 s43, s32, 8
s_add_u32 s43, s43, 51380224
v_lshrrev_b32 v64, 2, v1
L_krl39:
buffer_load_dword v63, v64, s[4:7], s43 offen sc1
s_add_u32 s51, s51, 1
s_cmp_gt_u32 s51, 300000
s_cbranch_scc1 L_end
s_waitcnt vmcnt(0)
v_cmp_eq_u32 vcc, 0, v63
s_ff1_i32_b64 s45, vcc
s_min_u32 s45, s45, 64
s_cmp_gt_u32 s45, s72
s_cbranch_scc0 L_krl39
L_kr39:
s_waitcnt vmcnt(0)
s_lshl_b32 s41, s75, 14
s_lshl_b32 s42, s33, 12
s_add_u32 s41, s41, s42
s_add_u32 s57, s42, 32768
s_mov_b32 s56, s41
buffer_load_dwordx2 v[60:61], v6, s[24:27], s74 offen
s_barrier
ds_read_b128 v[62:65], v1 offset:0
ds_read_b128 v[66:69], v1 offset:16384
ds_read_b128 v[70:73], v1 offset:1024
ds_read_b128 v[74:77], v1 offset:17408
ds_read_b128 v[78:81], v1 offset:2048
ds_read_b128 v[82:85], v1 offset:18432
s_waitcnt lgkmcnt(4)
v_mfma_f32_16x16x32_bf16 v[86:89], a[0:3], v[62:65], 0
v_mfma_f32_16x16x32_bf16 v[90:93], a[64:67], v[62:65], 0
v_mfma_f32_16x16x32_bf16 v[94:97], a[0:3], v[66:69], 0
v_mfma_f32_16x16x32_bf16 v[98:101], a[64:67], v[66:69], 0
ds_read_b128 v[62:65], v1 offset:3072
ds_read_b128 v[66:69], v1 offset:19456
s_waitcnt lgkmcnt(4)
v_mfma_f32_16x16x32_bf16 v[86:89], a[4:7], v[70:73], v[86:89]
v_mfma_f32_16x16x32_bf16 v[90:93], a[68:71], v[70:73], v[90:93]
v_mfma_f32_16x16x32_bf16 v[94:97], a[4:7], v[74:77], v[94:97]
v_mfma_f32_16x16x32_bf16 v[98:101], a[68:71], v[74:77], v[98:101]
s_mov_b32 m0, s57
s_nop 0
buffer_load_dwordx4 v1, s[4:7], s56 offen offset:0 sc1 lds
ds_read_b128 v[70:73], v1 offset:4096
ds_read_b128 v[74:77], v1 offset:20480
s_waitcnt lgkmcnt(4)
v_mfma_f32_16x16x32_bf16 v[86:89], a[8:11], v[78:81], v[86:89]
v_mfma_f32_16x16x32_bf16 v[90:93], a[72:75], v[78:81], v[90:93]
v_mfma_f32_16x16x32_bf16 v[94:97], a[8:11], v[82:85], v[94:97]
v_mfma_f32_16x16x32_bf16 v[98:101], a[72:75], v[82:85], v[98:101]
ds_read_b128 v[78:81], v1 offset:5120
ds_read_b128 v[82:85], v1 offset:21504
s_waitcnt lgkmcnt(4)
v_mfma_f32_16x16x32_bf16 v[86:89], a[12:15], v[62:65], v[86:89]
v_mfma_f32_16x16x32_bf16 v[90:93], a[76:79], v[62:65], v[90:93]
v_mfma_f32_16x16x32_bf16 v[94:97], a[12:15], v[66:69], v[94:97]
v_mfma_f32_16x16x32_bf16 v[98:101], a[76:79], v[66:69], v[98:101]
ds_read_b128 v[62:65], v1 offset:6144
ds_read_b128 v[66:69], v1 offset:22528
s_waitcnt lgkmcnt(4)
v_mfma_f32_16x16x32_bf16 v[86:89], a[16:19], v[70:73], v[86:89]
v_mfma_f32_16x16x32_bf16 v[90:93], a[80:83], v[70:73], v[90:93]
v_mfma_f32_16x16x32_bf16 v[94:97], a[16:19], v[74:77], v[94:97]
v_mfma_f32_16x16x32_bf16 v[98:101], a[80:83], v[74:77], v[98:101]
buffer_load_dwordx4 v1, s[4:7], s56 offen offset:1024 sc1 lds
ds_read_b128 v[70:73], v1 offset:7168
ds_read_b128 v[74:77], v1 offset:23552
s_waitcnt lgkmcnt(4)
v_mfma_f32_16x16x32_bf16 v[86:89], a[20:23], v[78:81], v[86:89]
v_mfma_f32_16x16x32_bf16 v[90:93], a[84:87], v[78:81], v[90:93]
v_mfma_f32_16x16x32_bf16 v[94:97], a[20:23], v[82:85], v[94:97]
v_mfma_f32_16x16x32_bf16 v[98:101], a[84:87], v[82:85], v[98:101]
ds_read_b128 v[78:81], v1 offset:8192
ds_read_b128 v[82:85], v1 offset:24576
s_waitcnt lgkmcnt(4)
v_mfma_f32_16x16x32_bf16 v[86:89], a[24:27], v[62:65], v[86:89]
v_mfma_f32_16x16x32_bf16 v[90:93], a[88:91], v[62:65], v[90:93]
v_mfma_f32_16x16x32_bf16 v[94:97], a[24:27], v[66:69], v[94:97]
v_mfma_f32_16x16x32_bf16 v[98:101], a[88:91], v[66:69], v[98:101]
ds_read_b128 v[62:65], v1 offset:9216
ds_read_b128 v[66:69], v1 offset:25600
s_waitcnt lgkmcnt(4)
v_mfma_f32_16x16x32_bf16 v[86:89], a[28:31], v[70:73], v[86:89]
v_mfma_f32_16x16x32_bf16 v[90:93], a[92:95], v[70:73], v[90:93]
v_mfma_f32_16x16x32_bf16 v[94:97], a[28:31], v[74:77], v[94:97]
v_mfma_f32_16x16x32_bf16 v[98:101], a[92:95], v[74:77], v[98:101]
buffer_load_dwordx4 v1, s[4:7], s56 offen offset:2048 sc1 lds
ds_read_b128 v[70:73], v1 offset:10240
ds_read_b128 v[74:77], v1 offset:26624
s_waitcnt lgkmcnt(4)
v_mfma_f32_16x16x32_bf16 v[86:89], a[32:35], v[78:81], v[86:89]
v_mfma_f32_16x16x32_bf16 v[90:93], a[96:99], v[78:81], v[90:93]
v_mfma_f32_16x16x32_bf16 v[94:97], a[32:35], v[82:85], v[94:97]
v_mfma_f32_16x16x32_bf16 v[98:101], a[96:99], v[82:85], v[98:101]
ds_read_b128 v[78:81], v1 offset:11264
ds_read_b128 v[82:85], v1 offset:27648
s_waitcnt lgkmcnt(4)
v_mfma_f32_16x16x32_bf16 v[86:89], a[36:39], v[62:65], v[86:89]
v_mfma_f32_16x16x32_bf16 v[90:93], a[100:103], v[62:65], v[90:93]
v_mfma_f32_16x16x32_bf16 v[94:97], a[36:39], v[66:69], v[94:97]
v_mfma_f32_16x16x32_bf16 v[98:101], a[100:103], v[66:69], v[98:101]
ds_read_b128 v[62:65], v1 offset:12288
ds_read_b128 v[66:69], v1 offset:28672
s_waitcnt lgkmcnt(4)
v_mfma_f32_16x16x32_bf16 v[86:89], a[40:43], v[70:73], v[86:89]
v_mfma_f32_16x16x32_bf16 v[90:93], a[104:107], v[70:73], v[90:93]
v_mfma_f32_16x16x32_bf16 v[94:97], a[40:43], v[74:77], v[94:97]
v_mfma_f32_16x16x32_bf16 v[98:101], a[104:107], v[74:77], v[98:101]
buffer_load_dwordx4 v1, s[4:7], s56 offen offset:3072 sc1 lds
ds_read_b128 v[70:73], v1 offset:13312
ds_read_b128 v[74:77], v1 offset:29696
s_waitcnt lgkmcnt(4)
v_mfma_f32_16x16x32_bf16 v[86:89], a[44:47], v[78:81], v[86:89]
v_mfma_f32_16x16x32_bf16 v[90:93], a[108:111], v[78:81], v[90:93]
v_mfma_f32_16x16x32_bf16 v[94:97], a[44:47], v[82:85], v[94:97]
v_mfma_f32_16x16x32_bf16 v[98:101], a[108:111], v[82:85], v[98:101]
ds_read_b128 v[78:81], v1 offset:14336
ds_read_b128 v[82:85], v1 offset:30720
s_waitcnt lgkmcnt(4)
v_mfma_f32_16x16x32_bf16 v[86:89], a[48:51], v[62:65], v[86:89]
v_mfma_f32_16x16x32_bf16 v[90:93], a[112:115], v[62:65], v[90:93]
v_mfma_f32_16x16x32_bf16 v[94:97], a[48:51], v[66:69], v[94:97]
v_mfma_f32_16x16x32_bf16 v[98:101], a[112:115], v[66:69], v[98:101]
ds_read_b128 v[62:65], v1 offset:15360
ds_read_b128 v[66:69], v1 offset:31744
s_waitcnt lgkmcnt(4)
v_mfma_f32_16x16x32_bf16 v[86:89], a[52:55], v[70:73], v[86:89]
v_mfma_f32_16x16x32_bf16 v[90:93], a[116:119], v[70:73], v[90:93]
v_mfma_f32_16x16x32_bf16 v[94:97], a[52:55], v[74:77], v[94:97]
v_mfma_f32_16x16x32_bf16 v[98:101], a[116:119], v[74:77], v[98:101]
s_waitcnt lgkmcnt(2)
v_mfma_f32_16x16x32_bf16 v[86:89], a[56:59], v[78:81], v[86:89]
v_mfma_f32_16x16x32_bf16 v[90:93], a[120:123], v[78:81], v[90:93]
v_mfma_f32_16x16x32_bf16 v[94:97], a[56:59], v[82:85], v[94:97]
v_mfma_f32_16x16x32_bf16 v[98:101], a[120:123], v[82:85], v[98:101]
s_waitcnt lgkmcnt(0)
v_mfma_f32_16x16x32_bf16 v[86:89], a[60:63], v[62:65], v[86:89]
v_mfma_f32_16x16x32_bf16 v[90:93], a[124:127], v[62:65], v[90:93]
v_mfma_f32_16x16x32_bf16 v[94:97], a[60:63], v[66:69], v[94:97]
v_mfma_f32_16x16x32_bf16 v[98:101], a[124:127], v[66:69], v[98:101]
s_lshl_b32 s41, s33, 10
v_add_u32 v62, s41, v1
v_cvt_pk_bf16_f32 v86, v86, v87
v_cvt_pk_bf16_f32 v87, v88, v89
v_cvt_pk_bf16_f32 v88, v90, v91
v_cvt_pk_bf16_f32 v89, v92, v93
ds_write_b128 v62, v[86:89] offset:57344
v_cvt_pk_bf16_f32 v94, v94, v95
v_cvt_pk_bf16_f32 v95, v96, v97
v_cvt_pk_bf16_f32 v96, v98, v99
v_cvt_pk_bf16_f32 v97, v100, v101
ds_write_b128 v62, v[94:97] offset:61440
L_noq_f:
s_cmp_lg_u32 s33, 0
s_cbranch_scc1 L_aw40
v_lshlrev_b32 v63, 3, v1
s_add_u32 s41, s76, 8192
s_mov_b64 exec, 0xfffffff
L_awl40:
buffer_load_dword v62, v63, s[4:7], s41 offen sc1
s_add_u32 s51, s51, 1
s_cmp_gt_u32 s51, 300000
s_cbranch_scc1 L_end
s_waitcnt vmcnt(0)
v_cmp_ne_u32 vcc, s77, v62
s_cbranch_vccz L_awd40
s_sleep 1
s_branch L_awl40
L_awd40:
s_mov_b64 exec, -1
L_aw40:
s_barrier
s_mov_b32 s41, s48
buffer_load_dwordx4 v[62:65], v4, s[4:7], s41 offen sc1
s_add_u32 s41, s41, 4096
buffer_load_dwordx4 v[66:69], v4, s[4:7], s41 offen sc1
s_add_u32 s41, s41, 4096
buffer_load_dwordx4 v[70:73], v4, s[4:7], s41 offen sc1
s_add_u32 s41, s41, 4096
buffer_load_dwordx4 v[74:77], v4, s[4:7], s41 offen sc1
s_add_u32 s41, s41, 4096
buffer_load_dwordx4 v[78:81], v4, s[4:7], s41 offen sc1
s_add_u32 s41, s41, 4096
buffer_load_dwordx4 v[82:85], v4, s[4:7], s41 offen sc1
s_add_u32 s41, s41, 4096
buffer_load_dwordx4 v[86:89], v4, s[4:7], s41 offen sc1
s_waitcnt vmcnt(6)
v_mfma_f32_16x16x32_bf16 v[96:99], v[36:39], v[62:65], 0
s_waitcnt vmcnt(5)
v_mfma_f32_16x16x32_bf16 v[96:99], v[36:39], v[66:69], v[96:99]
s_waitcnt vmcnt(4)
v_mfma_f32_16x16x32_bf16 v[96:99], v[36:39], v[70:73], v[96:99]
s_waitcnt vmcnt(3)
v_mfma_f32_16x16x32_bf16 v[96:99], v[36:39], v[74:77], v[96:99]
s_waitcnt vmcnt(2)
v_mfma_f32_16x16x32_bf16 v[96:99], v[36:39], v[78:81], v[96:99]
s_waitcnt vmcnt(1)
v_mfma_f32_16x16x32_bf16 v[96:99], v[36:39], v[82:85], v[96:99]
s_waitcnt vmcnt(0)
v_mfma_f32_16x16x32_bf16 v[96:99], v[36:39], v[86:89], v[96:99]
s_mov_b64 exec, s[38:39]
s_nop 6
v_add_f32 v96, v96, v28
v_add_f32 v97, v97, v29
v_add_f32 v98, v98, v30
v_add_f32 v99, v99, v31
v_fmac_f32 v56, v96, v24
v_fmac_f32 v57, v97, v25
v_fmac_f32 v58, v98, v26
v_fmac_f32 v59, v99, v27
v_cvt_pk_bf16_f32 v96, v56, v57
v_cvt_pk_bf16_f32 v97, v58, v59
buffer_store_dwordx2 v[96:97], v6, s[60:63], s52 offen
s_mov_b64 exec, -1
s_mov_b32 s35, s72
s_cmp_ge_u32 s35, 64
s_cbranch_scc1 L_postend_f
s_branch L_post_f
L_postend_f:
s_branch L_end
L_pl_s:
s_lshl_b32 s41, s58, 2
s_cmp_lg_u32 s33, 0
s_cbranch_scc1 L_w141
L_wg42:
buffer_load_dword v62, off, s[28:31], s41 offset:64 sc1
s_add_u32 s51, s51, 1
s_cmp_gt_u32 s51, 300000
s_cbranch_scc1 L_end
s_waitcnt vmcnt(0)
v_readfirstlane_b32 s40, v62
s_cmp_ge_u32 s40, 32
s_cbranch_scc1 L_wd42
s_sleep 4
s_branch L_wg42
L_wd42:
L_w141:
s_barrier
s_mov_b32 s45, 0
v_lshrrev_b32 v64, 1, v1
s_mov_b32 s41, 51404800
L_wh43:
buffer_load_dwordx2 v[62:63], v64, s[4:7], s41 offen sc1
s_add_u32 s51, s51, 1
s_cmp_gt_u32 s51, 300000
s_cbranch_scc1 L_end
s_waitcnt vmcnt(0)
v_min_u32 v62, v62, v63
v_cmp_eq_u32 vcc, 0, v62
s_cbranch_vccz L_whd43
s_sleep 4
s_branch L_wh43
L_whd43:
s_lshl_b32 s56, s35, 15
s_lshl_b32 s57, s33, 13
s_add_u32 s56, s56, s57
s_add_u32 s56, s56, 48234496
s_add_u32 s68, s56, 4096
s_add_u32 s69, s57, 4096
s_mov_b32 m0, s57
s_nop 0
buffer_load_dwordx4 v1, s[4:7], s56 offen offset:0 sc1 lds
buffer_load_dwordx4 v1, s[4:7], s56 offen offset:1024 sc1 lds
buffer_load_dwordx4 v1, s[4:7], s56 offen offset:2048 sc1 lds
buffer_load_dwordx4 v1, s[4:7], s56 offen offset:3072 sc1 lds
s_mov_b32 m0, s69
s_nop 0
buffer_load_dwordx4 v1, s[4:7], s68 offen offset:0 sc1 lds
buffer_load_dwordx4 v1, s[4:7], s68 offen offset:1024 sc1 lds
buffer_load_dwordx4 v1, s[4:7], s68 offen offset:2048 sc1 lds
buffer_load_dwordx4 v1, s[4:7], s68 offen offset:3072 sc1 lds
s_lshl_b32 s74, s35, 5
s_add_u32 s75, s74, s32
s_lshl_b32 s74, s75, 10
s_lshl_b32 s41, s33, 8
s_add_u32 s74, s74, s41
s_cmp_gt_u32 s45, s35
s_cbranch_scc1 L_kr44
s_lshl_b32 s43, s32, 8
s_add_u32 s43, s43, 51380224
v_lshrrev_b32 v64, 2, v1
L_krl44:
buffer_load_dword v63, v64, s[4:7], s43 offen sc1
s_add_u32 s51, s51, 1
s_cmp_gt_u32 s51, 300000
s_cbranch_scc1 L_end
s_waitcnt vmcnt(0)
v_cmp_eq_u32 vcc, 0, v63
s_ff1_i32_b64 s45, vcc
s_min_u32 s45, s45, 64
s_cmp_gt_u32 s45, s35
s_cbranch_scc0 L_krl44
L_kr44:
s_waitcnt vmcnt(0)
s_lshl_b32 s41, s75, 14
s_lshl_b32 s42, s33, 12
s_add_u32 s41, s41, s42
s_add_u32 s57, s42, 32768
s_mov_b32 s56, s41
buffer_load_dwordx2 v[60:61], v6, s[24:27], s74 offen
s_barrier
ds_read_b128 v[62:65], v1 offset:0
ds_read_b128 v[66:69], v1 offset:16384
ds_read_b128 v[70:73], v1 offset:1024
ds_read_b128 v[74:77], v1 offset:17408
ds_read_b128 v[78:81], v1 offset:2048
ds_read_b128 v[82:85], v1 offset:18432
s_waitcnt lgkmcnt(4)
v_mfma_f32_16x16x32_bf16 v[86:89], a[0:3], v[62:65], 0
v_mfma_f32_16x16x32_bf16 v[90:93], a[64:67], v[62:65], 0
v_mfma_f32_16x16x32_bf16 v[94:97], a[0:3], v[66:69], 0
v_mfma_f32_16x16x32_bf16 v[98:101], a[64:67], v[66:69], 0
ds_read_b128 v[62:65], v1 offset:3072
ds_read_b128 v[66:69], v1 offset:19456
s_waitcnt lgkmcnt(4)
v_mfma_f32_16x16x32_bf16 v[86:89], a[4:7], v[70:73], v[86:89]
v_mfma_f32_16x16x32_bf16 v[90:93], a[68:71], v[70:73], v[90:93]
v_mfma_f32_16x16x32_bf16 v[94:97], a[4:7], v[74:77], v[94:97]
v_mfma_f32_16x16x32_bf16 v[98:101], a[68:71], v[74:77], v[98:101]
s_mov_b32 m0, s57
s_nop 0
buffer_load_dwordx4 v1, s[4:7], s56 offen offset:0 sc1 lds
ds_read_b128 v[70:73], v1 offset:4096
ds_read_b128 v[74:77], v1 offset:20480
s_waitcnt lgkmcnt(4)
v_mfma_f32_16x16x32_bf16 v[86:89], a[8:11], v[78:81], v[86:89]
v_mfma_f32_16x16x32_bf16 v[90:93], a[72:75], v[78:81], v[90:93]
v_mfma_f32_16x16x32_bf16 v[94:97], a[8:11], v[82:85], v[94:97]
v_mfma_f32_16x16x32_bf16 v[98:101], a[72:75], v[82:85], v[98:101]
ds_read_b128 v[78:81], v1 offset:5120
ds_read_b128 v[82:85], v1 offset:21504
s_waitcnt lgkmcnt(4)
v_mfma_f32_16x16x32_bf16 v[86:89], a[12:15], v[62:65], v[86:89]
v_mfma_f32_16x16x32_bf16 v[90:93], a[76:79], v[62:65], v[90:93]
v_mfma_f32_16x16x32_bf16 v[94:97], a[12:15], v[66:69], v[94:97]
v_mfma_f32_16x16x32_bf16 v[98:101], a[76:79], v[66:69], v[98:101]
ds_read_b128 v[62:65], v1 offset:6144
ds_read_b128 v[66:69], v1 offset:22528
s_waitcnt lgkmcnt(4)
v_mfma_f32_16x16x32_bf16 v[86:89], a[16:19], v[70:73], v[86:89]
v_mfma_f32_16x16x32_bf16 v[90:93], a[80:83], v[70:73], v[90:93]
v_mfma_f32_16x16x32_bf16 v[94:97], a[16:19], v[74:77], v[94:97]
v_mfma_f32_16x16x32_bf16 v[98:101], a[80:83], v[74:77], v[98:101]
buffer_load_dwordx4 v1, s[4:7], s56 offen offset:1024 sc1 lds
ds_read_b128 v[70:73], v1 offset:7168
ds_read_b128 v[74:77], v1 offset:23552
s_waitcnt lgkmcnt(4)
v_mfma_f32_16x16x32_bf16 v[86:89], a[20:23], v[78:81], v[86:89]
v_mfma_f32_16x16x32_bf16 v[90:93], a[84:87], v[78:81], v[90:93]
v_mfma_f32_16x16x32_bf16 v[94:97], a[20:23], v[82:85], v[94:97]
v_mfma_f32_16x16x32_bf16 v[98:101], a[84:87], v[82:85], v[98:101]
ds_read_b128 v[78:81], v1 offset:8192
ds_read_b128 v[82:85], v1 offset:24576
s_waitcnt lgkmcnt(4)
v_mfma_f32_16x16x32_bf16 v[86:89], a[24:27], v[62:65], v[86:89]
v_mfma_f32_16x16x32_bf16 v[90:93], a[88:91], v[62:65], v[90:93]
v_mfma_f32_16x16x32_bf16 v[94:97], a[24:27], v[66:69], v[94:97]
v_mfma_f32_16x16x32_bf16 v[98:101], a[88:91], v[66:69], v[98:101]
ds_read_b128 v[62:65], v1 offset:9216
ds_read_b128 v[66:69], v1 offset:25600
s_waitcnt lgkmcnt(4)
v_mfma_f32_16x16x32_bf16 v[86:89], a[28:31], v[70:73], v[86:89]
v_mfma_f32_16x16x32_bf16 v[90:93], a[92:95], v[70:73], v[90:93]
v_mfma_f32_16x16x32_bf16 v[94:97], a[28:31], v[74:77], v[94:97]
v_mfma_f32_16x16x32_bf16 v[98:101], a[92:95], v[74:77], v[98:101]
buffer_load_dwordx4 v1, s[4:7], s56 offen offset:2048 sc1 lds
ds_read_b128 v[70:73], v1 offset:10240
ds_read_b128 v[74:77], v1 offset:26624
s_waitcnt lgkmcnt(4)
v_mfma_f32_16x16x32_bf16 v[86:89], a[32:35], v[78:81], v[86:89]
v_mfma_f32_16x16x32_bf16 v[90:93], a[96:99], v[78:81], v[90:93]
v_mfma_f32_16x16x32_bf16 v[94:97], a[32:35], v[82:85], v[94:97]
v_mfma_f32_16x16x32_bf16 v[98:101], a[96:99], v[82:85], v[98:101]
ds_read_b128 v[78:81], v1 offset:11264
ds_read_b128 v[82:85], v1 offset:27648
s_waitcnt lgkmcnt(4)
v_mfma_f32_16x16x32_bf16 v[86:89], a[36:39], v[62:65], v[86:89]
v_mfma_f32_16x16x32_bf16 v[90:93], a[100:103], v[62:65], v[90:93]
v_mfma_f32_16x16x32_bf16 v[94:97], a[36:39], v[66:69], v[94:97]
v_mfma_f32_16x16x32_bf16 v[98:101], a[100:103], v[66:69], v[98:101]
ds_read_b128 v[62:65], v1 offset:12288
ds_read_b128 v[66:69], v1 offset:28672
s_waitcnt lgkmcnt(4)
v_mfma_f32_16x16x32_bf16 v[86:89], a[40:43], v[70:73], v[86:89]
v_mfma_f32_16x16x32_bf16 v[90:93], a[104:107], v[70:73], v[90:93]
v_mfma_f32_16x16x32_bf16 v[94:97], a[40:43], v[74:77], v[94:97]
v_mfma_f32_16x16x32_bf16 v[98:101], a[104:107], v[74:77], v[98:101]
buffer_load_dwordx4 v1, s[4:7], s56 offen offset:3072 sc1 lds
ds_read_b128 v[70:73], v1 offset:13312
ds_read_b128 v[74:77], v1 offset:29696
s_waitcnt lgkmcnt(4)
v_mfma_f32_16x16x32_bf16 v[86:89], a[44:47], v[78:81], v[86:89]
v_mfma_f32_16x16x32_bf16 v[90:93], a[108:111], v[78:81], v[90:93]
v_mfma_f32_16x16x32_bf16 v[94:97], a[44:47], v[82:85], v[94:97]
v_mfma_f32_16x16x32_bf16 v[98:101], a[108:111], v[82:85], v[98:101]
ds_read_b128 v[78:81], v1 offset:14336
ds_read_b128 v[82:85], v1 offset:30720
s_waitcnt lgkmcnt(4)
v_mfma_f32_16x16x32_bf16 v[86:89], a[48:51], v[62:65], v[86:89]
v_mfma_f32_16x16x32_bf16 v[90:93], a[112:115], v[62:65], v[90:93]
v_mfma_f32_16x16x32_bf16 v[94:97], a[48:51], v[66:69], v[94:97]
v_mfma_f32_16x16x32_bf16 v[98:101], a[112:115], v[66:69], v[98:101]
ds_read_b128 v[62:65], v1 offset:15360
ds_read_b128 v[66:69], v1 offset:31744
s_waitcnt lgkmcnt(4)
v_mfma_f32_16x16x32_bf16 v[86:89], a[52:55], v[70:73], v[86:89]
v_mfma_f32_16x16x32_bf16 v[90:93], a[116:119], v[70:73], v[90:93]
v_mfma_f32_16x16x32_bf16 v[94:97], a[52:55], v[74:77], v[94:97]
v_mfma_f32_16x16x32_bf16 v[98:101], a[116:119], v[74:77], v[98:101]
s_waitcnt lgkmcnt(2)
v_mfma_f32_16x16x32_bf16 v[86:89], a[56:59], v[78:81], v[86:89]
v_mfma_f32_16x16x32_bf16 v[90:93], a[120:123], v[78:81], v[90:93]
v_mfma_f32_16x16x32_bf16 v[94:97], a[56:59], v[82:85], v[94:97]
v_mfma_f32_16x16x32_bf16 v[98:101], a[120:123], v[82:85], v[98:101]
s_waitcnt lgkmcnt(0)
v_mfma_f32_16x16x32_bf16 v[86:89], a[60:63], v[62:65], v[86:89]
v_mfma_f32_16x16x32_bf16 v[90:93], a[124:127], v[62:65], v[90:93]
v_mfma_f32_16x16x32_bf16 v[94:97], a[60:63], v[66:69], v[94:97]
v_mfma_f32_16x16x32_bf16 v[98:101], a[124:127], v[66:69], v[98:101]
s_lshl_b32 s41, s33, 10
v_add_u32 v62, s41, v1
v_cvt_pk_bf16_f32 v86, v86, v87
v_cvt_pk_bf16_f32 v87, v88, v89
v_cvt_pk_bf16_f32 v88, v90, v91
v_cvt_pk_bf16_f32 v89, v92, v93
ds_write_b128 v62, v[86:89] offset:57344
v_cvt_pk_bf16_f32 v94, v94, v95
v_cvt_pk_bf16_f32 v95, v96, v97
v_cvt_pk_bf16_f32 v96, v98, v99
v_cvt_pk_bf16_f32 v97, v100, v101
ds_write_b128 v62, v[94:97] offset:61440
L_post_s:
s_add_u32 s72, s35, 5
s_cmp_lt_u32 s72, 65
s_cselect_b32 s72, s72, s73
s_add_u32 s41, s35, 7
s_cmp_ge_u32 s35, 65
s_cselect_b32 s72, s41, s72
s_mov_b32 s52, s74
s_add_u32 s77, s35, 1
s_mov_b32 s53, s75
s_lshl_b32 s43, s32, 7
s_add_u32 s43, s43, s35
s_lshl_b32 s43, s43, 2
s_add_u32 s43, s43, 51388420
L_wg45:
buffer_load_dword v63, off, s[4:7], s43 offset:0 sc1
s_add_u32 s51, s51, 1
s_cmp_gt_u32 s51, 300000
s_cbranch_scc1 L_end
s_waitcnt vmcnt(0)
v_readfirstlane_b32 s40, v63
s_cmp_ge_u32 s40, 1
s_cbranch_scc1 L_wd45
s_sleep 4
s_branch L_wg45
L_wd45:
s_lshl_b32 s41, s53, 12
s_lshl_b32 s42, s33, 10
s_add_u32 s41, s41, s42
s_add_u32 s41, s41, 33554432
s_add_u32 s42, s42, 49152
s_mov_b32 s56, s41
s_mov_b32 s57, s42
s_mov_b32 m0, s57
s_nop 0
buffer_load_dwordx4 v1, s[4:7], s56 offen offset:0 sc1 lds
s_and_b32 s42, s33, 1
s_lshl_b32 s42, s42, 10
s_lshl_b32 s41, s53, 11
s_add_u32 s41, s41, s42
s_add_u32 s41, s41, 41943040
s_add_u32 s42, s42, 53248
s_mov_b32 s56, s41
s_mov_b32 s57, s42
s_mov_b32 m0, s57
s_nop 0
buffer_load_dwordx4 v1, s[4:7], s56 offen offset:0 sc1 lds
s_waitcnt vmcnt(0) lgkmcnt(0)
s_barrier
s_min_u32 s44, s72, 63
s_lshl_b32 s56, s44, 15
s_lshl_b32 s57, s33, 13
s_add_u32 s56, s56, s57
s_add_u32 s56, s56, 48234496
s_add_u32 s68, s56, 4096
s_add_u32 s69, s57, 4096
s_cmp_ge_u32 s72, 64
ds_read_b128 v[62:65], v8 offset:57344
ds_read_b128 v[66:69], v8 offset:58368
ds_read_b128 v[70:73], v8 offset:59392
ds_read_b128 v[74:77], v8 offset:60416
ds_read_b128 v[78:81], v1 offset:49152
ds_read_b128 v[82:85], v1 offset:50176
ds_read_b128 v[86:89], v1 offset:51200
ds_read_b128 v[90:93], v1 offset:52224
ds_read_b128 v[94:97], v1 offset:32768
ds_read_b128 v[98:101], v1 offset:33792
ds_read_b128 v[102:105], v1 offset:34816
ds_read_b128 v[106:109], v1 offset:35840
s_cbranch_scc1 L_nx46
s_mov_b32 m0, s57
s_nop 0
buffer_load_dwordx4 v1, s[4:7], s56 offen offset:0 sc1 lds
L_nx46:
s_waitcnt lgkmcnt(4)
v_mfma_f32_16x16x32_bf16 v[118:121], v[78:81], v[62:65], 0
v_mfma_f32_16x16x32_bf16 v[118:121], v[82:85], v[66:69], v[118:121]
v_mfma_f32_16x16x32_bf16 v[118:121], v[86:89], v[70:73], v[118:121]
v_mfma_f32_16x16x32_bf16 v[118:121], v[90:93], v[74:77], v[118:121]
ds_read_b128 v[78:81], v1 offset:36864
ds_read_b128 v[82:85], v1 offset:37888
ds_read_b128 v[86:89], v1 offset:38912
ds_read_b128 v[90:93], v1 offset:39936
s_waitcnt lgkmcnt(4)
v_mfma_f32_16x16x32_bf16 v[110:113], v[94:97], v[62:65], v[44:47]
v_mfma_f32_16x16x32_bf16 v[110:113], v[98:101], v[66:69], v[110:113]
s_cbranch_scc1 L_nx47
buffer_load_dwordx4 v1, s[4:7], s56 offen offset:1024 sc1 lds
L_nx47:
v_mfma_f32_16x16x32_bf16 v[110:113], v[102:105], v[70:73], v[110:113]
v_mfma_f32_16x16x32_bf16 v[110:113], v[106:109], v[74:77], v[110:113]
ds_read_b128 v[94:97], v9 offset:40960
ds_read_b128 v[98:101], v9 offset:41984
ds_read_b128 v[102:105], v9 offset:43008
ds_read_b128 v[106:109], v9 offset:44032
ds_read_b64 v[124:125], v10 offset:53248
ds_read_b64 v[126:127], v10 offset:53760
s_waitcnt lgkmcnt(6)
v_mfma_f32_16x16x32_bf16 v[114:117], v[78:81], v[62:65], v[48:51]
v_mfma_f32_16x16x32_bf16 v[114:117], v[82:85], v[66:69], v[114:117]
v_mfma_f32_16x16x32_bf16 v[114:117], v[86:89], v[70:73], v[114:117]
s_cbranch_scc1 L_nx48
buffer_load_dwordx4 v1, s[4:7], s56 offen offset:2048 sc1 lds
L_nx48:
v_mfma_f32_16x16x32_bf16 v[114:117], v[90:93], v[74:77], v[114:117]
v_max3_f32 v122, v118, v119, v110
v_max3_f32 v122, v122, v111, v112
s_nop 5
v_max3_f32 v122, v122, v113, v114
v_max3_f32 v122, v122, v115, v116
v_max_f32 v122, v122, v117
v_mov_b32 v123, v122
s_nop 1
v_permlane16_swap_b32 v122, v123
v_max_f32 v122, v122, v123
v_mov_b32 v123, v122
s_nop 1
v_permlane32_swap_b32 v122, v123
v_max_f32 v122, v122, v123
s_cbranch_scc1 L_nx49
buffer_load_dwordx4 v1, s[4:7], s56 offen offset:3072 sc1 lds
L_nx49:
v_mul_f32 v122, s46, v122
v_fma_f32 v110, v110, s46, -v122
v_fma_f32 v111, v111, s46, -v122
v_fma_f32 v112, v112, s46, -v122
v_fma_f32 v113, v113, s46, -v122
v_fma_f32 v114, v114, s46, -v122
v_fma_f32 v115, v115, s46, -v122
v_fma_f32 v116, v116, s46, -v122
v_fma_f32 v117, v117, s46, -v122
v_fma_f32 v118, v118, s46, -v122
v_fma_f32 v119, v119, s46, -v122
v_exp_f32 v110, v110
s_cbranch_scc1 L_nx50
s_mov_b32 m0, s69
s_nop 0
buffer_load_dwordx4 v1, s[4:7], s68 offen offset:0 sc1 lds
L_nx50:
v_exp_f32 v111, v111
v_exp_f32 v112, v112
v_exp_f32 v113, v113
v_exp_f32 v114, v114
v_exp_f32 v115, v115
v_exp_f32 v116, v116
v_exp_f32 v117, v117
v_exp_f32 v118, v118
v_exp_f32 v119, v119
v_cvt_pk_bf16_f32 v62, v110, v111
v_cvt_pk_bf16_f32 v63, v112, v113
v_cvt_pk_bf16_f32 v64, v114, v115
s_cbranch_scc1 L_nx51
buffer_load_dwordx4 v1, s[4:7], s68 offen offset:1024 sc1 lds
L_nx51:
v_cvt_pk_bf16_f32 v65, v116, v117
v_cvt_pk_bf16_f32 v52, v118, v119
v_cvt_pk_bf16_f32 v55, v118, v119
s_waitcnt lgkmcnt(0)
v_mfma_f32_16x16x32_bf16 v[66:69], v[40:43], v[62:65], 0
v_mfma_f32_16x16x32_bf16 v[78:81], v[94:97], v[62:65], 0
v_mfma_f32_16x16x32_bf16 v[82:85], v[98:101], v[62:65], 0
v_mfma_f32_16x16x32_bf16 v[86:89], v[102:105], v[62:65], 0
v_mfma_f32_16x16x32_bf16 v[90:93], v[106:109], v[62:65], 0
v_mfma_f32_16x16x16_bf16 v[66:69], v[40:41], v[52:53], v[66:69]
v_mfma_f32_16x16x16_bf16 v[78:81], v[124:125], v[52:53], v[78:81]
v_mfma_f32_16x16x16_bf16 v[82:85], v[124:125], v[54:55], v[82:85]
s_cbranch_scc1 L_nx52
buffer_load_dwordx4 v1, s[4:7], s68 offen offset:2048 sc1 lds
L_nx52:
v_mfma_f32_16x16x16_bf16 v[86:89], v[126:127], v[52:53], v[86:89]
v_mfma_f32_16x16x16_bf16 v[90:93], v[126:127], v[54:55], v[90:93]
v_rcp_f32 v122, v66
s_nop 0
v_mul_f32 v78, v78, v122
v_mul_f32 v79, v79, v122
v_mul_f32 v80, v80, v122
v_mul_f32 v81, v81, v122
v_mul_f32 v82, v82, v122
v_mul_f32 v83, v83, v122
v_mul_f32 v84, v84, v122
v_mul_f32 v85, v85, v122
v_mul_f32 v86, v86, v122
s_cbranch_scc1 L_nx53
buffer_load_dwordx4 v1, s[4:7], s68 offen offset:3072 sc1 lds
L_nx53:
v_mul_f32 v87, v87, v122
v_mul_f32 v88, v88, v122
v_mul_f32 v89, v89, v122
v_mul_f32 v90, v90, v122
v_mul_f32 v91, v91, v122
v_mul_f32 v92, v92, v122
v_mul_f32 v93, v93, v122
v_cvt_pk_bf16_f32 v78, v78, v79
v_cvt_pk_bf16_f32 v79, v80, v81
v_cvt_pk_bf16_f32 v80, v82, v83
v_cvt_pk_bf16_f32 v81, v84, v85
ds_write_b128 v11, v[78:81] offset:0
v_cvt_pk_bf16_f32 v86, v86, v87
v_cvt_pk_bf16_f32 v87, v88, v89
v_cvt_pk_bf16_f32 v88, v90, v91
v_cvt_pk_bf16_f32 v89, v92, v93
ds_write_b128 v11, v[86:89] offset:1024
s_waitcnt lgkmcnt(0)
s_barrier
ds_read_b128 v[62:65], v2 offset:0
ds_read_b128 v[66:69], v2 offset:1024
ds_read_b128 v[70:73], v2 offset:2048
ds_read_b128 v[74:77], v2 offset:3072
ds_read_b128 v[78:81], v2 offset:4096
ds_read_b128 v[82:85], v2 offset:5120
ds_read_b128 v[86:89], v2 offset:6144
ds_read_b128 v[90:93], v2 offset:7168
s_waitcnt lgkmcnt(0)
s_add_u32 s43, s50, 524288
v_mfma_f32_16x16x32_bf16 v[96:99], a[128:131], v[62:65], 0
v_mfma_f32_16x16x32_bf16 v[100:103], a[144:147], v[62:65], 0
v_mfma_f32_16x16x32_bf16 v[104:107], a[128:131], v[78:81], 0
v_mfma_f32_16x16x32_bf16 v[108:111], a[144:147], v[78:81], 0
v_mfma_f32_16x16x32_bf16 v[96:99], a[132:135], v[66:69], v[96:99]
v_mfma_f32_16x16x32_bf16 v[100:103], a[148:151], v[66:69], v[100:103]
v_mfma_f32_16x16x32_bf16 v[104:107], a[132:135], v[82:85], v[104:107]
v_mfma_f32_16x16x32_bf16 v[108:111], a[148:151], v[82:85], v[108:111]
v_mfma_f32_16x16x32_bf16 v[96:99], a[136:139], v[70:73], v[96:99]
v_mfma_f32_16x16x32_bf16 v[100:103], a[152:155], v[70:73], v[100:103]
v_mfma_f32_16x16x32_bf16 v[104:107], a[136:139], v[86:89], v[104:107]
v_mfma_f32_16x16x32_bf16 v[108:111], a[152:155], v[86:89], v[108:111]
v_mfma_f32_16x16x32_bf16 v[96:99], a[140:143], v[74:77], v[96:99]
v_mfma_f32_16x16x32_bf16 v[100:103], a[156:159], v[74:77], v[100:103]
v_mfma_f32_16x16x32_bf16 v[104:107], a[140:143], v[90:93], v[104:107]
v_mfma_f32_16x16x32_bf16 v[108:111], a[156:159], v[90:93], v[108:111]
v_mfma_f32_16x16x32_bf16 v[112:115], a[160:163], v[62:65], 0
v_mfma_f32_16x16x32_bf16 v[116:119], a[176:179], v[62:65], 0
v_mfma_f32_16x16x32_bf16 v[120:123], a[160:163], v[78:81], 0
v_cvt_pk_bf16_f32 v96, v96, v97
v_cvt_pk_bf16_f32 v97, v98, v99
v_mfma_f32_16x16x32_bf16 v[124:127], a[176:179], v[78:81], 0
v_cvt_pk_bf16_f32 v98, v100, v101
v_cvt_pk_bf16_f32 v99, v102, v103
v_mfma_f32_16x16x32_bf16 v[112:115], a[164:167], v[66:69], v[112:115]
buffer_store_dwordx4 v[96:99], v3, s[4:7], s50 offen offset:0 sc1
v_cvt_pk_bf16_f32 v104, v104, v105
v_mfma_f32_16x16x32_bf16 v[116:119], a[180:183], v[66:69], v[116:119]
v_cvt_pk_bf16_f32 v105, v106, v107
v_cvt_pk_bf16_f32 v106, v108, v109
v_mfma_f32_16x16x32_bf16 v[120:123], a[164:167], v[82:85], v[120:123]
v_cvt_pk_bf16_f32 v107, v110, v111
buffer_store_dwordx4 v[104:107], v3, s[4:7], s43 offen offset:0 sc1
v_mfma_f32_16x16x32_bf16 v[124:127], a[180:183], v[82:85], v[124:127]
v_mfma_f32_16x16x32_bf16 v[112:115], a[168:171], v[70:73], v[112:115]
v_mfma_f32_16x16x32_bf16 v[116:119], a[184:187], v[70:73], v[116:119]
v_mfma_f32_16x16x32_bf16 v[120:123], a[168:171], v[86:89], v[120:123]
v_mfma_f32_16x16x32_bf16 v[124:127], a[184:187], v[86:89], v[124:127]
v_mfma_f32_16x16x32_bf16 v[112:115], a[172:175], v[74:77], v[112:115]
v_mfma_f32_16x16x32_bf16 v[116:119], a[188:191], v[74:77], v[116:119]
v_mfma_f32_16x16x32_bf16 v[120:123], a[172:175], v[90:93], v[120:123]
v_mfma_f32_16x16x32_bf16 v[124:127], a[188:191], v[90:93], v[124:127]
v_mfma_f32_16x16x32_bf16 v[96:99], a[192:195], v[62:65], 0
v_mfma_f32_16x16x32_bf16 v[100:103], a[208:211], v[62:65], 0
v_mfma_f32_16x16x32_bf16 v[104:107], a[192:195], v[78:81], 0
v_cvt_pk_bf16_f32 v112, v112, v113
v_cvt_pk_bf16_f32 v113, v114, v115
v_mfma_f32_16x16x32_bf16 v[108:111], a[208:211], v[78:81], 0
v_cvt_pk_bf16_f32 v114, v116, v117
v_cvt_pk_bf16_f32 v115, v118, v119
v_mfma_f32_16x16x32_bf16 v[96:99], a[196:199], v[66:69], v[96:99]
buffer_store_dwordx4 v[112:115], v3, s[4:7], s50 offen offset:64 sc1
v_cvt_pk_bf16_f32 v120, v120, v121
v_mfma_f32_16x16x32_bf16 v[100:103], a[212:215], v[66:69], v[100:103]
v_cvt_pk_bf16_f32 v121, v122, v123
v_cvt_pk_bf16_f32 v122, v124, v125
v_mfma_f32_16x16x32_bf16 v[104:107], a[196:199], v[82:85], v[104:107]
v_cvt_pk_bf16_f32 v123, v126, v127
buffer_store_dwordx4 v[120:123], v3, s[4:7], s43 offen offset:64 sc1
v_mfma_f32_16x16x32_bf16 v[108:111], a[212:215], v[82:85], v[108:111]
v_mfma_f32_16x16x32_bf16 v[96:99], a[200:203], v[70:73], v[96:99]
v_mfma_f32_16x16x32_bf16 v[100:103], a[216:219], v[70:73], v[100:103]
v_mfma_f32_16x16x32_bf16 v[104:107], a[200:203], v[86:89], v[104:107]
v_mfma_f32_16x16x32_bf16 v[108:111], a[216:219], v[86:89], v[108:111]
v_mfma_f32_16x16x32_bf16 v[96:99], a[204:207], v[74:77], v[96:99]
v_mfma_f32_16x16x32_bf16 v[100:103], a[220:223], v[74:77], v[100:103]
v_mfma_f32_16x16x32_bf16 v[104:107], a[204:207], v[90:93], v[104:107]
v_mfma_f32_16x16x32_bf16 v[108:111], a[220:223], v[90:93], v[108:111]
v_mfma_f32_16x16x32_bf16 v[112:115], a[224:227], v[62:65], 0
v_mfma_f32_16x16x32_bf16 v[116:119], a[240:243], v[62:65], 0
v_mfma_f32_16x16x32_bf16 v[120:123], a[224:227], v[78:81], 0
v_cvt_pk_bf16_f32 v96, v96, v97
v_cvt_pk_bf16_f32 v97, v98, v99
v_mfma_f32_16x16x32_bf16 v[124:127], a[240:243], v[78:81], 0
v_cvt_pk_bf16_f32 v98, v100, v101
v_cvt_pk_bf16_f32 v99, v102, v103
v_mfma_f32_16x16x32_bf16 v[112:115], a[228:231], v[66:69], v[112:115]
buffer_store_dwordx4 v[96:99], v3, s[4:7], s50 offen offset:128 sc1
v_cvt_pk_bf16_f32 v104, v104, v105
v_mfma_f32_16x16x32_bf16 v[116:119], a[244:247], v[66:69], v[116:119]
v_cvt_pk_bf16_f32 v105, v106, v107
v_cvt_pk_bf16_f32 v106, v108, v109
v_mfma_f32_16x16x32_bf16 v[120:123], a[228:231], v[82:85], v[120:123]
v_cvt_pk_bf16_f32 v107, v110, v111
buffer_store_dwordx4 v[104:107], v3, s[4:7], s43 offen offset:128 sc1
v_mfma_f32_16x16x32_bf16 v[124:127], a[244:247], v[82:85], v[124:127]
v_mfma_f32_16x16x32_bf16 v[112:115], a[232:235], v[70:73], v[112:115]
v_mfma_f32_16x16x32_bf16 v[116:119], a[248:251], v[70:73], v[116:119]
v_mfma_f32_16x16x32_bf16 v[120:123], a[232:235], v[86:89], v[120:123]
v_mfma_f32_16x16x32_bf16 v[124:127], a[248:251], v[86:89], v[124:127]
v_mfma_f32_16x16x32_bf16 v[112:115], a[236:239], v[74:77], v[112:115]
v_mfma_f32_16x16x32_bf16 v[116:119], a[252:255], v[74:77], v[116:119]
v_mfma_f32_16x16x32_bf16 v[120:123], a[236:239], v[90:93], v[120:123]
v_mfma_f32_16x16x32_bf16 v[124:127], a[252:255], v[90:93], v[124:127]
v_cvt_pk_bf16_f32 v112, v112, v113
v_cvt_pk_bf16_f32 v113, v114, v115
v_cvt_pk_bf16_f32 v114, v116, v117
v_cvt_pk_bf16_f32 v115, v118, v119
buffer_store_dwordx4 v[112:115], v3, s[4:7], s50 offen offset:192 sc1
v_cvt_pk_bf16_f32 v120, v120, v121
v_cvt_pk_bf16_f32 v121, v122, v123
s_nop 0
v_cvt_pk_bf16_f32 v122, v124, v125
v_cvt_pk_bf16_f32 v123, v126, v127
buffer_store_dwordx4 v[120:123], v3, s[4:7], s43 offen offset:192 sc1
s_waitcnt vmcnt(0)
s_barrier
s_cmp_lg_u32 s33, 0
s_cbranch_scc1 L_pb54
s_lshl_b32 s41, s32, 7
s_add_u32 s41, s41, s76
s_add_u32 s41, s41, 0
v_mov_b32 v62, s77
buffer_store_dword v62, off, s[4:7], s41 sc1
L_pb54:
s_cmp_lg_u32 s33, 0
s_cbranch_scc1 L_aw55
v_lshlrev_b32 v63, 3, v1
s_add_u32 s41, s76, 0
s_mov_b64 exec, 0xffffffff
L_awl55:
buffer_load_dword v62, v63, s[4:7], s41 offen sc1
s_add_u32 s51, s51, 1
s_cmp_gt_u32 s51, 300000
s_cbranch_scc1 L_end
s_waitcnt vmcnt(0)
v_cmp_ne_u32 vcc, s77, v62
s_cbranch_vccz L_awd55
s_sleep 1
s_branch L_awl55
L_awd55:
s_mov_b64 exec, -1
L_aw55:
s_barrier
s_mov_b32 s41, s47
buffer_load_dwordx4 v[62:65], v4, s[4:7], s41 offen sc1
s_add_u32 s41, s41, 4096
buffer_load_dwordx4 v[66:69], v4, s[4:7], s41 offen sc1
s_add_u32 s41, s41, 4096
buffer_load_dwordx4 v[70:73], v4, s[4:7], s41 offen sc1
s_add_u32 s41, s41, 4096
buffer_load_dwordx4 v[74:77], v4, s[4:7], s41 offen sc1
s_add_u32 s41, s41, 4096
buffer_load_dwordx4 v[78:81], v4, s[4:7], s41 offen sc1
s_add_u32 s41, s41, 4096
buffer_load_dwordx4 v[82:85], v4, s[4:7], s41 offen sc1
s_add_u32 s41, s41, 4096
buffer_load_dwordx4 v[86:89], v4, s[4:7], s41 offen sc1
s_add_u32 s41, s41, 4096
buffer_load_dwordx4 v[90:93], v4, s[4:7], s41 offen sc1
s_waitcnt vmcnt(7)
v_mfma_f32_16x16x32_bf16 v[96:99], v[36:39], v[62:65], 0
s_waitcnt vmcnt(6)
v_mfma_f32_16x16x32_bf16 v[96:99], v[36:39], v[66:69], v[96:99]
s_waitcnt vmcnt(5)
v_mfma_f32_16x16x32_bf16 v[96:99], v[36:39], v[70:73], v[96:99]
s_waitcnt vmcnt(4)
v_mfma_f32_16x16x32_bf16 v[96:99], v[36:39], v[74:77], v[96:99]
s_waitcnt vmcnt(3)
v_mfma_f32_16x16x32_bf16 v[96:99], v[36:39], v[78:81], v[96:99]
s_waitcnt vmcnt(2)
v_mfma_f32_16x16x32_bf16 v[96:99], v[36:39], v[82:85], v[96:99]
s_waitcnt vmcnt(1)
v_mfma_f32_16x16x32_bf16 v[96:99], v[36:39], v[86:89], v[96:99]
s_waitcnt vmcnt(0)
v_mfma_f32_16x16x32_bf16 v[96:99], v[36:39], v[90:93], v[96:99]
s_mov_b64 exec, s[38:39]
s_nop 6
v_cvt_pk_bf16_f32 v96, v96, v97
v_cvt_pk_bf16_f32 v97, v98, v99
v_lshlrev_b32 v62, 16, v96
v_and_b32 v63, 0xffff0000, v96
v_lshlrev_b32 v56, 16, v60
v_and_b32 v57, 0xffff0000, v60
v_lshlrev_b32 v64, 16, v97
v_and_b32 v65, 0xffff0000, v97
v_lshlrev_b32 v58, 16, v61
v_and_b32 v59, 0xffff0000, v61
v_fmac_f32 v56, v62, v12
v_fmac_f32 v57, v63, v13
v_fmac_f32 v58, v64, v14
v_fmac_f32 v59, v65, v15
v_cvt_pk_bf16_f32 v96, v56, v57
v_cvt_pk_bf16_f32 v97, v58, v59
v_lshlrev_b32 v56, 16, v96
v_and_b32 v57, 0xffff0000, v96
v_lshlrev_b32 v58, 16, v97
v_and_b32 v59, 0xffff0000, v97
v_add_f32 v70, v56, v57
v_add_f32 v70, v70, v58
v_add_f32 v70, v70, v59
s_nop 1
v_add_f32_dpp v70, v70, v70 quad_perm:[1,0,3,2] row_mask:0xf bank_mask:0xf
s_nop 1
v_add_f32_dpp v70, v70, v70 quad_perm:[2,3,0,1] row_mask:0xf bank_mask:0xf
s_nop 1
v_add_f32_dpp v70, v70, v70 row_half_mirror row_mask:0xf bank_mask:0xf
s_nop 1
v_add_f32_dpp v70, v70, v70 row_mirror row_mask:0xf bank_mask:0xf
v_mov_b32 v72, v70
s_mov_b64 exec, -1
s_nop 0
v_permlane16_swap_b32 v70, v72
s_mov_b64 exec, s[38:39]
v_add_f32 v70, v70, v72
s_lshl_b32 s41, s33, 2
s_add_u32 s41, s41, 110592
v_mov_b32 v72, s41
ds_write_b32 v72, v70
s_waitcnt vmcnt(0) lgkmcnt(0)
s_barrier
v_mov_b32 v72, 110592
ds_read_b128 v[74:77], v72
s_waitcnt lgkmcnt(0)
v_add_f32 v74, v74, v75
v_add_f32 v76, v76, v77
v_add_f32 v70, v74, v76
v_mul_f32 v70, 0x3b000000, v70
v_sub_f32 v62, v56, v70
v_sub_f32 v63, v57, v70
v_sub_f32 v64, v58, v70
v_sub_f32 v65, v59, v70
v_mul_f32 v70, v62, v62
v_fmac_f32 v70, v63, v63
v_fmac_f32 v70, v64, v64
v_fmac_f32 v70, v65, v65
s_nop 1
v_add_f32_dpp v70, v70, v70 quad_perm:[1,0,3,2] row_mask:0xf bank_mask:0xf
s_nop 1
v_add_f32_dpp v70, v70, v70 quad_perm:[2,3,0,1] row_mask:0xf bank_mask:0xf
s_nop 1
v_add_f32_dpp v70, v70, v70 row_half_mirror row_mask:0xf bank_mask:0xf
s_nop 1
v_add_f32_dpp v70, v70, v70 row_mirror row_mask:0xf bank_mask:0xf
v_mov_b32 v72, v70
s_mov_b64 exec, -1
s_nop 0
v_permlane16_swap_b32 v70, v72
s_mov_b64 exec, s[38:39]
v_add_f32 v70, v70, v72
s_lshl_b32 s41, s33, 2
s_add_u32 s41, s41, 110608
v_mov_b32 v72, s41
ds_write_b32 v72, v70
s_waitcnt vmcnt(0) lgkmcnt(0)
s_barrier
v_mov_b32 v72, 110608
ds_read_b128 v[74:77], v72
s_waitcnt lgkmcnt(0)
v_add_f32 v74, v74, v75
v_add_f32 v76, v76, v77
v_add_f32 v70, v74, v76
v_mov_b32 v71, 0x3727c5ac
v_fmac_f32 v71, 0x3b000000, v70
v_rsq_f32 v70, v71
s_nop 0
v_mul_f32 v62, v62, v70
v_mul_f32 v63, v63, v70
v_mul_f32 v64, v64, v70
v_mul_f32 v65, v65, v70
v_fma_f32 v62, v62, v16, v20
v_fma_f32 v63, v63, v17, v21
v_fma_f32 v64, v64, v18, v22
v_fma_f32 v65, v65, v19, v23
v_cvt_pk_bf16_f32 v96, v62, v63
v_cvt_pk_bf16_f32 v97, v64, v65
buffer_store_dwordx2 v[96:97], v5, s[4:7], s49 offen sc1
s_mov_b64 exec, -1
s_waitcnt vmcnt(0)
s_barrier
s_cmp_lg_u32 s33, 0
s_cbranch_scc1 L_pb56
s_lshl_b32 s41, s32, 7
s_add_u32 s41, s41, s76
s_add_u32 s41, s41, 4096
v_mov_b32 v62, s77
buffer_store_dword v62, off, s[4:7], s41 sc1
L_pb56:
s_cmp_ge_u32 s32, 28
s_cbranch_scc1 L_nomlp_s
s_lshl_b32 s57, s33, 13
s_add_u32 s56, s57, s36
s_add_u32 s56, s56, 2621440
s_add_u32 s68, s56, 4096
s_add_u32 s57, s57, 73728
s_add_u32 s69, s57, 4096
s_cmp_lg_u32 s33, 0
s_cbranch_scc1 L_aw57
v_lshlrev_b32 v63, 3, v1
s_add_u32 s41, s76, 4096
s_mov_b64 exec, 0xffffffff
L_awl57:
buffer_load_dword v62, v63, s[4:7], s41 offen sc1
s_add_u32 s51, s51, 1
s_cmp_gt_u32 s51, 300000
s_cbranch_scc1 L_end
s_waitcnt vmcnt(0)
v_cmp_ne_u32 vcc, s77, v62
s_cbranch_vccz L_awd57
s_sleep 1
s_branch L_awl57
L_awd57:
s_mov_b64 exec, -1
L_aw57:
s_barrier
s_mov_b32 m0, s57
s_nop 0
buffer_load_dwordx4 v1, s[4:7], s56 offen offset:0 sc1 lds
buffer_load_dwordx4 v1, s[4:7], s56 offen offset:1024 sc1 lds
buffer_load_dwordx4 v1, s[4:7], s56 offen offset:2048 sc1 lds
buffer_load_dwordx4 v1, s[4:7], s56 offen offset:3072 sc1 lds
s_mov_b32 m0, s69
s_nop 0
buffer_load_dwordx4 v1, s[4:7], s68 offen offset:0 sc1 lds
buffer_load_dwordx4 v1, s[4:7], s68 offen offset:1024 sc1 lds
buffer_load_dwordx4 v1, s[4:7], s68 offen offset:2048 sc1 lds
buffer_load_dwordx4 v1, s[4:7], s68 offen offset:3072 sc1 lds
s_waitcnt vmcnt(0)
s_barrier
ds_read_b128 v[62:65], v2 offset:8192
ds_read_b128 v[66:69], v2 offset:24576
ds_read_b128 v[70:73], v2 offset:9216
ds_read_b128 v[74:77], v2 offset:25600
ds_read_b128 v[78:81], v2 offset:10240
ds_read_b128 v[82:85], v2 offset:26624
s_waitcnt lgkmcnt(4)
v_mfma_f32_16x16x32_bf16 v[86:89], v[128:131], v[62:65], v[32:35]
v_mfma_f32_16x16x32_bf16 v[90:93], v[128:131], v[66:69], v[32:35]
ds_read_b128 v[62:65], v2 offset:11264
ds_read_b128 v[66:69], v2 offset:27648
s_waitcnt lgkmcnt(4)
v_mfma_f32_16x16x32_bf16 v[86:89], v[132:135], v[70:73], v[86:89]
v_mfma_f32_16x16x32_bf16 v[90:93], v[132:135], v[74:77], v[90:93]
ds_read_b128 v[70:73], v2 offset:12288
ds_read_b128 v[74:77], v2 offset:28672
s_waitcnt lgkmcnt(4)
v_mfma_f32_16x16x32_bf16 v[86:89], v[136:139], v[78:81], v[86:89]
v_mfma_f32_16x16x32_bf16 v[90:93], v[136:139], v[82:85], v[90:93]
ds_read_b128 v[78:81], v2 offset:13312
ds_read_b128 v[82:85], v2 offset:29696
s_waitcnt lgkmcnt(4)
v_mfma_f32_16x16x32_bf16 v[86:89], v[140:143], v[62:65], v[86:89]
v_mfma_f32_16x16x32_bf16 v[90:93], v[140:143], v[66:69], v[90:93]
ds_read_b128 v[62:65], v2 offset:14336
ds_read_b128 v[66:69], v2 offset:30720
s_waitcnt lgkmcnt(4)
v_mfma_f32_16x16x32_bf16 v[86:89], v[144:147], v[70:73], v[86:89]
v_mfma_f32_16x16x32_bf16 v[90:93], v[144:147], v[74:77], v[90:93]
ds_read_b128 v[70:73], v2 offset:15360
ds_read_b128 v[74:77], v2 offset:31744
s_waitcnt lgkmcnt(4)
v_mfma_f32_16x16x32_bf16 v[86:89], v[148:151], v[78:81], v[86:89]
v_mfma_f32_16x16x32_bf16 v[90:93], v[148:151], v[82:85], v[90:93]
ds_read_b128 v[78:81], v2 offset:16384
ds_read_b128 v[82:85], v2 offset:32768
s_waitcnt lgkmcnt(4)
v_mfma_f32_16x16x32_bf16 v[86:89], v[152:155], v[62:65], v[86:89]
v_mfma_f32_16x16x32_bf16 v[90:93], v[152:155], v[66:69], v[90:93]
ds_read_b128 v[62:65], v2 offset:17408
ds_read_b128 v[66:69], v2 offset:33792
s_waitcnt lgkmcnt(4)
v_mfma_f32_16x16x32_bf16 v[86:89], v[156:159], v[70:73], v[86:89]
v_mfma_f32_16x16x32_bf16 v[90:93], v[156:159], v[74:77], v[90:93]
ds_read_b128 v[70:73], v2 offset:18432
ds_read_b128 v[74:77], v2 offset:34816
s_waitcnt lgkmcnt(4)
v_mfma_f32_16x16x32_bf16 v[86:89], v[160:163], v[78:81], v[86:89]
v_mfma_f32_16x16x32_bf16 v[90:93], v[160:163], v[82:85], v[90:93]
ds_read_b128 v[78:81], v2 offset:19456
ds_read_b128 v[82:85], v2 offset:35840
s_waitcnt lgkmcnt(4)
v_mfma_f32_16x16x32_bf16 v[86:89], v[164:167], v[62:65], v[86:89]
v_mfma_f32_16x16x32_bf16 v[90:93], v[164:167], v[66:69], v[90:93]
ds_read_b128 v[62:65], v2 offset:20480
ds_read_b128 v[66:69], v2 offset:36864
s_waitcnt lgkmcnt(4)
v_mfma_f32_16x16x32_bf16 v[86:89], v[168:171], v[70:73], v[86:89]
v_mfma_f32_16x16x32_bf16 v[90:93], v[168:171], v[74:77], v[90:93]
ds_read_b128 v[70:73], v2 offset:21504
ds_read_b128 v[74:77], v2 offset:37888
s_waitcnt lgkmcnt(4)
v_mfma_f32_16x16x32_bf16 v[86:89], v[172:175], v[78:81], v[86:89]
v_mfma_f32_16x16x32_bf16 v[90:93], v[172:175], v[82:85], v[90:93]
ds_read_b128 v[78:81], v2 offset:22528
ds_read_b128 v[82:85], v2 offset:38912
s_waitcnt lgkmcnt(4)
v_mfma_f32_16x16x32_bf16 v[86:89], v[176:179], v[62:65], v[86:89]
v_mfma_f32_16x16x32_bf16 v[90:93], v[176:179], v[66:69], v[90:93]
ds_read_b128 v[62:65], v2 offset:23552
ds_read_b128 v[66:69], v2 offset:39936
s_waitcnt lgkmcnt(4)
v_mfma_f32_16x16x32_bf16 v[86:89], v[180:183], v[70:73], v[86:89]
v_mfma_f32_16x16x32_bf16 v[90:93], v[180:183], v[74:77], v[90:93]
s_waitcnt lgkmcnt(2)
v_mfma_f32_16x16x32_bf16 v[86:89], v[184:187], v[78:81], v[86:89]
v_mfma_f32_16x16x32_bf16 v[90:93], v[184:187], v[82:85], v[90:93]
s_waitcnt lgkmcnt(0)
v_mfma_f32_16x16x32_bf16 v[86:89], v[188:191], v[62:65], v[86:89]
v_mfma_f32_16x16x32_bf16 v[90:93], v[188:191], v[66:69], v[90:93]
s_mov_b32 s41, 0xbdd2d3e8
v_mov_b32 v102, 0xc0135761
s_nop 2
v_mul_f32 v94, v86, v86
v_mul_f32 v95, v87, v87
v_mul_f32 v96, v88, v88
v_mul_f32 v97, v89, v89
v_mul_f32 v98, v90, v90
v_mul_f32 v99, v91, v91
v_mul_f32 v100, v92, v92
v_mul_f32 v101, v93, v93
v_fma_f32 v94, v94, s41, v102
v_fma_f32 v95, v95, s41, v102
v_fma_f32 v96, v96, s41, v102
v_fma_f32 v97, v97, s41, v102
v_fma_f32 v98, v98, s41, v102
v_fma_f32 v99, v99, s41, v102
v_fma_f32 v100, v100, s41, v102
v_fma_f32 v101, v101, s41, v102
v_mul_f32 v94, v94, v86
v_mul_f32 v95, v95, v87
v_mul_f32 v96, v96, v88
v_mul_f32 v97, v97, v89
v_mul_f32 v98, v98, v90
v_mul_f32 v99, v99, v91
v_mul_f32 v100, v100, v92
v_mul_f32 v101, v101, v93
v_exp_f32 v94, v94
v_exp_f32 v95, v95
v_exp_f32 v96, v96
v_exp_f32 v97, v97
v_exp_f32 v98, v98
v_exp_f32 v99, v99
v_exp_f32 v100, v100
v_exp_f32 v101, v101
v_add_f32 v94, 1.0, v94
v_add_f32 v95, 1.0, v95
v_add_f32 v96, 1.0, v96
v_add_f32 v97, 1.0, v97
v_add_f32 v98, 1.0, v98
v_add_f32 v99, 1.0, v99
v_add_f32 v100, 1.0, v100
v_add_f32 v101, 1.0, v101
v_rcp_f32 v94, v94
v_rcp_f32 v95, v95
v_rcp_f32 v96, v96
v_rcp_f32 v97, v97
v_rcp_f32 v98, v98
v_rcp_f32 v99, v99
v_rcp_f32 v100, v100
v_rcp_f32 v101, v101
v_mul_f32 v86, v86, v94
v_mul_f32 v87, v87, v95
v_mul_f32 v88, v88, v96
v_mul_f32 v89, v89, v97
v_mul_f32 v90, v90, v98
v_mul_f32 v91, v91, v99
v_mul_f32 v92, v92, v100
v_mul_f32 v93, v93, v101
v_cvt_pk_bf16_f32 v86, v86, v87
v_cvt_pk_bf16_f32 v87, v88, v89
ds_write_b64 v7, v[86:87] offset:0
v_cvt_pk_bf16_f32 v90, v90, v91
v_cvt_pk_bf16_f32 v91, v92, v93
ds_write_b64 v7, v[90:91] offset:2048
s_waitcnt lgkmcnt(0)
s_barrier
ds_read_b128 v[62:65], v2 offset:40960
ds_read_b128 v[66:69], v2 offset:41984
ds_read_b128 v[70:73], v2 offset:43008
ds_read_b128 v[74:77], v2 offset:44032
s_add_u32 s44, s50, 1310720
s_waitcnt lgkmcnt(0)
s_add_u32 s43, s44, 524288
v_mfma_f32_16x16x32_bf16 v[96:99], v[192:195], v[62:65], 0
v_mfma_f32_16x16x32_bf16 v[100:103], v[200:203], v[62:65], 0
v_mfma_f32_16x16x32_bf16 v[104:107], v[192:195], v[70:73], 0
v_mfma_f32_16x16x32_bf16 v[108:111], v[200:203], v[70:73], 0
v_mfma_f32_16x16x32_bf16 v[96:99], v[196:199], v[66:69], v[96:99]
v_mfma_f32_16x16x32_bf16 v[100:103], v[204:207], v[66:69], v[100:103]
v_mfma_f32_16x16x32_bf16 v[104:107], v[196:199], v[74:77], v[104:107]
v_mfma_f32_16x16x32_bf16 v[108:111], v[204:207], v[74:77], v[108:111]
v_mfma_f32_16x16x32_bf16 v[112:115], v[208:211], v[62:65], 0
v_mfma_f32_16x16x32_bf16 v[116:119], v[216:219], v[62:65], 0
v_mfma_f32_16x16x32_bf16 v[120:123], v[208:211], v[70:73], 0
v_cvt_pk_bf16_f32 v96, v96, v97
v_cvt_pk_bf16_f32 v97, v98, v99
v_mfma_f32_16x16x32_bf16 v[124:127], v[216:219], v[70:73], 0
v_cvt_pk_bf16_f32 v98, v100, v101
v_cvt_pk_bf16_f32 v99, v102, v103
v_mfma_f32_16x16x32_bf16 v[112:115], v[212:215], v[66:69], v[112:115]
buffer_store_dwordx4 v[96:99], v3, s[4:7], s44 offen offset:0 sc1
v_cvt_pk_bf16_f32 v104, v104, v105
v_mfma_f32_16x16x32_bf16 v[116:119], v[220:223], v[66:69], v[116:119]
v_cvt_pk_bf16_f32 v105, v106, v107
v_cvt_pk_bf16_f32 v106, v108, v109
v_mfma_f32_16x16x32_bf16 v[120:123], v[212:215], v[74:77], v[120:123]
v_cvt_pk_bf16_f32 v107, v110, v111
buffer_store_dwordx4 v[104:107], v3, s[4:7], s43 offen offset:0 sc1
v_mfma_f32_16x16x32_bf16 v[124:127], v[220:223], v[74:77], v[124:127]
v_mfma_f32_16x16x32_bf16 v[96:99], v[224:227], v[62:65], 0
v_mfma_f32_16x16x32_bf16 v[100:103], v[232:235], v[62:65], 0
v_mfma_f32_16x16x32_bf16 v[104:107], v[224:227], v[70:73], 0
v_cvt_pk_bf16_f32 v112, v112, v113
v_cvt_pk_bf16_f32 v113, v114, v115
v_mfma_f32_16x16x32_bf16 v[108:111], v[232:235], v[70:73], 0
v_cvt_pk_bf16_f32 v114, v116, v117
v_cvt_pk_bf16_f32 v115, v118, v119
v_mfma_f32_16x16x32_bf16 v[96:99], v[228:231], v[66:69], v[96:99]
buffer_store_dwordx4 v[112:115], v3, s[4:7], s44 offen offset:64 sc1
v_cvt_pk_bf16_f32 v120, v120, v121
v_mfma_f32_16x16x32_bf16 v[100:103], v[236:239], v[66:69], v[100:103]
v_cvt_pk_bf16_f32 v121, v122, v123
v_cvt_pk_bf16_f32 v122, v124, v125
v_mfma_f32_16x16x32_bf16 v[104:107], v[228:231], v[74:77], v[104:107]
v_cvt_pk_bf16_f32 v123, v126, v127
buffer_store_dwordx4 v[120:123], v3, s[4:7], s43 offen offset:64 sc1
v_mfma_f32_16x16x32_bf16 v[108:111], v[236:239], v[74:77], v[108:111]
v_mfma_f32_16x16x32_bf16 v[112:115], v[240:243], v[62:65], 0
v_mfma_f32_16x16x32_bf16 v[116:119], v[248:251], v[62:65], 0
v_mfma_f32_16x16x32_bf16 v[120:123], v[240:243], v[70:73], 0
v_cvt_pk_bf16_f32 v96, v96, v97
v_cvt_pk_bf16_f32 v97, v98, v99
v_mfma_f32_16x16x32_bf16 v[124:127], v[248:251], v[70:73], 0
v_cvt_pk_bf16_f32 v98, v100, v101
v_cvt_pk_bf16_f32 v99, v102, v103
v_mfma_f32_16x16x32_bf16 v[112:115], v[244:247], v[66:69], v[112:115]
buffer_store_dwordx4 v[96:99], v3, s[4:7], s44 offen offset:128 sc1
v_cvt_pk_bf16_f32 v104, v104, v105
v_mfma_f32_16x16x32_bf16 v[116:119], v[252:255], v[66:69], v[116:119]
v_cvt_pk_bf16_f32 v105, v106, v107
v_cvt_pk_bf16_f32 v106, v108, v109
v_mfma_f32_16x16x32_bf16 v[120:123], v[244:247], v[74:77], v[120:123]
v_cvt_pk_bf16_f32 v107, v110, v111
buffer_store_dwordx4 v[104:107], v3, s[4:7], s43 offen offset:128 sc1
v_mfma_f32_16x16x32_bf16 v[124:127], v[252:255], v[74:77], v[124:127]
v_cvt_pk_bf16_f32 v112, v112, v113
v_cvt_pk_bf16_f32 v113, v114, v115
v_cvt_pk_bf16_f32 v114, v116, v117
v_cvt_pk_bf16_f32 v115, v118, v119
buffer_store_dwordx4 v[112:115], v3, s[4:7], s44 offen offset:192 sc1
v_cvt_pk_bf16_f32 v120, v120, v121
v_cvt_pk_bf16_f32 v121, v122, v123
s_nop 0
v_cvt_pk_bf16_f32 v122, v124, v125
v_cvt_pk_bf16_f32 v123, v126, v127
buffer_store_dwordx4 v[120:123], v3, s[4:7], s43 offen offset:192 sc1
s_waitcnt vmcnt(0)
s_barrier
s_cmp_lg_u32 s33, 0
s_cbranch_scc1 L_pb58
s_lshl_b32 s41, s32, 7
s_add_u32 s41, s41, s76
s_add_u32 s41, s41, 8192
v_mov_b32 v62, s77
buffer_store_dword v62, off, s[4:7], s41 sc1
L_pb58:
L_nomlp_s:
L_mlpd_s:
s_cmp_ge_u32 s72, 64
s_cbranch_scc1 L_noq_s
s_lshl_b32 s74, s72, 5
s_add_u32 s75, s74, s32
s_lshl_b32 s74, s75, 10
s_lshl_b32 s41, s33, 8
s_add_u32 s74, s74, s41
s_cmp_gt_u32 s45, s72
s_cbranch_scc1 L_kr59
s_lshl_b32 s43, s32, 8
s_add_u32 s43, s43, 51380224
v_lshrrev_b32 v64, 2, v1
L_krl59:
buffer_load_dword v63, v64, s[4:7], s43 offen sc1
s_add_u32 s51, s51, 1
s_cmp_gt_u32 s51, 300000
s_cbranch_scc1 L_end
s_waitcnt vmcnt(0)
v_cmp_eq_u32 vcc, 0, v63
s_ff1_i32_b64 s45, vcc
s_min_u32 s45, s45, 64
s_cmp_gt_u32 s45, s72
s_cbranch_scc0 L_krl59
L_kr59:
s_waitcnt vmcnt(0)
s_lshl_b32 s41, s75, 14
s_lshl_b32 s42, s33, 12
s_add_u32 s41, s41, s42
s_add_u32 s57, s42, 32768
s_mov_b32 s56, s41
buffer_load_dwordx2 v[60:61], v6, s[24:27], s74 offen
s_barrier
ds_read_b128 v[62:65], v1 offset:0
ds_read_b128 v[66:69], v1 offset:16384
ds_read_b128 v[70:73], v1 offset:1024
ds_read_b128 v[74:77], v1 offset:17408
ds_read_b128 v[78:81], v1 offset:2048
ds_read_b128 v[82:85], v1 offset:18432
s_waitcnt lgkmcnt(4)
v_mfma_f32_16x16x32_bf16 v[86:89], a[0:3], v[62:65], 0
v_mfma_f32_16x16x32_bf16 v[90:93], a[64:67], v[62:65], 0
v_mfma_f32_16x16x32_bf16 v[94:97], a[0:3], v[66:69], 0
v_mfma_f32_16x16x32_bf16 v[98:101], a[64:67], v[66:69], 0
ds_read_b128 v[62:65], v1 offset:3072
ds_read_b128 v[66:69], v1 offset:19456
s_waitcnt lgkmcnt(4)
v_mfma_f32_16x16x32_bf16 v[86:89], a[4:7], v[70:73], v[86:89]
v_mfma_f32_16x16x32_bf16 v[90:93], a[68:71], v[70:73], v[90:93]
v_mfma_f32_16x16x32_bf16 v[94:97], a[4:7], v[74:77], v[94:97]
v_mfma_f32_16x16x32_bf16 v[98:101], a[68:71], v[74:77], v[98:101]
s_mov_b32 m0, s57
s_nop 0
buffer_load_dwordx4 v1, s[4:7], s56 offen offset:0 sc1 lds
ds_read_b128 v[70:73], v1 offset:4096
ds_read_b128 v[74:77], v1 offset:20480
s_waitcnt lgkmcnt(4)
v_mfma_f32_16x16x32_bf16 v[86:89], a[8:11], v[78:81], v[86:89]
v_mfma_f32_16x16x32_bf16 v[90:93], a[72:75], v[78:81], v[90:93]
v_mfma_f32_16x16x32_bf16 v[94:97], a[8:11], v[82:85], v[94:97]
v_mfma_f32_16x16x32_bf16 v[98:101], a[72:75], v[82:85], v[98:101]
ds_read_b128 v[78:81], v1 offset:5120
ds_read_b128 v[82:85], v1 offset:21504
s_waitcnt lgkmcnt(4)
v_mfma_f32_16x16x32_bf16 v[86:89], a[12:15], v[62:65], v[86:89]
v_mfma_f32_16x16x32_bf16 v[90:93], a[76:79], v[62:65], v[90:93]
v_mfma_f32_16x16x32_bf16 v[94:97], a[12:15], v[66:69], v[94:97]
v_mfma_f32_16x16x32_bf16 v[98:101], a[76:79], v[66:69], v[98:101]
ds_read_b128 v[62:65], v1 offset:6144
ds_read_b128 v[66:69], v1 offset:22528
s_waitcnt lgkmcnt(4)
v_mfma_f32_16x16x32_bf16 v[86:89], a[16:19], v[70:73], v[86:89]
v_mfma_f32_16x16x32_bf16 v[90:93], a[80:83], v[70:73], v[90:93]
v_mfma_f32_16x16x32_bf16 v[94:97], a[16:19], v[74:77], v[94:97]
v_mfma_f32_16x16x32_bf16 v[98:101], a[80:83], v[74:77], v[98:101]
buffer_load_dwordx4 v1, s[4:7], s56 offen offset:1024 sc1 lds
ds_read_b128 v[70:73], v1 offset:7168
ds_read_b128 v[74:77], v1 offset:23552
s_waitcnt lgkmcnt(4)
v_mfma_f32_16x16x32_bf16 v[86:89], a[20:23], v[78:81], v[86:89]
v_mfma_f32_16x16x32_bf16 v[90:93], a[84:87], v[78:81], v[90:93]
v_mfma_f32_16x16x32_bf16 v[94:97], a[20:23], v[82:85], v[94:97]
v_mfma_f32_16x16x32_bf16 v[98:101], a[84:87], v[82:85], v[98:101]
ds_read_b128 v[78:81], v1 offset:8192
ds_read_b128 v[82:85], v1 offset:24576
s_waitcnt lgkmcnt(4)
v_mfma_f32_16x16x32_bf16 v[86:89], a[24:27], v[62:65], v[86:89]
v_mfma_f32_16x16x32_bf16 v[90:93], a[88:91], v[62:65], v[90:93]
v_mfma_f32_16x16x32_bf16 v[94:97], a[24:27], v[66:69], v[94:97]
v_mfma_f32_16x16x32_bf16 v[98:101], a[88:91], v[66:69], v[98:101]
ds_read_b128 v[62:65], v1 offset:9216
ds_read_b128 v[66:69], v1 offset:25600
s_waitcnt lgkmcnt(4)
v_mfma_f32_16x16x32_bf16 v[86:89], a[28:31], v[70:73], v[86:89]
v_mfma_f32_16x16x32_bf16 v[90:93], a[92:95], v[70:73], v[90:93]
v_mfma_f32_16x16x32_bf16 v[94:97], a[28:31], v[74:77], v[94:97]
v_mfma_f32_16x16x32_bf16 v[98:101], a[92:95], v[74:77], v[98:101]
buffer_load_dwordx4 v1, s[4:7], s56 offen offset:2048 sc1 lds
ds_read_b128 v[70:73], v1 offset:10240
ds_read_b128 v[74:77], v1 offset:26624
s_waitcnt lgkmcnt(4)
v_mfma_f32_16x16x32_bf16 v[86:89], a[32:35], v[78:81], v[86:89]
v_mfma_f32_16x16x32_bf16 v[90:93], a[96:99], v[78:81], v[90:93]
v_mfma_f32_16x16x32_bf16 v[94:97], a[32:35], v[82:85], v[94:97]
v_mfma_f32_16x16x32_bf16 v[98:101], a[96:99], v[82:85], v[98:101]
ds_read_b128 v[78:81], v1 offset:11264
ds_read_b128 v[82:85], v1 offset:27648
s_waitcnt lgkmcnt(4)
v_mfma_f32_16x16x32_bf16 v[86:89], a[36:39], v[62:65], v[86:89]
v_mfma_f32_16x16x32_bf16 v[90:93], a[100:103], v[62:65], v[90:93]
v_mfma_f32_16x16x32_bf16 v[94:97], a[36:39], v[66:69], v[94:97]
v_mfma_f32_16x16x32_bf16 v[98:101], a[100:103], v[66:69], v[98:101]
ds_read_b128 v[62:65], v1 offset:12288
ds_read_b128 v[66:69], v1 offset:28672
s_waitcnt lgkmcnt(4)
v_mfma_f32_16x16x32_bf16 v[86:89], a[40:43], v[70:73], v[86:89]
v_mfma_f32_16x16x32_bf16 v[90:93], a[104:107], v[70:73], v[90:93]
v_mfma_f32_16x16x32_bf16 v[94:97], a[40:43], v[74:77], v[94:97]
v_mfma_f32_16x16x32_bf16 v[98:101], a[104:107], v[74:77], v[98:101]
buffer_load_dwordx4 v1, s[4:7], s56 offen offset:3072 sc1 lds
ds_read_b128 v[70:73], v1 offset:13312
ds_read_b128 v[74:77], v1 offset:29696
s_waitcnt lgkmcnt(4)
v_mfma_f32_16x16x32_bf16 v[86:89], a[44:47], v[78:81], v[86:89]
v_mfma_f32_16x16x32_bf16 v[90:93], a[108:111], v[78:81], v[90:93]
v_mfma_f32_16x16x32_bf16 v[94:97], a[44:47], v[82:85], v[94:97]
v_mfma_f32_16x16x32_bf16 v[98:101], a[108:111], v[82:85], v[98:101]
ds_read_b128 v[78:81], v1 offset:14336
ds_read_b128 v[82:85], v1 offset:30720
s_waitcnt lgkmcnt(4)
v_mfma_f32_16x16x32_bf16 v[86:89], a[48:51], v[62:65], v[86:89]
v_mfma_f32_16x16x32_bf16 v[90:93], a[112:115], v[62:65], v[90:93]
v_mfma_f32_16x16x32_bf16 v[94:97], a[48:51], v[66:69], v[94:97]
v_mfma_f32_16x16x32_bf16 v[98:101], a[112:115], v[66:69], v[98:101]
ds_read_b128 v[62:65], v1 offset:15360
ds_read_b128 v[66:69], v1 offset:31744
s_waitcnt lgkmcnt(4)
v_mfma_f32_16x16x32_bf16 v[86:89], a[52:55], v[70:73], v[86:89]
v_mfma_f32_16x16x32_bf16 v[90:93], a[116:119], v[70:73], v[90:93]
v_mfma_f32_16x16x32_bf16 v[94:97], a[52:55], v[74:77], v[94:97]
v_mfma_f32_16x16x32_bf16 v[98:101], a[116:119], v[74:77], v[98:101]
s_waitcnt lgkmcnt(2)
v_mfma_f32_16x16x32_bf16 v[86:89], a[56:59], v[78:81], v[86:89]
v_mfma_f32_16x16x32_bf16 v[90:93], a[120:123], v[78:81], v[90:93]
v_mfma_f32_16x16x32_bf16 v[94:97], a[56:59], v[82:85], v[94:97]
v_mfma_f32_16x16x32_bf16 v[98:101], a[120:123], v[82:85], v[98:101]
s_waitcnt lgkmcnt(0)
v_mfma_f32_16x16x32_bf16 v[86:89], a[60:63], v[62:65], v[86:89]
v_mfma_f32_16x16x32_bf16 v[90:93], a[124:127], v[62:65], v[90:93]
v_mfma_f32_16x16x32_bf16 v[94:97], a[60:63], v[66:69], v[94:97]
v_mfma_f32_16x16x32_bf16 v[98:101], a[124:127], v[66:69], v[98:101]
s_lshl_b32 s41, s33, 10
v_add_u32 v62, s41, v1
v_cvt_pk_bf16_f32 v86, v86, v87
v_cvt_pk_bf16_f32 v87, v88, v89
v_cvt_pk_bf16_f32 v88, v90, v91
v_cvt_pk_bf16_f32 v89, v92, v93
ds_write_b128 v62, v[86:89] offset:57344
v_cvt_pk_bf16_f32 v94, v94, v95
v_cvt_pk_bf16_f32 v95, v96, v97
v_cvt_pk_bf16_f32 v96, v98, v99
v_cvt_pk_bf16_f32 v97, v100, v101
ds_write_b128 v62, v[94:97] offset:61440
L_noq_s:
s_cmp_lg_u32 s33, 0
s_cbranch_scc1 L_aw60
v_lshlrev_b32 v63, 3, v1
s_add_u32 s41, s76, 8192
s_mov_b64 exec, 0xfffffff
L_awl60:
buffer_load_dword v62, v63, s[4:7], s41 offen sc1
s_add_u32 s51, s51, 1
s_cmp_gt_u32 s51, 300000
s_cbranch_scc1 L_end
s_waitcnt vmcnt(0)
v_cmp_ne_u32 vcc, s77, v62
s_cbranch_vccz L_awd60
s_sleep 1
s_branch L_awl60
L_awd60:
s_mov_b64 exec, -1
L_aw60:
s_barrier
s_mov_b32 s41, s48
buffer_load_dwordx4 v[62:65], v4, s[4:7], s41 offen sc1
s_add_u32 s41, s41, 4096
buffer_load_dwordx4 v[66:69], v4, s[4:7], s41 offen sc1
s_add_u32 s41, s41, 4096
buffer_load_dwordx4 v[70:73], v4, s[4:7], s41 offen sc1
s_add_u32 s41, s41, 4096
buffer_load_dwordx4 v[74:77], v4, s[4:7], s41 offen sc1
s_add_u32 s41, s41, 4096
buffer_load_dwordx4 v[78:81], v4, s[4:7], s41 offen sc1
s_add_u32 s41, s41, 4096
buffer_load_dwordx4 v[82:85], v4, s[4:7], s41 offen sc1
s_add_u32 s41, s41, 4096
buffer_load_dwordx4 v[86:89], v4, s[4:7], s41 offen sc1
s_waitcnt vmcnt(6)
v_mfma_f32_16x16x32_bf16 v[96:99], v[36:39], v[62:65], 0
s_waitcnt vmcnt(5)
v_mfma_f32_16x16x32_bf16 v[96:99], v[36:39], v[66:69], v[96:99]
s_waitcnt vmcnt(4)
v_mfma_f32_16x16x32_bf16 v[96:99], v[36:39], v[70:73], v[96:99]
s_waitcnt vmcnt(3)
v_mfma_f32_16x16x32_bf16 v[96:99], v[36:39], v[74:77], v[96:99]
s_waitcnt vmcnt(2)
v_mfma_f32_16x16x32_bf16 v[96:99], v[36:39], v[78:81], v[96:99]
s_waitcnt vmcnt(1)
v_mfma_f32_16x16x32_bf16 v[96:99], v[36:39], v[82:85], v[96:99]
s_waitcnt vmcnt(0)
v_mfma_f32_16x16x32_bf16 v[96:99], v[36:39], v[86:89], v[96:99]
s_mov_b64 exec, s[38:39]
s_nop 6
v_add_f32 v96, v96, v28
v_add_f32 v97, v97, v29
v_add_f32 v98, v98, v30
v_add_f32 v99, v99, v31
v_fmac_f32 v56, v96, v24
v_fmac_f32 v57, v97, v25
v_fmac_f32 v58, v98, v26
v_fmac_f32 v59, v99, v27
v_cvt_pk_bf16_f32 v96, v56, v57
v_cvt_pk_bf16_f32 v97, v58, v59
buffer_store_dwordx2 v[96:97], v6, s[60:63], s52 offen
s_mov_b64 exec, -1
s_mov_b32 s35, s72
s_cmp_ge_u32 s35, 64
s_cbranch_scc1 L_postend_s
s_branch L_post_s
L_postend_s:
s_branch L_end
L_chain:
v_lshrrev_b32 v42, 2, v1
buffer_load_dword v40, v42, s[4:7], s61 offen sc1
s_waitcnt vmcnt(1)
s_barrier
v_xor_b32 v66, 0, v63
ds_read_b64_tr_b16 v[112:113], v66 offset:0
ds_read_b64_tr_b16 v[114:115], v66 offset:2048
ds_read_b64_tr_b16 v[116:117], v66 offset:32768
ds_read_b64_tr_b16 v[118:119], v66 offset:34816
v_xor_b32 v67, 32, v63
ds_read_b64_tr_b16 v[28:29], v67 offset:0
ds_read_b64_tr_b16 v[30:31], v67 offset:2048
ds_read_b64_tr_b16 v[32:33], v67 offset:32768
ds_read_b64_tr_b16 v[34:35], v67 offset:34816
s_waitcnt lgkmcnt(0)
v_xor_b32 v66, 64, v63
ds_read_b64_tr_b16 v[44:45], v66 offset:0
ds_read_b64_tr_b16 v[46:47], v66 offset:2048
ds_read_b64_tr_b16 v[48:49], v66 offset:32768
ds_read_b64_tr_b16 v[50:51], v66 offset:34816
v_xor_b32 v67, 96, v63
ds_read_b64_tr_b16 v[52:53], v67 offset:0
ds_read_b64_tr_b16 v[54:55], v67 offset:2048
ds_read_b64_tr_b16 v[56:57], v67 offset:32768
ds_read_b64_tr_b16 v[58:59], v67 offset:34816
s_waitcnt lgkmcnt(0)
v_xor_b32 v66, 128, v63
ds_read_b64_tr_b16 v[84:85], v66 offset:0
ds_read_b64_tr_b16 v[86:87], v66 offset:2048
ds_read_b64_tr_b16 v[88:89], v66 offset:32768
ds_read_b64_tr_b16 v[90:91], v66 offset:34816
v_xor_b32 v67, 160, v63
ds_read_b64_tr_b16 v[92:93], v67 offset:0
ds_read_b64_tr_b16 v[94:95], v67 offset:2048
ds_read_b64_tr_b16 v[96:97], v67 offset:32768
ds_read_b64_tr_b16 v[98:99], v67 offset:34816
s_waitcnt lgkmcnt(0)
v_xor_b32 v66, 192, v63
ds_read_b64_tr_b16 v[100:101], v66 offset:0
ds_read_b64_tr_b16 v[102:103], v66 offset:2048
ds_read_b64_tr_b16 v[104:105], v66 offset:32768
ds_read_b64_tr_b16 v[106:107], v66 offset:34816
v_xor_b32 v67, 224, v63
ds_read_b64_tr_b16 v[76:77], v67 offset:0
ds_read_b64_tr_b16 v[78:79], v67 offset:2048
ds_read_b64_tr_b16 v[80:81], v67 offset:32768
ds_read_b64_tr_b16 v[82:83], v67 offset:34816
s_waitcnt lgkmcnt(0)
s_barrier
ds_write_b128 v10, v[28:31] offset:0
ds_write_b128 v10, v[32:35] offset:1024
ds_write_b128 v10, v[44:47] offset:2048
ds_write_b128 v10, v[48:51] offset:3072
ds_write_b128 v10, v[52:55] offset:4096
ds_write_b128 v10, v[56:59] offset:5120
ds_write_b128 v10, v[84:87] offset:6144
ds_write_b128 v10, v[88:91] offset:7168
ds_write_b128 v10, v[92:95] offset:8192
ds_write_b128 v10, v[96:99] offset:9216
ds_write_b128 v10, v[100:103] offset:10240
ds_write_b128 v10, v[104:107] offset:11264
ds_write_b128 v10, v[76:79] offset:12288
ds_write_b128 v10, v[80:83] offset:13312
s_waitcnt lgkmcnt(0)
s_barrier
s_waitcnt vmcnt(0)
v_cmp_eq_u32 vcc, 0, v40
s_ff1_i32_b64 s60, vcc
s_min_u32 s60, s60, 64
s_cmp_lt_u32 s60, 2
s_cbranch_scc1 L_kv0_late
s_lshl_b32 s43, s33, 12
s_add_u32 s40, s43, 131072
s_mov_b32 m0, s40
s_lshl_b32 s41, s32, 14
s_add_u32 s41, s41, s43
buffer_load_dwordx4 v1, s[4:7], s41 offen offset:0 sc1 lds
buffer_load_dwordx4 v1, s[4:7], s41 offen offset:1024 sc1 lds
buffer_load_dwordx4 v1, s[4:7], s41 offen offset:2048 sc1 lds
buffer_load_dwordx4 v1, s[4:7], s41 offen offset:3072 sc1 lds
L_kv0_late:
v_xor_b32 v66, 0, v64
ds_read_b64_tr_b16 v[120:121], v66 offset:0
ds_read_b64_tr_b16 v[122:123], v66 offset:2048
ds_read_b64_tr_b16 v[124:125], v66 offset:32768
ds_read_b64_tr_b16 v[126:127], v66 offset:34816
v_xor_b32 v67, 32, v64
ds_read_b64_tr_b16 v[28:29], v67 offset:0
ds_read_b64_tr_b16 v[30:31], v67 offset:2048
ds_read_b64_tr_b16 v[32:33], v67 offset:32768
ds_read_b64_tr_b16 v[34:35], v67 offset:34816
s_waitcnt lgkmcnt(0)
v_xor_b32 v66, 64, v64
ds_read_b64_tr_b16 v[44:45], v66 offset:0
ds_read_b64_tr_b16 v[46:47], v66 offset:2048
ds_read_b64_tr_b16 v[48:49], v66 offset:32768
ds_read_b64_tr_b16 v[50:51], v66 offset:34816
v_xor_b32 v67, 96, v64
ds_read_b64_tr_b16 v[52:53], v67 offset:0
ds_read_b64_tr_b16 v[54:55], v67 offset:2048
ds_read_b64_tr_b16 v[56:57], v67 offset:32768
ds_read_b64_tr_b16 v[58:59], v67 offset:34816
s_waitcnt lgkmcnt(0)
v_xor_b32 v66, 128, v64
ds_read_b64_tr_b16 v[84:85], v66 offset:0
ds_read_b64_tr_b16 v[86:87], v66 offset:2048
ds_read_b64_tr_b16 v[88:89], v66 offset:32768
ds_read_b64_tr_b16 v[90:91], v66 offset:34816
v_xor_b32 v67, 160, v64
ds_read_b64_tr_b16 v[92:93], v67 offset:0
ds_read_b64_tr_b16 v[94:95], v67 offset:2048
ds_read_b64_tr_b16 v[96:97], v67 offset:32768
ds_read_b64_tr_b16 v[98:99], v67 offset:34816
s_waitcnt lgkmcnt(0)
v_xor_b32 v66, 192, v64
ds_read_b64_tr_b16 v[100:101], v66 offset:0
ds_read_b64_tr_b16 v[102:103], v66 offset:2048
ds_read_b64_tr_b16 v[104:105], v66 offset:32768
ds_read_b64_tr_b16 v[106:107], v66 offset:34816
v_xor_b32 v67, 224, v64
ds_read_b64_tr_b16 v[76:77], v67 offset:0
ds_read_b64_tr_b16 v[78:79], v67 offset:2048
ds_read_b64_tr_b16 v[80:81], v67 offset:32768
ds_read_b64_tr_b16 v[82:83], v67 offset:34816
s_waitcnt lgkmcnt(0)
s_barrier
ds_write_b128 v11, v[28:31] offset:0
ds_write_b128 v11, v[32:35] offset:1024
ds_write_b128 v11, v[44:47] offset:2048
ds_write_b128 v11, v[48:51] offset:3072
ds_write_b128 v11, v[52:55] offset:4096
ds_write_b128 v11, v[56:59] offset:5120
ds_write_b128 v11, v[84:87] offset:6144
ds_write_b128 v11, v[88:91] offset:7168
ds_write_b128 v11, v[92:95] offset:8192
ds_write_b128 v11, v[96:99] offset:9216
ds_write_b128 v11, v[100:103] offset:10240
ds_write_b128 v11, v[104:107] offset:11264
ds_write_b128 v11, v[76:79] offset:12288
ds_write_b128 v11, v[80:83] offset:13312
s_waitcnt lgkmcnt(0)
s_barrier
v_lshlrev_b32 v15, 4, v0
v_add_u32 v15, 155648, v15
ds_write_b128 v15, v[24:27]
s_lshl_b32 s40, s33, 11
v_add_u32 v92, s40, v2
ds_read_b128 v[28:31], v92 offset:32768
ds_read_b128 v[32:35], v92 offset:33792
v_mov_b64 v[60:61], 0
v_mov_b64 v[62:63], 0
v_mov_b64 v[64:65], 0
v_mov_b64 v[66:67], 0
v_mov_b64 v[68:69], 0
v_mov_b64 v[70:71], 0
v_mov_b64 v[72:73], 0
v_mov_b64 v[74:75], 0
v_mov_b64 v[76:77], 0
v_mov_b64 v[78:79], 0
v_mov_b64 v[80:81], 0
v_mov_b64 v[82:83], 0
s_cmp_ge_u32 s60, 2
s_cbranch_scc1 L_kv0_done
s_mov_b32 s43, 1
s_cmp_gt_u32 s60, s43
s_cbranch_scc1 L_kr61
v_lshrrev_b32 v15, 2, v1
L_krl61:
buffer_load_dword v0, v15, s[4:7], s61 offen sc1
s_add_u32 s51, s51, 1
s_cmp_gt_u32 s51, 300000
s_cbranch_scc1 L_end
s_waitcnt vmcnt(0)
v_cmp_eq_u32 vcc, 0, v0
s_ff1_i32_b64 s60, vcc
s_min_u32 s60, s60, 64
s_cmp_gt_u32 s60, s43
s_cbranch_scc0 L_krl61
L_kr61:
s_lshl_b32 s43, s33, 12
s_add_u32 s40, s43, 131072
s_mov_b32 m0, s40
s_lshl_b32 s41, s32, 14
s_add_u32 s41, s41, s43
buffer_load_dwordx4 v1, s[4:7], s41 offen offset:0 sc1 lds
buffer_load_dwordx4 v1, s[4:7], s41 offen offset:1024 sc1 lds
buffer_load_dwordx4 v1, s[4:7], s41 offen offset:2048 sc1 lds
buffer_load_dwordx4 v1, s[4:7], s41 offen offset:3072 sc1 lds
L_kv0_done:
s_mov_b32 s34, 0
s_lshl_b32 s8, s32, 13
s_add_u32 s8, s8, 47251456
s_mov_b32 s10, 47251584
s_lshl_b32 s40, s32, 2
s_add_u32 s9, s10, s40
s_lshl_b32 s11, s33, 16
s_add_u32 s11, s11, s40
s_add_u32 s11, s11, 47251456
s_add_u32 s12, s11, 32768
s_mov_b32 s14, 0x00010001
s_mov_b32 s15, 0x00010001
s_mul_i32 s40, s32, 8192
s_lshl_b32 s41, s33, 11
s_add_u32 s47, s40, s41
s_add_u32 s47, s47, 46399488
s_mov_b32 s52, s57
v_mov_b64 v[100:101], -1
v_mov_b64 v[102:103], -1
v_mov_b64 v[108:109], 0
v_mov_b64 v[110:111], 0
s_waitcnt vmcnt(0) lgkmcnt(0)
s_barrier
s_lshl_b32 s40, s59, 2
s_add_u32 s40, s40, s33
s_cmp_lg_u32 s33, 0
s_cbranch_scc1 L_pp_0
s_add_u32 s35, s34, 1
s_and_b32 s43, s34, 1
s_lshl_b32 s43, s43, 14
s_xor_b32 s42, s43, 16384
v_add_u32 v14, s42, v2
s_add_u32 s43, s43, 114688
s_mov_b32 m0, s43
s_add_u32 s42, s34, 1
s_cmp_eq_u32 s34, 63
s_cselect_b32 s42, 62, s42
s_lshl_b32 s64, s42, 19
s_lshl_b32 s40, s32, 14
s_add_u32 s64, s64, s40
s_add_u32 s64, s64, 0
s_lshl_b32 s50, s34, 5
s_add_u32 s50, s50, s32
s_lshl_b32 s65, s50, 11
s_add_u32 s65, s65, 41943040
s_lshl_b32 s66, s50, 12
s_add_u32 s66, s66, 33554432
s_and_b32 s45, s34, 1
s_mul_i32 s45, s45, 262144
s_mul_i32 s40, s32, 8192
s_add_u32 s68, s45, s40
s_add_u32 s68, s68, 46137344
s_add_u32 s45, s45, s56
s_add_u32 s45, s45, 46137344
s_add_u32 s67, s45, 32768
s_add_u32 s40, s34, 1
s_and_b32 s40, s40, 3
s_lshl_b32 s40, s40, 13
s_add_u32 s69, s40, 47185920
L_pp_0:
s_cmp_lg_u32 s33, 1
s_cbranch_scc1 L_pp_1
s_add_u32 s35, s34, 1
s_and_b32 s43, s34, 1
s_lshl_b32 s43, s43, 14
s_xor_b32 s42, s43, 16384
v_add_u32 v14, s42, v2
s_add_u32 s43, s43, 118784
s_mov_b32 m0, s43
s_add_u32 s42, s34, 1
s_cmp_eq_u32 s34, 63
s_cselect_b32 s42, 62, s42
s_lshl_b32 s64, s42, 19
s_lshl_b32 s40, s32, 14
s_add_u32 s64, s64, s40
s_add_u32 s64, s64, 4096
s_lshl_b32 s50, s34, 5
s_add_u32 s50, s50, s32
s_lshl_b32 s65, s50, 11
s_add_u32 s65, s65, 41943552
s_lshl_b32 s66, s50, 12
s_add_u32 s66, s66, 33555456
s_and_b32 s45, s34, 1
s_mul_i32 s45, s45, 262144
s_mul_i32 s40, s32, 8192
s_add_u32 s68, s45, s40
s_add_u32 s68, s68, 46137344
s_add_u32 s45, s45, s56
s_add_u32 s45, s45, 46202880
s_add_u32 s67, s45, 32768
s_add_u32 s40, s34, 1
s_and_b32 s40, s40, 3
s_lshl_b32 s40, s40, 13
s_add_u32 s69, s40, 47187968
L_pp_1:
s_cmp_lg_u32 s33, 2
s_cbranch_scc1 L_pp_2
s_add_u32 s35, s34, 1
s_and_b32 s43, s34, 1
s_lshl_b32 s43, s43, 14
s_xor_b32 s42, s43, 16384
v_add_u32 v14, s42, v2
s_add_u32 s43, s43, 122880
s_mov_b32 m0, s43
s_add_u32 s42, s34, 1
s_cmp_eq_u32 s34, 63
s_cselect_b32 s42, 62, s42
s_lshl_b32 s64, s42, 19
s_lshl_b32 s40, s32, 14
s_add_u32 s64, s64, s40
s_add_u32 s64, s64, 8192
s_lshl_b32 s50, s34, 5
s_add_u32 s50, s50, s32
s_lshl_b32 s65, s50, 11
s_add_u32 s65, s65, 41944064
s_lshl_b32 s66, s50, 12
s_add_u32 s66, s66, 33556480
s_and_b32 s45, s34, 1
s_mul_i32 s45, s45, 262144
s_mul_i32 s40, s32, 8192
s_add_u32 s68, s45, s40
s_add_u32 s68, s68, 46137344
s_add_u32 s45, s45, s56
s_add_u32 s45, s45, 46268416
s_add_u32 s67, s45, 32768
s_add_u32 s40, s34, 1
s_and_b32 s40, s40, 3
s_lshl_b32 s40, s40, 13
s_add_u32 s69, s40, 47190016
s_add_u32 s49, s40, s57
s_add_u32 s48, s68, 4096
s_add_u32 s52, s34, 3
s_and_b32 s52, s52, 3
s_lshl_b32 s52, s52, 13
s_add_u32 s52, s52, s57
L_pp_2:
s_cmp_lg_u32 s33, 3
s_cbranch_scc1 L_pp_3
s_add_u32 s35, s34, 1
s_and_b32 s43, s34, 1
s_lshl_b32 s43, s43, 14
s_xor_b32 s42, s43, 16384
v_add_u32 v14, s42, v2
s_add_u32 s43, s43, 126976
s_mov_b32 m0, s43
s_add_u32 s42, s34, 1
s_cmp_eq_u32 s34, 63
s_cselect_b32 s42, 62, s42
s_lshl_b32 s64, s42, 19
s_lshl_b32 s40, s32, 14
s_add_u32 s64, s64, s40
s_add_u32 s64, s64, 12288
s_lshl_b32 s50, s34, 5
s_add_u32 s50, s50, s32
s_lshl_b32 s65, s50, 11
s_add_u32 s65, s65, 41944576
s_lshl_b32 s66, s50, 12
s_add_u32 s66, s66, 33557504
s_and_b32 s45, s34, 1
s_mul_i32 s45, s45, 262144
s_mul_i32 s40, s32, 8192
s_add_u32 s68, s45, s40
s_add_u32 s68, s68, 46137344
s_add_u32 s45, s45, s56
s_add_u32 s45, s45, 46333952
s_add_u32 s67, s45, 32768
s_add_u32 s40, s34, 1
s_and_b32 s40, s40, 3
s_lshl_b32 s40, s40, 13
s_add_u32 s69, s40, 47192064
L_pp_3:
s_lshl_b32 s40, s59, 2
s_add_u32 s40, s40, s33
s_cmp_eq_u32 s40, 1
s_cbranch_scc1 L_step_w1f
s_cmp_eq_u32 s40, 2
s_cbranch_scc1 L_step_w2f
s_cmp_eq_u32 s40, 3
s_cbranch_scc1 L_step_w3f
s_cmp_eq_u32 s40, 4
s_cbranch_scc1 L_step_w0s
s_cmp_eq_u32 s40, 5
s_cbranch_scc1 L_step_w1s
s_cmp_eq_u32 s40, 6
s_cbranch_scc1 L_step_w2s
s_cmp_eq_u32 s40, 7
s_cbranch_scc1 L_step_w3s
L_step_w0f:
v_smfmac_f32_16x16x64_bf16 v[60:63], v[28:31], a[0:7], v3
ds_write_b128 v2, v[28:31] offset:32768
v_smfmac_f32_16x16x64_bf16 v[64:67], v[28:31], a[64:71], v3
ds_write_b128 v2, v[32:35] offset:33792
v_smfmac_f32_16x16x64_bf16 v[68:71], v[28:31], a[128:135], v3
v_smfmac_f32_16x16x64_bf16 v[72:75], v[28:31], a[192:199], v3
v_smfmac_f32_16x16x64_bf16 v[60:63], v[32:35], a[8:15], v3
v_smfmac_f32_16x16x64_bf16 v[64:67], v[32:35], a[72:79], v3
v_smfmac_f32_16x16x64_bf16 v[68:71], v[32:35], a[136:143], v3
v_smfmac_f32_16x16x64_bf16 v[72:75], v[32:35], a[200:207], v3
s_waitcnt lgkmcnt(0)
s_barrier
ds_read_b128 v[36:39], v2 offset:34816
ds_read_b128 v[40:43], v2 offset:35840
v_smfmac_f32_16x16x64_bf16 v[76:79], v[28:31], v[128:135], v3
ds_read_b128 v[44:47], v2 offset:36864
ds_read_b128 v[48:51], v2 offset:37888
v_smfmac_f32_16x16x64_bf16 v[80:83], v[28:31], v[192:199], v3
ds_read_b128 v[52:55], v2 offset:38912
ds_read_b128 v[56:59], v2 offset:39936
v_smfmac_f32_16x16x64_bf16 v[76:79], v[32:35], v[136:143], v3
v_smfmac_f32_16x16x64_bf16 v[80:83], v[32:35], v[200:207], v3
s_waitcnt lgkmcnt(4)
v_smfmac_f32_16x16x64_bf16 v[60:63], v[36:39], a[16:23], v3
v_smfmac_f32_16x16x64_bf16 v[64:67], v[36:39], a[80:87], v3
v_smfmac_f32_16x16x64_bf16 v[60:63], v[40:43], a[24:31], v3
v_smfmac_f32_16x16x64_bf16 v[64:67], v[40:43], a[88:95], v3
s_waitcnt vmcnt(0) lgkmcnt(0)
v_smfmac_f32_16x16x64_bf16 v[60:63], v[44:47], a[32:39], v3
buffer_store_dwordx4 v[100:103], v1, s[4:7], s47 offen offset:0
ds_read_b128 v[28:31], v14 offset:0
v_smfmac_f32_16x16x64_bf16 v[64:67], v[44:47], a[96:103], v3
ds_read_b128 v[32:35], v14 offset:1024
v_smfmac_f32_16x16x64_bf16 v[60:63], v[48:51], a[40:47], v3
ds_read_b128 v[104:107], v14 offset:5120
v_smfmac_f32_16x16x64_bf16 v[64:67], v[48:51], a[104:111], v3
ds_read_b128 v[108:111], v14 offset:6144
v_smfmac_f32_16x16x64_bf16 v[60:63], v[52:55], a[48:55], v3
buffer_store_dwordx4 v[100:103], v1, s[4:7], s47 offen offset:1024
v_smfmac_f32_16x16x64_bf16 v[64:67], v[52:55], a[112:119], v3
v_smfmac_f32_16x16x64_bf16 v[60:63], v[56:59], a[56:63], v3
v_smfmac_f32_16x16x64_bf16 v[64:67], v[56:59], a[120:127], v3
v_smfmac_f32_16x16x64_bf16 v[68:71], v[36:39], a[144:151], v3
buffer_load_dwordx4 v1, s[4:7], s64 offen offset:0 sc1 lds
v_smfmac_f32_16x16x64_bf16 v[72:75], v[36:39], a[208:215], v3
ds_read_b128 v[100:103], v14 offset:4096
v_add_f32 v60, v60, v61
v_smfmac_f32_16x16x64_bf16 v[68:71], v[40:43], a[152:159], v3
v_add_f32 v62, v62, v63
v_smfmac_f32_16x16x64_bf16 v[72:75], v[40:43], a[216:223], v3
v_cvt_pk_bf16_f32 v0, v60, v62
v_smfmac_f32_16x16x64_bf16 v[68:71], v[44:47], a[160:167], v3
buffer_load_dwordx4 v1, s[4:7], s64 offen offset:1024 sc1 lds
v_add_f32 v64, v64, v65
v_smfmac_f32_16x16x64_bf16 v[72:75], v[44:47], a[224:231], v3
v_add_f32 v66, v66, v67
v_smfmac_f32_16x16x64_bf16 v[68:71], v[48:51], a[168:175], v3
v_cvt_pk_bf16_f32 v15, v64, v66
v_smfmac_f32_16x16x64_bf16 v[72:75], v[48:51], a[232:239], v3
ds_write2_b32 v4, v0, v15 offset0:0 offset1:64
v_smfmac_f32_16x16x64_bf16 v[68:71], v[52:55], a[176:183], v3
buffer_load_dwordx4 v1, s[4:7], s64 offen offset:2048 sc1 lds
v_smfmac_f32_16x16x64_bf16 v[72:75], v[52:55], a[240:247], v3
ds_read_b128 v[64:67], v14 offset:7168
v_smfmac_f32_16x16x64_bf16 v[68:71], v[56:59], a[184:191], v3
v_smfmac_f32_16x16x64_bf16 v[72:75], v[56:59], a[248:255], v3
v_smfmac_f32_16x16x64_bf16 v[76:79], v[36:39], v[144:151], v3
s_nop 0
v_add_f32 v68, v68, v69
v_add_f32 v70, v70, v71
v_cvt_pk_bf16_f32 v0, v68, v70
v_smfmac_f32_16x16x64_bf16 v[80:83], v[36:39], v[208:215], v3
v_add_f32 v72, v72, v73
v_add_f32 v74, v74, v75
v_cvt_pk_bf16_f32 v15, v72, v74
ds_write2_b32 v5, v0, v15 offset0:0 offset1:128
ds_read_b128 v[36:39], v14 offset:2048
v_smfmac_f32_16x16x64_bf16 v[76:79], v[40:43], v[152:159], v3
s_waitcnt lgkmcnt(0)
s_barrier
ds_read_b64_tr_b16 v[84:85], v6 offset:0
ds_read_b64_tr_b16 v[86:87], v6 offset:64
v_smfmac_f32_16x16x64_bf16 v[80:83], v[40:43], v[216:223], v3
ds_read_b64_tr_b16 v[88:89], v6 offset:512
ds_read_b64_tr_b16 v[90:91], v6 offset:576
v_smfmac_f32_16x16x64_bf16 v[76:79], v[44:47], v[160:167], v3
ds_read_b64_tr_b16 v[92:93], v6 offset:1024
ds_read_b64_tr_b16 v[94:95], v6 offset:1088
v_smfmac_f32_16x16x64_bf16 v[80:83], v[44:47], v[224:231], v3
ds_read_b64_tr_b16 v[96:97], v6 offset:1536
ds_read_b64_tr_b16 v[98:99], v6 offset:1600
v_smfmac_f32_16x16x64_bf16 v[76:79], v[48:51], v[168:175], v3
ds_read_b128 v[40:43], v14 offset:3072
v_smfmac_f32_16x16x64_bf16 v[80:83], v[48:51], v[232:239], v3
v_smfmac_f32_16x16x64_bf16 v[76:79], v[52:55], v[176:183], v3
ds_read_b64_tr_b16 v[44:45], v7 offset:0
ds_read_b64_tr_b16 v[46:47], v7 offset:128
ds_read_b64_tr_b16 v[48:49], v7 offset:1024
ds_read_b64_tr_b16 v[50:51], v7 offset:1152
v_smfmac_f32_16x16x64_bf16 v[80:83], v[52:55], v[240:247], v3
ds_read_b64_tr_b16 v[52:53], v7 offset:2048
ds_read_b64_tr_b16 v[54:55], v7 offset:2176
v_smfmac_f32_16x16x64_bf16 v[76:79], v[56:59], v[184:191], v3
v_smfmac_f32_16x16x64_bf16 v[80:83], v[56:59], v[248:255], v3
ds_read_b64_tr_b16 v[56:57], v7 offset:3072
ds_read_b64_tr_b16 v[58:59], v7 offset:3200
s_waitcnt lgkmcnt(8)
v_mfma_f32_16x16x32_bf16 v[72:75], v[100:103], v[84:87], 0
buffer_load_dwordx4 v1, s[4:7], s64 offen offset:3072 sc1 lds
v_mfma_f32_16x16x32_bf16 v[72:75], v[104:107], v[88:91], v[72:75]
v_add_f32 v76, v76, v77
v_add_f32 v78, v78, v79
v_mfma_f32_16x16x32_bf16 v[72:75], v[108:111], v[92:95], v[72:75]
v_cvt_pk_bf16_f32 v77, v76, v78
v_add_f32 v80, v80, v81
v_mfma_f32_16x16x32_bf16 v[72:75], v[64:67], v[96:99], v[72:75]
v_add_f32 v82, v82, v83
v_cvt_pk_bf16_f32 v83, v80, v82
v_mfma_f32_16x16x32_bf16 v[68:71], v[28:31], v[84:87], 0
v_mov_b32 v82, v77
v_lshrrev_b32 v15, 1, v1
ds_read_b128 v[100:103], v10 offset:0
v_mfma_f32_16x16x32_bf16 v[68:71], v[32:35], v[88:91], v[68:71]
ds_read_b128 v[104:107], v10 offset:1024
buffer_store_dwordx2 v[82:83], v15, s[4:7], s65 offen sc1
v_mfma_f32_16x16x32_bf16 v[68:71], v[36:39], v[92:95], v[68:71]
v_mfma_f32_16x16x32_bf16 v[68:71], v[40:43], v[96:99], v[68:71]
s_waitcnt lgkmcnt(2)
v_mfma_f32_16x16x32_bf16 v[60:63], v[44:47], v[84:87], 0
ds_read_b128 v[28:31], v14 offset:8192
buffer_store_dwordx4 v[44:47], v1, s[4:7], s66 offen sc1
v_max3_f32 v0, v72, v73, v74
v_mfma_f32_16x16x32_bf16 v[60:63], v[48:51], v[88:91], v[60:63]
ds_read_b128 v[32:35], v14 offset:9216
v_mfma_f32_16x16x32_bf16 v[60:63], v[52:55], v[92:95], v[60:63]
ds_read_b128 v[36:39], v11 offset:0
v_max3_f32 v0, v0, v75, v68
v_max3_f32 v0, v0, v69, v70
v_mfma_f32_16x16x32_bf16 v[60:63], v[56:59], v[96:99], v[60:63]
ds_read_b128 v[40:43], v11 offset:1024
v_max_f32 v0, v0, v71
s_cmp_eq_u32 s34, 63
s_cbranch_scc1 L_chain_fin
s_nop 1
s_nop 1
v_max3_f32 v0, v0, v60, v61
v_mov_b32 v15, v0
s_nop 1
v_permlane16_swap_b32 v0, v15
v_max_f32 v0, v0, v15
v_mov_b32 v15, v0
s_nop 1
v_permlane32_swap_b32 v0, v15
v_max_f32 v0, v0, v15
v_mul_f32 v62, s38, v0
v_pk_fma_f32 v[68:69], v[68:69], s[38:39], v[62:63] op_sel_hi:[1,1,0] neg_lo:[0,0,1] neg_hi:[0,0,1]
v_pk_fma_f32 v[70:71], v[70:71], s[38:39], v[62:63] op_sel_hi:[1,1,0] neg_lo:[0,0,1] neg_hi:[0,0,1]
v_pk_fma_f32 v[72:73], v[72:73], s[38:39], v[62:63] op_sel_hi:[1,1,0] neg_lo:[0,0,1] neg_hi:[0,0,1]
v_pk_fma_f32 v[74:75], v[74:75], s[38:39], v[62:63] op_sel_hi:[1,1,0] neg_lo:[0,0,1] neg_hi:[0,0,1]
v_pk_fma_f32 v[60:61], v[60:61], s[38:39], v[62:63] op_sel_hi:[1,1,0] neg_lo:[0,0,1] neg_hi:[0,0,1]
v_exp_f32 v68, v68
v_exp_f32 v69, v69
ds_read_b128 v[44:47], v10 offset:2048
v_exp_f32 v70, v70
v_exp_f32 v71, v71
ds_read_b128 v[48:51], v10 offset:3072
v_cvt_pk_bf16_f32 v76, v68, v69
v_exp_f32 v72, v72
v_cvt_pk_bf16_f32 v77, v70, v71
v_exp_f32 v73, v73
s_waitcnt lgkmcnt(4)
v_mfma_f32_16x16x16_bf16 v[92:95], v[16:17], v[76:77], 0
v_exp_f32 v74, v74
v_mfma_f32_16x16x16_bf16 v[84:87], v[28:29], v[76:77], 0
v_exp_f32 v75, v75
v_mfma_f32_16x16x16_bf16 v[88:91], v[32:33], v[76:77], 0
v_cvt_pk_bf16_f32 v78, v72, v73
v_exp_f32 v60, v60
v_cvt_pk_bf16_f32 v79, v74, v75
v_exp_f32 v61, v61
s_nop 0
v_mfma_f32_16x16x16_bf16 v[92:95], v[16:17], v[78:79], v[92:95]
ds_read_b128 v[52:55], v11 offset:2048
v_cvt_pk_bf16_f32 v24, v60, v61
v_mfma_f32_16x16x16_bf16 v[84:87], v[30:31], v[78:79], v[84:87]
ds_read_b128 v[56:59], v11 offset:3072
v_cvt_pk_bf16_f32 v27, v60, v61
v_mfma_f32_16x16x16_bf16 v[88:91], v[34:35], v[78:79], v[88:91]
v_mfma_f32_16x16x16_bf16 v[92:95], v[16:17], v[24:25], v[92:95]
v_mfma_f32_16x16x16_bf16 v[84:87], v[82:83], v[24:25], v[84:87]
v_mfma_f32_16x16x16_bf16 v[88:91], v[82:83], v[26:27], v[88:91]
s_nop 0
v_rcp_f32 v0, v92
s_nop 2
v_pk_mul_f32 v[84:85], v[84:85], v[0:1] op_sel_hi:[1,0]
v_pk_mul_f32 v[86:87], v[86:87], v[0:1] op_sel_hi:[1,0]
v_cvt_pk_bf16_f32 v84, v84, v85
v_cvt_pk_bf16_f32 v85, v86, v87
ds_write_b64 v8, v[84:85]
v_pk_mul_f32 v[88:89], v[88:89], v[0:1] op_sel_hi:[1,0]
v_pk_mul_f32 v[90:91], v[90:91], v[0:1] op_sel_hi:[1,0]
v_cvt_pk_bf16_f32 v88, v88, v89
v_cvt_pk_bf16_f32 v89, v90, v91
ds_write_b64 v8, v[88:89] offset:32
v_mov_b64 v[68:69], 0
v_mov_b64 v[70:71], 0
v_mov_b64 v[72:73], 0
v_mov_b64 v[74:75], 0
v_mov_b64 v[76:77], 0
v_mov_b64 v[78:79], 0
v_mov_b64 v[60:61], 0
v_mov_b64 v[62:63], 0
s_waitcnt vmcnt(6) lgkmcnt(0)
s_barrier
ds_read_b128 v[28:31], v9
ds_read_b128 v[32:35], v9 offset:128
ds_read_b128 v[84:87], v10 offset:4096
ds_read_b128 v[88:91], v10 offset:5120
v_mov_b64 v[64:65], 0
v_mov_b64 v[66:67], 0
v_mov_b64 v[80:81], 0
v_mov_b64 v[82:83], 0
v_mov_b64 v[96:97], 0
v_mov_b64 v[98:99], 0
v_mov_b64 v[92:93], 0
v_mov_b64 v[94:95], 0
s_waitcnt lgkmcnt(2)
v_smfmac_f32_16x16x64_bf16 v[72:75], v[28:31], v[100:107], v3
ds_read_b128 v[100:103], v11 offset:4096
ds_read_b128 v[104:107], v11 offset:5120
v_smfmac_f32_16x16x64_bf16 v[72:75], v[32:35], v[36:43], v3
ds_read_b128 v[36:39], v10 offset:6144
ds_read_b128 v[40:43], v10 offset:7168
v_smfmac_f32_16x16x64_bf16 v[76:79], v[28:31], v[44:51], v3
ds_read_b128 v[44:47], v11 offset:6144
ds_read_b128 v[48:51], v11 offset:7168
v_smfmac_f32_16x16x64_bf16 v[76:79], v[32:35], v[52:59], v3
ds_read_b128 v[52:55], v10 offset:8192
ds_read_b128 v[56:59], v10 offset:9216
v_add_f32 v72, v72, v73
v_smfmac_f32_16x16x64_bf16 v[68:71], v[28:31], v[112:119], v3
v_add_f32 v74, v74, v75
v_cvt_pk_bf16_f32 v109, v72, v74
v_smfmac_f32_16x16x64_bf16 v[68:71], v[32:35], v[120:127], v3
s_nop 0
v_add_f32 v76, v76, v77
v_add_f32 v78, v78, v79
s_waitcnt lgkmcnt(6)
v_smfmac_f32_16x16x64_bf16 v[60:63], v[28:31], v[84:91], v3
ds_read_b128 v[84:87], v11 offset:8192
ds_read_b128 v[88:91], v11 offset:9216
v_cvt_pk_bf16_f32 v110, v76, v78
v_smfmac_f32_16x16x64_bf16 v[60:63], v[32:35], v[100:107], v3
ds_read_b128 v[100:103], v10 offset:10240
ds_read_b128 v[104:107], v10 offset:11264
v_add_f32 v68, v68, v69
s_waitcnt lgkmcnt(6)
v_smfmac_f32_16x16x64_bf16 v[64:67], v[28:31], v[36:43], v3
ds_read_b128 v[36:39], v11 offset:10240
ds_read_b128 v[40:43], v11 offset:11264
v_add_f32 v70, v70, v71
v_cvt_pk_bf16_f32 v108, v68, v70
v_smfmac_f32_16x16x64_bf16 v[64:67], v[32:35], v[44:51], v3
ds_read_b128 v[44:47], v10 offset:12288
ds_read_b128 v[48:51], v10 offset:13312
v_add_f32 v60, v60, v61
v_add_f32 v62, v62, v63
v_cvt_pk_bf16_f32 v111, v60, v62
buffer_store_dwordx4 v[108:111], v12, s[4:7], s45 offen
s_waitcnt lgkmcnt(6)
v_smfmac_f32_16x16x64_bf16 v[80:83], v[28:31], v[52:59], v3
ds_read_b128 v[52:55], v11 offset:12288
ds_read_b128 v[56:59], v11 offset:13312
v_smfmac_f32_16x16x64_bf16 v[80:83], v[32:35], v[84:91], v3
v_add_f32 v64, v64, v65
v_add_f32 v66, v66, v67
s_waitcnt lgkmcnt(4)
v_smfmac_f32_16x16x64_bf16 v[96:99], v[28:31], v[100:107], v3
v_cvt_pk_bf16_f32 v108, v64, v66
v_smfmac_f32_16x16x64_bf16 v[96:99], v[32:35], v[36:43], v3
s_nop 0
v_add_f32 v80, v80, v81
v_add_f32 v82, v82, v83
s_waitcnt lgkmcnt(0)
v_smfmac_f32_16x16x64_bf16 v[92:95], v[28:31], v[44:51], v3
v_cvt_pk_bf16_f32 v109, v80, v82
v_smfmac_f32_16x16x64_bf16 v[92:95], v[32:35], v[52:59], v3
v_add_f32 v96, v96, v97
v_add_f32 v98, v98, v99
v_cvt_pk_bf16_f32 v110, v96, v98
s_nop 4
v_add_f32 v92, v92, v93
v_add_f32 v94, v94, v95
v_cvt_pk_bf16_f32 v111, v92, v94
buffer_store_dwordx4 v[108:111], v12, s[4:7], s67 offen
s_mov_b32 s46, s69
s_add_u32 s43, s34, 2
s_min_u32 s43, s43, 63
s_cmp_gt_u32 s60, s43
s_cbranch_scc1 L_kr62
v_lshrrev_b32 v15, 2, v1
L_krl62:
buffer_load_dword v0, v15, s[4:7], s61 offen sc1
s_add_u32 s51, s51, 1
s_cmp_gt_u32 s51, 300000
s_cbranch_scc1 L_end
s_waitcnt vmcnt(0)
v_cmp_eq_u32 vcc, 0, v0
s_ff1_i32_b64 s60, vcc
s_min_u32 s60, s60, 64
s_cmp_gt_u32 s60, s43
s_cbranch_scc0 L_krl62
L_kr62:
s_mov_b32 s44, s35
v_mov_b64 v[60:61], 0
v_mov_b64 v[62:63], 0
v_mov_b64 v[64:65], 0
v_mov_b64 v[66:67], 0
v_mov_b64 v[68:69], 0
v_mov_b64 v[70:71], 0
v_mov_b64 v[72:73], 0
v_mov_b64 v[74:75], 0
v_mov_b64 v[76:77], 0
v_mov_b64 v[78:79], 0
v_mov_b64 v[80:81], 0
v_mov_b64 v[82:83], 0
v_mov_b64 v[100:101], -1
v_mov_b64 v[102:103], -1
s_add_u32 s47, s68, 0
s_add_u32 s34, s34, 1
s_add_u32 s35, s34, 1
s_and_b32 s43, s34, 1
s_lshl_b32 s43, s43, 14
s_xor_b32 s42, s43, 16384
v_add_u32 v14, s42, v2
s_add_u32 s43, s43, 114688
s_mov_b32 m0, s43
s_add_u32 s42, s34, 1
s_cmp_eq_u32 s34, 63
s_cselect_b32 s42, 62, s42
s_lshl_b32 s64, s42, 19
s_lshl_b32 s40, s32, 14
s_add_u32 s64, s64, s40
s_add_u32 s64, s64, 0
s_lshl_b32 s50, s34, 5
s_add_u32 s50, s50, s32
s_lshl_b32 s65, s50, 11
s_add_u32 s65, s65, 41943040
s_lshl_b32 s66, s50, 12
s_add_u32 s66, s66, 33554432
s_and_b32 s45, s34, 1
s_mul_i32 s45, s45, 262144
s_mul_i32 s40, s32, 8192
s_add_u32 s68, s45, s40
s_add_u32 s68, s68, 46137344
s_add_u32 s45, s45, s56
s_add_u32 s45, s45, 46137344
s_add_u32 s67, s45, 32768
s_add_u32 s40, s34, 1
s_and_b32 s40, s40, 3
s_lshl_b32 s40, s40, 13
s_add_u32 s69, s40, 47185920
s_barrier
s_sleep 3
buffer_load_dwordx4 v[28:31], v1, s[4:7], s46 offen offset:0 sc1
buffer_load_dwordx4 v[32:35], v1, s[4:7], s46 offen offset:1024 sc1
s_sleep 1
L_pa_w0f:
buffer_load_dwordx4 v[84:87], v1, s[4:7], s46 offen offset:0 sc1
buffer_load_dwordx4 v[88:91], v1, s[4:7], s46 offen offset:1024 sc1
s_waitcnt vmcnt(2)
v_max3_u32 v0, v28, v29, v30
v_max3_u32 v15, v31, v32, v33
v_max3_u32 v0, v0, v34, v35
v_max_u32 v0, v0, v15
v_cmp_eq_u32 vcc, -1, v0
s_cbranch_vccz L_paok_w0f
buffer_load_dwordx4 v[28:31], v1, s[4:7], s46 offen offset:0 sc1
buffer_load_dwordx4 v[32:35], v1, s[4:7], s46 offen offset:1024 sc1
s_add_u32 s51, s51, 1
s_cmp_gt_u32 s51, 300000
s_cbranch_scc1 L_end
s_waitcnt vmcnt(2)
v_max3_u32 v0, v84, v85, v86
v_max3_u32 v15, v87, v88, v89
v_max3_u32 v0, v0, v90, v91
v_max_u32 v0, v0, v15
v_cmp_eq_u32 vcc, -1, v0
s_cbranch_vccnz L_pa_w0f
v_mov_b64 v[28:29], v[84:85]
v_mov_b64 v[30:31], v[86:87]
v_mov_b64 v[32:33], v[88:89]
v_mov_b64 v[34:35], v[90:91]
s_branch L_paok2_w0f
L_paok_w0f:
L_paok2_w0f:
s_branch L_step_w0f
L_step_w1f:
v_smfmac_f32_16x16x64_bf16 v[60:63], v[28:31], a[16:23], v3
ds_write_b128 v2, v[28:31] offset:34816
v_smfmac_f32_16x16x64_bf16 v[64:67], v[28:31], a[80:87], v3
ds_write_b128 v2, v[32:35] offset:35840
v_smfmac_f32_16x16x64_bf16 v[68:71], v[28:31], a[144:151], v3
v_smfmac_f32_16x16x64_bf16 v[72:75], v[28:31], a[208:215], v3
v_smfmac_f32_16x16x64_bf16 v[60:63], v[32:35], a[24:31], v3
v_smfmac_f32_16x16x64_bf16 v[64:67], v[32:35], a[88:95], v3
v_smfmac_f32_16x16x64_bf16 v[68:71], v[32:35], a[152:159], v3
v_smfmac_f32_16x16x64_bf16 v[72:75], v[32:35], a[216:223], v3
s_waitcnt lgkmcnt(0)
s_barrier
ds_read_b128 v[36:39], v2 offset:32768
ds_read_b128 v[40:43], v2 offset:33792
v_smfmac_f32_16x16x64_bf16 v[76:79], v[28:31], v[144:151], v3
ds_read_b128 v[44:47], v2 offset:36864
ds_read_b128 v[48:51], v2 offset:37888
v_smfmac_f32_16x16x64_bf16 v[80:83], v[28:31], v[208:215], v3
ds_read_b128 v[52:55], v2 offset:38912
ds_read_b128 v[56:59], v2 offset:39936
v_smfmac_f32_16x16x64_bf16 v[76:79], v[32:35], v[152:159], v3
v_smfmac_f32_16x16x64_bf16 v[80:83], v[32:35], v[216:223], v3
s_waitcnt lgkmcnt(4)
v_smfmac_f32_16x16x64_bf16 v[60:63], v[36:39], a[0:7], v3
v_smfmac_f32_16x16x64_bf16 v[64:67], v[36:39], a[64:71], v3
v_smfmac_f32_16x16x64_bf16 v[60:63], v[40:43], a[8:15], v3
v_smfmac_f32_16x16x64_bf16 v[64:67], v[40:43], a[72:79], v3
s_waitcnt vmcnt(0) lgkmcnt(0)
v_smfmac_f32_16x16x64_bf16 v[60:63], v[44:47], a[32:39], v3
ds_read_b128 v[28:31], v14 offset:0
v_smfmac_f32_16x16x64_bf16 v[64:67], v[44:47], a[96:103], v3
buffer_store_dwordx4 v[100:103], v1, s[4:7], s47 offen offset:0
ds_read_b128 v[32:35], v14 offset:1024
v_smfmac_f32_16x16x64_bf16 v[60:63], v[48:51], a[40:47], v3
ds_read_b128 v[104:107], v14 offset:5120
v_smfmac_f32_16x16x64_bf16 v[64:67], v[48:51], a[104:111], v3
ds_read_b128 v[108:111], v14 offset:6144
v_smfmac_f32_16x16x64_bf16 v[60:63], v[52:55], a[48:55], v3
v_smfmac_f32_16x16x64_bf16 v[64:67], v[52:55], a[112:119], v3
buffer_store_dwordx4 v[100:103], v1, s[4:7], s47 offen offset:1024
v_smfmac_f32_16x16x64_bf16 v[60:63], v[56:59], a[56:63], v3
v_smfmac_f32_16x16x64_bf16 v[64:67], v[56:59], a[120:127], v3
v_smfmac_f32_16x16x64_bf16 v[68:71], v[36:39], a[128:135], v3
v_smfmac_f32_16x16x64_bf16 v[72:75], v[36:39], a[192:199], v3
ds_read_b128 v[100:103], v14 offset:4096
buffer_load_dwordx4 v1, s[4:7], s64 offen offset:0 sc1 lds
v_add_f32 v60, v60, v61
v_smfmac_f32_16x16x64_bf16 v[68:71], v[40:43], a[136:143], v3
v_add_f32 v62, v62, v63
v_smfmac_f32_16x16x64_bf16 v[72:75], v[40:43], a[200:207], v3
v_cvt_pk_bf16_f32 v0, v60, v62
v_smfmac_f32_16x16x64_bf16 v[68:71], v[44:47], a[160:167], v3
v_add_f32 v64, v64, v65
v_smfmac_f32_16x16x64_bf16 v[72:75], v[44:47], a[224:231], v3
buffer_load_dwordx4 v1, s[4:7], s64 offen offset:1024 sc1 lds
v_add_f32 v66, v66, v67
v_smfmac_f32_16x16x64_bf16 v[68:71], v[48:51], a[168:175], v3
v_cvt_pk_bf16_f32 v15, v64, v66
v_smfmac_f32_16x16x64_bf16 v[72:75], v[48:51], a[232:239], v3
ds_write2_b32 v4, v0, v15 offset0:0 offset1:64
v_smfmac_f32_16x16x64_bf16 v[68:71], v[52:55], a[176:183], v3
v_smfmac_f32_16x16x64_bf16 v[72:75], v[52:55], a[240:247], v3
buffer_load_dwordx4 v1, s[4:7], s64 offen offset:2048 sc1 lds
ds_read_b128 v[64:67], v14 offset:7168
v_smfmac_f32_16x16x64_bf16 v[68:71], v[56:59], a[184:191], v3
v_smfmac_f32_16x16x64_bf16 v[72:75], v[56:59], a[248:255], v3
v_smfmac_f32_16x16x64_bf16 v[76:79], v[36:39], v[128:135], v3
s_nop 0
v_add_f32 v68, v68, v69
v_add_f32 v70, v70, v71
v_cvt_pk_bf16_f32 v0, v68, v70
v_smfmac_f32_16x16x64_bf16 v[80:83], v[36:39], v[192:199], v3
v_add_f32 v72, v72, v73
v_add_f32 v74, v74, v75
v_cvt_pk_bf16_f32 v15, v72, v74
ds_write2_b32 v5, v0, v15 offset0:0 offset1:128
ds_read_b128 v[36:39], v14 offset:2048
v_smfmac_f32_16x16x64_bf16 v[76:79], v[40:43], v[136:143], v3
s_waitcnt lgkmcnt(0)
s_barrier
ds_read_b64_tr_b16 v[84:85], v6 offset:0
ds_read_b64_tr_b16 v[86:87], v6 offset:64
v_smfmac_f32_16x16x64_bf16 v[80:83], v[40:43], v[200:207], v3
ds_read_b64_tr_b16 v[88:89], v6 offset:512
ds_read_b64_tr_b16 v[90:91], v6 offset:576
v_smfmac_f32_16x16x64_bf16 v[76:79], v[44:47], v[160:167], v3
ds_read_b64_tr_b16 v[92:93], v6 offset:1024
ds_read_b64_tr_b16 v[94:95], v6 offset:1088
v_smfmac_f32_16x16x64_bf16 v[80:83], v[44:47], v[224:231], v3
ds_read_b64_tr_b16 v[96:97], v6 offset:1536
ds_read_b64_tr_b16 v[98:99], v6 offset:1600
v_smfmac_f32_16x16x64_bf16 v[76:79], v[48:51], v[168:175], v3
ds_read_b128 v[40:43], v14 offset:3072
v_smfmac_f32_16x16x64_bf16 v[80:83], v[48:51], v[232:239], v3
v_smfmac_f32_16x16x64_bf16 v[76:79], v[52:55], v[176:183], v3
ds_read_b64_tr_b16 v[44:45], v7 offset:0
ds_read_b64_tr_b16 v[46:47], v7 offset:128
ds_read_b64_tr_b16 v[48:49], v7 offset:1024
ds_read_b64_tr_b16 v[50:51], v7 offset:1152
v_smfmac_f32_16x16x64_bf16 v[80:83], v[52:55], v[240:247], v3
ds_read_b64_tr_b16 v[52:53], v7 offset:2048
ds_read_b64_tr_b16 v[54:55], v7 offset:2176
v_smfmac_f32_16x16x64_bf16 v[76:79], v[56:59], v[184:191], v3
v_smfmac_f32_16x16x64_bf16 v[80:83], v[56:59], v[248:255], v3
ds_read_b64_tr_b16 v[56:57], v7 offset:3072
ds_read_b64_tr_b16 v[58:59], v7 offset:3200
s_waitcnt lgkmcnt(8)
v_mfma_f32_16x16x32_bf16 v[72:75], v[100:103], v[84:87], 0
v_mfma_f32_16x16x32_bf16 v[72:75], v[104:107], v[88:91], v[72:75]
buffer_load_dwordx4 v1, s[4:7], s64 offen offset:3072 sc1 lds
v_add_f32 v76, v76, v77
v_add_f32 v78, v78, v79
v_mfma_f32_16x16x32_bf16 v[72:75], v[108:111], v[92:95], v[72:75]
v_cvt_pk_bf16_f32 v77, v76, v78
v_add_f32 v80, v80, v81
v_mfma_f32_16x16x32_bf16 v[72:75], v[64:67], v[96:99], v[72:75]
v_add_f32 v82, v82, v83
v_cvt_pk_bf16_f32 v83, v80, v82
v_mfma_f32_16x16x32_bf16 v[68:71], v[28:31], v[84:87], 0
v_mov_b32 v82, v77
v_lshrrev_b32 v15, 1, v1
ds_read_b128 v[100:103], v10 offset:0
v_mfma_f32_16x16x32_bf16 v[68:71], v[32:35], v[88:91], v[68:71]
ds_read_b128 v[104:107], v10 offset:1024
v_mfma_f32_16x16x32_bf16 v[68:71], v[36:39], v[92:95], v[68:71]
buffer_store_dwordx2 v[82:83], v15, s[4:7], s65 offen sc1
v_mfma_f32_16x16x32_bf16 v[68:71], v[40:43], v[96:99], v[68:71]
s_waitcnt lgkmcnt(2)
v_mfma_f32_16x16x32_bf16 v[60:63], v[44:47], v[84:87], 0
ds_read_b128 v[28:31], v14 offset:10240
v_max3_f32 v0, v72, v73, v74
v_mfma_f32_16x16x32_bf16 v[60:63], v[48:51], v[88:91], v[60:63]
ds_read_b128 v[32:35], v14 offset:11264
buffer_store_dwordx4 v[48:51], v1, s[4:7], s66 offen sc1
v_mfma_f32_16x16x32_bf16 v[60:63], v[52:55], v[92:95], v[60:63]
ds_read_b128 v[36:39], v11 offset:0
v_max3_f32 v0, v0, v75, v68
v_max3_f32 v0, v0, v69, v70
v_mfma_f32_16x16x32_bf16 v[60:63], v[56:59], v[96:99], v[60:63]
ds_read_b128 v[40:43], v11 offset:1024
v_max_f32 v0, v0, v71
s_cmp_eq_u32 s34, 63
s_cbranch_scc1 L_chain_fin
s_nop 1
s_nop 1
v_max3_f32 v0, v0, v60, v61
v_mov_b32 v15, v0
s_nop 1
v_permlane16_swap_b32 v0, v15
v_max_f32 v0, v0, v15
v_mov_b32 v15, v0
s_nop 1
v_permlane32_swap_b32 v0, v15
v_max_f32 v0, v0, v15
v_mul_f32 v62, s38, v0
v_pk_fma_f32 v[68:69], v[68:69], s[38:39], v[62:63] op_sel_hi:[1,1,0] neg_lo:[0,0,1] neg_hi:[0,0,1]
v_pk_fma_f32 v[70:71], v[70:71], s[38:39], v[62:63] op_sel_hi:[1,1,0] neg_lo:[0,0,1] neg_hi:[0,0,1]
v_pk_fma_f32 v[72:73], v[72:73], s[38:39], v[62:63] op_sel_hi:[1,1,0] neg_lo:[0,0,1] neg_hi:[0,0,1]
v_pk_fma_f32 v[74:75], v[74:75], s[38:39], v[62:63] op_sel_hi:[1,1,0] neg_lo:[0,0,1] neg_hi:[0,0,1]
v_pk_fma_f32 v[60:61], v[60:61], s[38:39], v[62:63] op_sel_hi:[1,1,0] neg_lo:[0,0,1] neg_hi:[0,0,1]
v_exp_f32 v68, v68
v_exp_f32 v69, v69
ds_read_b128 v[44:47], v10 offset:2048
v_exp_f32 v70, v70
v_exp_f32 v71, v71
ds_read_b128 v[48:51], v10 offset:3072
v_cvt_pk_bf16_f32 v76, v68, v69
v_exp_f32 v72, v72
v_cvt_pk_bf16_f32 v77, v70, v71
v_exp_f32 v73, v73
s_waitcnt lgkmcnt(4)
v_mfma_f32_16x16x16_bf16 v[92:95], v[16:17], v[76:77], 0
v_exp_f32 v74, v74
v_mfma_f32_16x16x16_bf16 v[84:87], v[28:29], v[76:77], 0
v_exp_f32 v75, v75
v_mfma_f32_16x16x16_bf16 v[88:91], v[32:33], v[76:77], 0
v_cvt_pk_bf16_f32 v78, v72, v73
v_exp_f32 v60, v60
v_cvt_pk_bf16_f32 v79, v74, v75
v_exp_f32 v61, v61
s_nop 0
v_mfma_f32_16x16x16_bf16 v[92:95], v[16:17], v[78:79], v[92:95]
ds_read_b128 v[52:55], v11 offset:2048
v_cvt_pk_bf16_f32 v24, v60, v61
v_mfma_f32_16x16x16_bf16 v[84:87], v[30:31], v[78:79], v[84:87]
ds_read_b128 v[56:59], v11 offset:3072
v_cvt_pk_bf16_f32 v27, v60, v61
v_mfma_f32_16x16x16_bf16 v[88:91], v[34:35], v[78:79], v[88:91]
v_mfma_f32_16x16x16_bf16 v[92:95], v[16:17], v[24:25], v[92:95]
v_mfma_f32_16x16x16_bf16 v[84:87], v[82:83], v[24:25], v[84:87]
v_mfma_f32_16x16x16_bf16 v[88:91], v[82:83], v[26:27], v[88:91]
s_nop 0
v_rcp_f32 v0, v92
s_nop 2
v_pk_mul_f32 v[84:85], v[84:85], v[0:1] op_sel_hi:[1,0]
v_pk_mul_f32 v[86:87], v[86:87], v[0:1] op_sel_hi:[1,0]
v_cvt_pk_bf16_f32 v84, v84, v85
v_cvt_pk_bf16_f32 v85, v86, v87
ds_write_b64 v8, v[84:85]
v_pk_mul_f32 v[88:89], v[88:89], v[0:1] op_sel_hi:[1,0]
v_pk_mul_f32 v[90:91], v[90:91], v[0:1] op_sel_hi:[1,0]
v_cvt_pk_bf16_f32 v88, v88, v89
v_cvt_pk_bf16_f32 v89, v90, v91
ds_write_b64 v8, v[88:89] offset:32
v_mov_b64 v[68:69], 0
v_mov_b64 v[70:71], 0
v_mov_b64 v[72:73], 0
v_mov_b64 v[74:75], 0
v_mov_b64 v[76:77], 0
v_mov_b64 v[78:79], 0
v_mov_b64 v[60:61], 0
v_mov_b64 v[62:63], 0
s_waitcnt vmcnt(6) lgkmcnt(0)
s_barrier
ds_read_b128 v[28:31], v9
ds_read_b128 v[32:35], v9 offset:128
ds_read_b128 v[84:87], v10 offset:4096
ds_read_b128 v[88:91], v10 offset:5120
v_mov_b64 v[64:65], 0
v_mov_b64 v[66:67], 0
v_mov_b64 v[80:81], 0
v_mov_b64 v[82:83], 0
v_mov_b64 v[96:97], 0
v_mov_b64 v[98:99], 0
v_mov_b64 v[92:93], 0
v_mov_b64 v[94:95], 0
s_waitcnt lgkmcnt(2)
v_smfmac_f32_16x16x64_bf16 v[72:75], v[28:31], v[100:107], v3
ds_read_b128 v[100:103], v11 offset:4096
ds_read_b128 v[104:107], v11 offset:5120
v_smfmac_f32_16x16x64_bf16 v[72:75], v[32:35], v[36:43], v3
ds_read_b128 v[36:39], v10 offset:6144
ds_read_b128 v[40:43], v10 offset:7168
v_smfmac_f32_16x16x64_bf16 v[76:79], v[28:31], v[44:51], v3
ds_read_b128 v[44:47], v11 offset:6144
ds_read_b128 v[48:51], v11 offset:7168
v_smfmac_f32_16x16x64_bf16 v[76:79], v[32:35], v[52:59], v3
ds_read_b128 v[52:55], v10 offset:8192
ds_read_b128 v[56:59], v10 offset:9216
v_add_f32 v72, v72, v73
v_smfmac_f32_16x16x64_bf16 v[68:71], v[28:31], v[112:119], v3
v_add_f32 v74, v74, v75
v_cvt_pk_bf16_f32 v109, v72, v74
v_smfmac_f32_16x16x64_bf16 v[68:71], v[32:35], v[120:127], v3
s_nop 0
v_add_f32 v76, v76, v77
v_add_f32 v78, v78, v79
s_waitcnt lgkmcnt(6)
v_smfmac_f32_16x16x64_bf16 v[60:63], v[28:31], v[84:91], v3
ds_read_b128 v[84:87], v11 offset:8192
ds_read_b128 v[88:91], v11 offset:9216
v_cvt_pk_bf16_f32 v110, v76, v78
v_smfmac_f32_16x16x64_bf16 v[60:63], v[32:35], v[100:107], v3
ds_read_b128 v[100:103], v10 offset:10240
ds_read_b128 v[104:107], v10 offset:11264
v_add_f32 v68, v68, v69
s_waitcnt lgkmcnt(6)
v_smfmac_f32_16x16x64_bf16 v[64:67], v[28:31], v[36:43], v3
ds_read_b128 v[36:39], v11 offset:10240
ds_read_b128 v[40:43], v11 offset:11264
v_add_f32 v70, v70, v71
v_cvt_pk_bf16_f32 v108, v68, v70
v_smfmac_f32_16x16x64_bf16 v[64:67], v[32:35], v[44:51], v3
ds_read_b128 v[44:47], v10 offset:12288
ds_read_b128 v[48:51], v10 offset:13312
v_add_f32 v60, v60, v61
v_add_f32 v62, v62, v63
v_cvt_pk_bf16_f32 v111, v60, v62
buffer_store_dwordx4 v[108:111], v12, s[4:7], s45 offen
s_waitcnt lgkmcnt(6)
v_smfmac_f32_16x16x64_bf16 v[80:83], v[28:31], v[52:59], v3
ds_read_b128 v[52:55], v11 offset:12288
ds_read_b128 v[56:59], v11 offset:13312
v_smfmac_f32_16x16x64_bf16 v[80:83], v[32:35], v[84:91], v3
v_add_f32 v64, v64, v65
v_add_f32 v66, v66, v67
s_waitcnt lgkmcnt(4)
v_smfmac_f32_16x16x64_bf16 v[96:99], v[28:31], v[100:107], v3
v_cvt_pk_bf16_f32 v108, v64, v66
v_smfmac_f32_16x16x64_bf16 v[96:99], v[32:35], v[36:43], v3
s_nop 0
v_add_f32 v80, v80, v81
v_add_f32 v82, v82, v83
s_waitcnt lgkmcnt(0)
v_smfmac_f32_16x16x64_bf16 v[92:95], v[28:31], v[44:51], v3
v_cvt_pk_bf16_f32 v109, v80, v82
v_smfmac_f32_16x16x64_bf16 v[92:95], v[32:35], v[52:59], v3
v_add_f32 v96, v96, v97
v_add_f32 v98, v98, v99
v_cvt_pk_bf16_f32 v110, v96, v98
s_nop 4
v_add_f32 v92, v92, v93
v_add_f32 v94, v94, v95
v_cvt_pk_bf16_f32 v111, v92, v94
buffer_store_dwordx4 v[108:111], v12, s[4:7], s67 offen
s_mov_b32 s46, s69
v_mov_b64 v[60:61], 0
v_mov_b64 v[62:63], 0
v_mov_b64 v[64:65], 0
v_mov_b64 v[66:67], 0
v_mov_b64 v[68:69], 0
v_mov_b64 v[70:71], 0
v_mov_b64 v[72:73], 0
v_mov_b64 v[74:75], 0
v_mov_b64 v[76:77], 0
v_mov_b64 v[78:79], 0
v_mov_b64 v[80:81], 0
v_mov_b64 v[82:83], 0
v_mov_b64 v[100:101], -1
v_mov_b64 v[102:103], -1
s_add_u32 s47, s68, 2048
s_add_u32 s34, s34, 1
s_add_u32 s35, s34, 1
s_and_b32 s43, s34, 1
s_lshl_b32 s43, s43, 14
s_xor_b32 s42, s43, 16384
v_add_u32 v14, s42, v2
s_add_u32 s43, s43, 118784
s_mov_b32 m0, s43
s_add_u32 s42, s34, 1
s_cmp_eq_u32 s34, 63
s_cselect_b32 s42, 62, s42
s_lshl_b32 s64, s42, 19
s_lshl_b32 s40, s32, 14
s_add_u32 s64, s64, s40
s_add_u32 s64, s64, 4096
s_lshl_b32 s50, s34, 5
s_add_u32 s50, s50, s32
s_lshl_b32 s65, s50, 11
s_add_u32 s65, s65, 41943552
s_lshl_b32 s66, s50, 12
s_add_u32 s66, s66, 33555456
s_and_b32 s45, s34, 1
s_mul_i32 s45, s45, 262144
s_mul_i32 s40, s32, 8192
s_add_u32 s68, s45, s40
s_add_u32 s68, s68, 46137344
s_add_u32 s45, s45, s56
s_add_u32 s45, s45, 46202880
s_add_u32 s67, s45, 32768
s_add_u32 s40, s34, 1
s_and_b32 s40, s40, 3
s_lshl_b32 s40, s40, 13
s_add_u32 s69, s40, 47187968
s_barrier
s_sleep 3
buffer_load_dwordx4 v[28:31], v1, s[4:7], s46 offen offset:0 sc1
buffer_load_dwordx4 v[32:35], v1, s[4:7], s46 offen offset:1024 sc1
s_sleep 1
L_pa_w1f:
buffer_load_dwordx4 v[84:87], v1, s[4:7], s46 offen offset:0 sc1
buffer_load_dwordx4 v[88:91], v1, s[4:7], s46 offen offset:1024 sc1
s_waitcnt vmcnt(2)
v_max3_u32 v0, v28, v29, v30
v_max3_u32 v15, v31, v32, v33
v_max3_u32 v0, v0, v34, v35
v_max_u32 v0, v0, v15
v_cmp_eq_u32 vcc, -1, v0
s_cbranch_vccz L_paok_w1f
buffer_load_dwordx4 v[28:31], v1, s[4:7], s46 offen offset:0 sc1
buffer_load_dwordx4 v[32:35], v1, s[4:7], s46 offen offset:1024 sc1
s_add_u32 s51, s51, 1
s_cmp_gt_u32 s51, 300000
s_cbranch_scc1 L_end
s_waitcnt vmcnt(2)
v_max3_u32 v0, v84, v85, v86
v_max3_u32 v15, v87, v88, v89
v_max3_u32 v0, v0, v90, v91
v_max_u32 v0, v0, v15
v_cmp_eq_u32 vcc, -1, v0
s_cbranch_vccnz L_pa_w1f
v_mov_b64 v[28:29], v[84:85]
v_mov_b64 v[30:31], v[86:87]
v_mov_b64 v[32:33], v[88:89]
v_mov_b64 v[34:35], v[90:91]
s_branch L_paok2_w1f
L_paok_w1f:
L_paok2_w1f:
s_branch L_step_w1f
L_step_w2f:
v_smfmac_f32_16x16x64_bf16 v[60:63], v[28:31], a[32:39], v3
ds_write_b128 v2, v[28:31] offset:36864
v_smfmac_f32_16x16x64_bf16 v[64:67], v[28:31], a[96:103], v3
ds_write_b128 v2, v[32:35] offset:37888
v_smfmac_f32_16x16x64_bf16 v[68:71], v[28:31], a[160:167], v3
v_smfmac_f32_16x16x64_bf16 v[72:75], v[28:31], a[224:231], v3
v_smfmac_f32_16x16x64_bf16 v[60:63], v[32:35], a[40:47], v3
v_smfmac_f32_16x16x64_bf16 v[64:67], v[32:35], a[104:111], v3
v_smfmac_f32_16x16x64_bf16 v[68:71], v[32:35], a[168:175], v3
v_smfmac_f32_16x16x64_bf16 v[72:75], v[32:35], a[232:239], v3
s_waitcnt lgkmcnt(0)
s_barrier
ds_read_b128 v[36:39], v2 offset:32768
ds_read_b128 v[40:43], v2 offset:33792
v_smfmac_f32_16x16x64_bf16 v[76:79], v[28:31], v[160:167], v3
ds_read_b128 v[44:47], v2 offset:34816
ds_read_b128 v[48:51], v2 offset:35840
v_smfmac_f32_16x16x64_bf16 v[80:83], v[28:31], v[224:231], v3
ds_read_b128 v[52:55], v2 offset:38912
ds_read_b128 v[56:59], v2 offset:39936
v_smfmac_f32_16x16x64_bf16 v[76:79], v[32:35], v[168:175], v3
v_smfmac_f32_16x16x64_bf16 v[80:83], v[32:35], v[232:239], v3
s_waitcnt lgkmcnt(4)
v_smfmac_f32_16x16x64_bf16 v[60:63], v[36:39], a[0:7], v3
v_smfmac_f32_16x16x64_bf16 v[64:67], v[36:39], a[64:71], v3
v_smfmac_f32_16x16x64_bf16 v[60:63], v[40:43], a[8:15], v3
v_smfmac_f32_16x16x64_bf16 v[64:67], v[40:43], a[72:79], v3
s_waitcnt vmcnt(0) lgkmcnt(0)
v_smfmac_f32_16x16x64_bf16 v[60:63], v[44:47], a[16:23], v3
ds_read_b128 v[28:31], v14 offset:0
v_smfmac_f32_16x16x64_bf16 v[64:67], v[44:47], a[80:87], v3
buffer_store_dwordx2 v[100:101], v13, s[4:7], s52 offen
ds_read_b128 v[32:35], v14 offset:1024
v_smfmac_f32_16x16x64_bf16 v[60:63], v[48:51], a[24:31], v3
buffer_store_dwordx4 v[100:103], v1, s[4:7], s47 offen offset:0
ds_read_b128 v[104:107], v14 offset:5120
v_smfmac_f32_16x16x64_bf16 v[64:67], v[48:51], a[88:95], v3
ds_read_b128 v[108:111], v14 offset:6144
v_smfmac_f32_16x16x64_bf16 v[60:63], v[52:55], a[48:55], v3
v_smfmac_f32_16x16x64_bf16 v[64:67], v[52:55], a[112:119], v3
v_smfmac_f32_16x16x64_bf16 v[60:63], v[56:59], a[56:63], v3
buffer_store_dwordx4 v[100:103], v1, s[4:7], s47 offen offset:1024
v_smfmac_f32_16x16x64_bf16 v[64:67], v[56:59], a[120:127], v3
v_smfmac_f32_16x16x64_bf16 v[68:71], v[36:39], a[128:135], v3
v_smfmac_f32_16x16x64_bf16 v[72:75], v[36:39], a[192:199], v3
ds_read_b128 v[100:103], v14 offset:4096
v_add_f32 v60, v60, v61
v_smfmac_f32_16x16x64_bf16 v[68:71], v[40:43], a[136:143], v3
buffer_load_dwordx4 v1, s[4:7], s64 offen offset:0 sc1 lds
v_add_f32 v62, v62, v63
v_smfmac_f32_16x16x64_bf16 v[72:75], v[40:43], a[200:207], v3
v_cvt_pk_bf16_f32 v0, v60, v62
v_smfmac_f32_16x16x64_bf16 v[68:71], v[44:47], a[144:151], v3
v_add_f32 v64, v64, v65
v_smfmac_f32_16x16x64_bf16 v[72:75], v[44:47], a[208:215], v3
v_add_f32 v66, v66, v67
v_smfmac_f32_16x16x64_bf16 v[68:71], v[48:51], a[152:159], v3
buffer_load_dwordx4 v1, s[4:7], s64 offen offset:1024 sc1 lds
v_cvt_pk_bf16_f32 v15, v64, v66
v_smfmac_f32_16x16x64_bf16 v[72:75], v[48:51], a[216:223], v3
ds_write2_b32 v4, v0, v15 offset0:0 offset1:64
v_smfmac_f32_16x16x64_bf16 v[68:71], v[52:55], a[176:183], v3
v_smfmac_f32_16x16x64_bf16 v[72:75], v[52:55], a[240:247], v3
ds_read_b128 v[64:67], v14 offset:7168
v_smfmac_f32_16x16x64_bf16 v[68:71], v[56:59], a[184:191], v3
buffer_load_dwordx4 v1, s[4:7], s64 offen offset:2048 sc1 lds
v_smfmac_f32_16x16x64_bf16 v[72:75], v[56:59], a[248:255], v3
v_smfmac_f32_16x16x64_bf16 v[76:79], v[36:39], v[128:135], v3
s_nop 0
v_add_f32 v68, v68, v69
v_add_f32 v70, v70, v71
v_cvt_pk_bf16_f32 v0, v68, v70
v_smfmac_f32_16x16x64_bf16 v[80:83], v[36:39], v[192:199], v3
v_add_f32 v72, v72, v73
v_add_f32 v74, v74, v75
v_cvt_pk_bf16_f32 v15, v72, v74
ds_write2_b32 v5, v0, v15 offset0:0 offset1:128
ds_read_b128 v[36:39], v14 offset:2048
v_smfmac_f32_16x16x64_bf16 v[76:79], v[40:43], v[136:143], v3
s_waitcnt lgkmcnt(0)
s_barrier
ds_read_b64_tr_b16 v[84:85], v6 offset:0
ds_read_b64_tr_b16 v[86:87], v6 offset:64
v_smfmac_f32_16x16x64_bf16 v[80:83], v[40:43], v[200:207], v3
ds_read_b64_tr_b16 v[88:89], v6 offset:512
ds_read_b64_tr_b16 v[90:91], v6 offset:576
v_smfmac_f32_16x16x64_bf16 v[76:79], v[44:47], v[144:151], v3
ds_read_b64_tr_b16 v[92:93], v6 offset:1024
ds_read_b64_tr_b16 v[94:95], v6 offset:1088
v_smfmac_f32_16x16x64_bf16 v[80:83], v[44:47], v[208:215], v3
ds_read_b64_tr_b16 v[96:97], v6 offset:1536
ds_read_b64_tr_b16 v[98:99], v6 offset:1600
v_smfmac_f32_16x16x64_bf16 v[76:79], v[48:51], v[152:159], v3
ds_read_b128 v[40:43], v14 offset:3072
v_smfmac_f32_16x16x64_bf16 v[80:83], v[48:51], v[216:223], v3
v_smfmac_f32_16x16x64_bf16 v[76:79], v[52:55], v[176:183], v3
ds_read_b64_tr_b16 v[44:45], v7 offset:0
ds_read_b64_tr_b16 v[46:47], v7 offset:128
ds_read_b64_tr_b16 v[48:49], v7 offset:1024
ds_read_b64_tr_b16 v[50:51], v7 offset:1152
v_smfmac_f32_16x16x64_bf16 v[80:83], v[52:55], v[240:247], v3
ds_read_b64_tr_b16 v[52:53], v7 offset:2048
ds_read_b64_tr_b16 v[54:55], v7 offset:2176
v_smfmac_f32_16x16x64_bf16 v[76:79], v[56:59], v[184:191], v3
v_smfmac_f32_16x16x64_bf16 v[80:83], v[56:59], v[248:255], v3
ds_read_b64_tr_b16 v[56:57], v7 offset:3072
ds_read_b64_tr_b16 v[58:59], v7 offset:3200
s_waitcnt lgkmcnt(8)
v_mfma_f32_16x16x32_bf16 v[72:75], v[100:103], v[84:87], 0
v_mfma_f32_16x16x32_bf16 v[72:75], v[104:107], v[88:91], v[72:75]
v_add_f32 v76, v76, v77
v_add_f32 v78, v78, v79
v_mfma_f32_16x16x32_bf16 v[72:75], v[108:111], v[92:95], v[72:75]
buffer_load_dwordx4 v1, s[4:7], s64 offen offset:3072 sc1 lds
v_cvt_pk_bf16_f32 v77, v76, v78
v_add_f32 v80, v80, v81
v_mfma_f32_16x16x32_bf16 v[72:75], v[64:67], v[96:99], v[72:75]
v_add_f32 v82, v82, v83
v_cvt_pk_bf16_f32 v83, v80, v82
v_mfma_f32_16x16x32_bf16 v[68:71], v[28:31], v[84:87], 0
v_mov_b32 v82, v77
v_lshrrev_b32 v15, 1, v1
ds_read_b128 v[100:103], v10 offset:0
v_mfma_f32_16x16x32_bf16 v[68:71], v[32:35], v[88:91], v[68:71]
ds_read_b128 v[104:107], v10 offset:1024
buffer_store_dwordx2 v[82:83], v15, s[4:7], s65 offen sc1
v_mfma_f32_16x16x32_bf16 v[68:71], v[36:39], v[92:95], v[68:71]
v_mfma_f32_16x16x32_bf16 v[68:71], v[40:43], v[96:99], v[68:71]
s_waitcnt lgkmcnt(2)
v_mfma_f32_16x16x32_bf16 v[60:63], v[44:47], v[84:87], 0
ds_read_b128 v[28:31], v14 offset:12288
v_max3_f32 v0, v72, v73, v74
v_mfma_f32_16x16x32_bf16 v[60:63], v[48:51], v[88:91], v[60:63]
ds_read_b128 v[32:35], v14 offset:13312
v_mfma_f32_16x16x32_bf16 v[60:63], v[52:55], v[92:95], v[60:63]
ds_read_b128 v[36:39], v11 offset:0
buffer_store_dwordx4 v[52:55], v1, s[4:7], s66 offen sc1
v_max3_f32 v0, v0, v75, v68
v_max3_f32 v0, v0, v69, v70
v_mfma_f32_16x16x32_bf16 v[60:63], v[56:59], v[96:99], v[60:63]
ds_read_b128 v[40:43], v11 offset:1024
v_max_f32 v0, v0, v71
s_cmp_eq_u32 s34, 63
s_cbranch_scc1 L_chain_fin
s_nop 1
s_nop 1
v_max3_f32 v0, v0, v60, v61
v_mov_b32 v15, v0
s_nop 1
v_permlane16_swap_b32 v0, v15
v_max_f32 v0, v0, v15
v_mov_b32 v15, v0
s_nop 1
v_permlane32_swap_b32 v0, v15
v_max_f32 v0, v0, v15
v_mul_f32 v62, s38, v0
v_pk_fma_f32 v[68:69], v[68:69], s[38:39], v[62:63] op_sel_hi:[1,1,0] neg_lo:[0,0,1] neg_hi:[0,0,1]
v_pk_fma_f32 v[70:71], v[70:71], s[38:39], v[62:63] op_sel_hi:[1,1,0] neg_lo:[0,0,1] neg_hi:[0,0,1]
v_pk_fma_f32 v[72:73], v[72:73], s[38:39], v[62:63] op_sel_hi:[1,1,0] neg_lo:[0,0,1] neg_hi:[0,0,1]
v_pk_fma_f32 v[74:75], v[74:75], s[38:39], v[62:63] op_sel_hi:[1,1,0] neg_lo:[0,0,1] neg_hi:[0,0,1]
v_pk_fma_f32 v[60:61], v[60:61], s[38:39], v[62:63] op_sel_hi:[1,1,0] neg_lo:[0,0,1] neg_hi:[0,0,1]
v_exp_f32 v68, v68
v_exp_f32 v69, v69
ds_read_b128 v[44:47], v10 offset:2048
v_exp_f32 v70, v70
v_exp_f32 v71, v71
ds_read_b128 v[48:51], v10 offset:3072
v_cvt_pk_bf16_f32 v76, v68, v69
v_exp_f32 v72, v72
v_cvt_pk_bf16_f32 v77, v70, v71
v_exp_f32 v73, v73
s_waitcnt lgkmcnt(4)
v_mfma_f32_16x16x16_bf16 v[92:95], v[16:17], v[76:77], 0
v_exp_f32 v74, v74
v_mfma_f32_16x16x16_bf16 v[84:87], v[28:29], v[76:77], 0
v_exp_f32 v75, v75
v_mfma_f32_16x16x16_bf16 v[88:91], v[32:33], v[76:77], 0
v_cvt_pk_bf16_f32 v78, v72, v73
v_exp_f32 v60, v60
v_cvt_pk_bf16_f32 v79, v74, v75
v_exp_f32 v61, v61
s_nop 0
v_mfma_f32_16x16x16_bf16 v[92:95], v[16:17], v[78:79], v[92:95]
ds_read_b128 v[52:55], v11 offset:2048
v_cvt_pk_bf16_f32 v24, v60, v61
v_mfma_f32_16x16x16_bf16 v[84:87], v[30:31], v[78:79], v[84:87]
ds_read_b128 v[56:59], v11 offset:3072
v_cvt_pk_bf16_f32 v27, v60, v61
v_mfma_f32_16x16x16_bf16 v[88:91], v[34:35], v[78:79], v[88:91]
v_mfma_f32_16x16x16_bf16 v[92:95], v[16:17], v[24:25], v[92:95]
v_mfma_f32_16x16x16_bf16 v[84:87], v[82:83], v[24:25], v[84:87]
v_mfma_f32_16x16x16_bf16 v[88:91], v[82:83], v[26:27], v[88:91]
s_nop 0
v_rcp_f32 v0, v92
s_nop 2
v_pk_mul_f32 v[84:85], v[84:85], v[0:1] op_sel_hi:[1,0]
v_pk_mul_f32 v[86:87], v[86:87], v[0:1] op_sel_hi:[1,0]
v_cvt_pk_bf16_f32 v84, v84, v85
v_cvt_pk_bf16_f32 v85, v86, v87
ds_write_b64 v8, v[84:85]
v_pk_mul_f32 v[88:89], v[88:89], v[0:1] op_sel_hi:[1,0]
v_pk_mul_f32 v[90:91], v[90:91], v[0:1] op_sel_hi:[1,0]
v_cvt_pk_bf16_f32 v88, v88, v89
v_cvt_pk_bf16_f32 v89, v90, v91
ds_write_b64 v8, v[88:89] offset:32
v_mov_b64 v[68:69], 0
v_mov_b64 v[70:71], 0
v_mov_b64 v[72:73], 0
v_mov_b64 v[74:75], 0
v_mov_b64 v[76:77], 0
v_mov_b64 v[78:79], 0
v_mov_b64 v[60:61], 0
v_mov_b64 v[62:63], 0
s_waitcnt vmcnt(6) lgkmcnt(0)
s_barrier
ds_read_b128 v[28:31], v9
ds_read_b128 v[32:35], v9 offset:128
ds_read_b128 v[84:87], v10 offset:4096
ds_read_b128 v[88:91], v10 offset:5120
v_mov_b64 v[64:65], 0
v_mov_b64 v[66:67], 0
v_mov_b64 v[80:81], 0
v_mov_b64 v[82:83], 0
v_mov_b64 v[96:97], 0
v_mov_b64 v[98:99], 0
v_mov_b64 v[92:93], 0
v_mov_b64 v[94:95], 0
s_waitcnt lgkmcnt(2)
v_smfmac_f32_16x16x64_bf16 v[72:75], v[28:31], v[100:107], v3
ds_read_b128 v[100:103], v11 offset:4096
ds_read_b128 v[104:107], v11 offset:5120
v_smfmac_f32_16x16x64_bf16 v[72:75], v[32:35], v[36:43], v3
ds_read_b128 v[36:39], v10 offset:6144
ds_read_b128 v[40:43], v10 offset:7168
v_smfmac_f32_16x16x64_bf16 v[76:79], v[28:31], v[44:51], v3
ds_read_b128 v[44:47], v11 offset:6144
ds_read_b128 v[48:51], v11 offset:7168
v_smfmac_f32_16x16x64_bf16 v[76:79], v[32:35], v[52:59], v3
ds_read_b128 v[52:55], v10 offset:8192
ds_read_b128 v[56:59], v10 offset:9216
v_add_f32 v72, v72, v73
v_smfmac_f32_16x16x64_bf16 v[68:71], v[28:31], v[112:119], v3
v_add_f32 v74, v74, v75
v_cvt_pk_bf16_f32 v109, v72, v74
v_smfmac_f32_16x16x64_bf16 v[68:71], v[32:35], v[120:127], v3
s_nop 0
v_add_f32 v76, v76, v77
v_add_f32 v78, v78, v79
s_waitcnt lgkmcnt(6)
v_smfmac_f32_16x16x64_bf16 v[60:63], v[28:31], v[84:91], v3
ds_read_b128 v[84:87], v11 offset:8192
ds_read_b128 v[88:91], v11 offset:9216
v_cvt_pk_bf16_f32 v110, v76, v78
v_smfmac_f32_16x16x64_bf16 v[60:63], v[32:35], v[100:107], v3
ds_read_b128 v[100:103], v10 offset:10240
ds_read_b128 v[104:107], v10 offset:11264
v_add_f32 v68, v68, v69
s_waitcnt lgkmcnt(6)
v_smfmac_f32_16x16x64_bf16 v[64:67], v[28:31], v[36:43], v3
ds_read_b128 v[36:39], v11 offset:10240
ds_read_b128 v[40:43], v11 offset:11264
v_add_f32 v70, v70, v71
v_cvt_pk_bf16_f32 v108, v68, v70
v_smfmac_f32_16x16x64_bf16 v[64:67], v[32:35], v[44:51], v3
ds_read_b128 v[44:47], v10 offset:12288
ds_read_b128 v[48:51], v10 offset:13312
v_add_f32 v60, v60, v61
v_add_f32 v62, v62, v63
v_cvt_pk_bf16_f32 v111, v60, v62
buffer_store_dwordx4 v[108:111], v12, s[4:7], s45 offen
s_waitcnt lgkmcnt(6)
v_smfmac_f32_16x16x64_bf16 v[80:83], v[28:31], v[52:59], v3
ds_read_b128 v[52:55], v11 offset:12288
ds_read_b128 v[56:59], v11 offset:13312
v_smfmac_f32_16x16x64_bf16 v[80:83], v[32:35], v[84:91], v3
v_add_f32 v64, v64, v65
v_add_f32 v66, v66, v67
s_waitcnt lgkmcnt(4)
v_smfmac_f32_16x16x64_bf16 v[96:99], v[28:31], v[100:107], v3
v_cvt_pk_bf16_f32 v108, v64, v66
v_smfmac_f32_16x16x64_bf16 v[96:99], v[32:35], v[36:43], v3
s_nop 0
v_add_f32 v80, v80, v81
v_add_f32 v82, v82, v83
s_waitcnt lgkmcnt(0)
v_smfmac_f32_16x16x64_bf16 v[92:95], v[28:31], v[44:51], v3
v_cvt_pk_bf16_f32 v109, v80, v82
v_smfmac_f32_16x16x64_bf16 v[92:95], v[32:35], v[52:59], v3
v_add_f32 v96, v96, v97
v_add_f32 v98, v98, v99
v_cvt_pk_bf16_f32 v110, v96, v98
s_nop 4
v_add_f32 v92, v92, v93
v_add_f32 v94, v94, v95
v_cvt_pk_bf16_f32 v111, v92, v94
buffer_store_dwordx4 v[108:111], v12, s[4:7], s67 offen
s_mov_b32 s44, 0
s_sleep 4
buffer_load_dwordx4 v[28:31], v1, s[4:7], s68 offen offset:0 sc1
buffer_load_dwordx4 v[32:35], v1, s[4:7], s68 offen offset:1024 sc1
buffer_load_dwordx4 v[36:39], v1, s[4:7], s68 offen offset:2048 sc1
buffer_load_dwordx4 v[40:43], v1, s[4:7], s68 offen offset:3072 sc1
buffer_load_dwordx4 v[44:47], v1, s[4:7], s48 offen offset:0 sc1
buffer_load_dwordx4 v[48:51], v1, s[4:7], s48 offen offset:1024 sc1
buffer_load_dwordx4 v[52:55], v1, s[4:7], s48 offen offset:2048 sc1
buffer_load_dwordx4 v[56:59], v1, s[4:7], s48 offen offset:3072 sc1
s_sleep 1
buffer_load_dwordx4 v[60:63], v1, s[4:7], s68 offen offset:0 sc1
buffer_load_dwordx4 v[64:67], v1, s[4:7], s68 offen offset:1024 sc1
buffer_load_dwordx4 v[68:71], v1, s[4:7], s68 offen offset:2048 sc1
buffer_load_dwordx4 v[72:75], v1, s[4:7], s68 offen offset:3072 sc1
buffer_load_dwordx4 v[76:79], v1, s[4:7], s48 offen offset:0 sc1
buffer_load_dwordx4 v[80:83], v1, s[4:7], s48 offen offset:1024 sc1
buffer_load_dwordx4 v[84:87], v1, s[4:7], s48 offen offset:2048 sc1
buffer_load_dwordx4 v[88:91], v1, s[4:7], s48 offen offset:3072 sc1
L_pr0_w2f:
s_waitcnt vmcnt(15)
v_mfma_f32_16x16x32_bf16 v[100:103], v[28:31], v[20:23], 0
v_max3_u32 v0, v28, v29, v30
v_max_u32 v0, v0, v31
s_waitcnt vmcnt(14)
v_mfma_f32_16x16x32_bf16 v[100:103], v[32:35], v[20:23], v[100:103]
v_max3_u32 v0, v0, v32, v33
v_max3_u32 v0, v0, v34, v35
s_waitcnt vmcnt(13)
v_mfma_f32_16x16x32_bf16 v[100:103], v[36:39], v[20:23], v[100:103]
v_max3_u32 v0, v0, v36, v37
v_max3_u32 v0, v0, v38, v39
s_waitcnt vmcnt(12)
v_mfma_f32_16x16x32_bf16 v[100:103], v[40:43], v[20:23], v[100:103]
v_max3_u32 v0, v0, v40, v41
v_max3_u32 v0, v0, v42, v43
s_waitcnt vmcnt(11)
v_mfma_f32_16x16x32_bf16 v[100:103], v[44:47], v[20:23], v[100:103]
v_max3_u32 v0, v0, v44, v45
v_max3_u32 v0, v0, v46, v47
s_waitcnt vmcnt(10)
v_mfma_f32_16x16x32_bf16 v[100:103], v[48:51], v[20:23], v[100:103]
v_max3_u32 v0, v0, v48, v49
v_max3_u32 v0, v0, v50, v51
s_waitcnt vmcnt(9)
v_mfma_f32_16x16x32_bf16 v[100:103], v[52:55], v[20:23], v[100:103]
v_max3_u32 v0, v0, v52, v53
v_max3_u32 v0, v0, v54, v55
s_waitcnt vmcnt(8)
v_mfma_f32_16x16x32_bf16 v[100:103], v[56:59], v[20:23], v[100:103]
v_max3_u32 v0, v0, v56, v57
v_max3_u32 v0, v0, v58, v59
v_cmp_eq_u32 vcc, -1, v0
s_cbranch_vccz L_prok_w2f
buffer_load_dwordx4 v[28:31], v1, s[4:7], s68 offen offset:0 sc1
buffer_load_dwordx4 v[32:35], v1, s[4:7], s68 offen offset:1024 sc1
buffer_load_dwordx4 v[36:39], v1, s[4:7], s68 offen offset:2048 sc1
buffer_load_dwordx4 v[40:43], v1, s[4:7], s68 offen offset:3072 sc1
buffer_load_dwordx4 v[44:47], v1, s[4:7], s48 offen offset:0 sc1
buffer_load_dwordx4 v[48:51], v1, s[4:7], s48 offen offset:1024 sc1
buffer_load_dwordx4 v[52:55], v1, s[4:7], s48 offen offset:2048 sc1
buffer_load_dwordx4 v[56:59], v1, s[4:7], s48 offen offset:3072 sc1
s_waitcnt vmcnt(15)
v_mfma_f32_16x16x32_bf16 v[100:103], v[60:63], v[20:23], 0
v_max3_u32 v0, v60, v61, v62
v_max_u32 v0, v0, v63
s_waitcnt vmcnt(14)
v_mfma_f32_16x16x32_bf16 v[100:103], v[64:67], v[20:23], v[100:103]
v_max3_u32 v0, v0, v64, v65
v_max3_u32 v0, v0, v66, v67
s_waitcnt vmcnt(13)
v_mfma_f32_16x16x32_bf16 v[100:103], v[68:71], v[20:23], v[100:103]
v_max3_u32 v0, v0, v68, v69
v_max3_u32 v0, v0, v70, v71
s_waitcnt vmcnt(12)
v_mfma_f32_16x16x32_bf16 v[100:103], v[72:75], v[20:23], v[100:103]
v_max3_u32 v0, v0, v72, v73
v_max3_u32 v0, v0, v74, v75
s_waitcnt vmcnt(11)
v_mfma_f32_16x16x32_bf16 v[100:103], v[76:79], v[20:23], v[100:103]
v_max3_u32 v0, v0, v76, v77
v_max3_u32 v0, v0, v78, v79
s_waitcnt vmcnt(10)
v_mfma_f32_16x16x32_bf16 v[100:103], v[80:83], v[20:23], v[100:103]
v_max3_u32 v0, v0, v80, v81
v_max3_u32 v0, v0, v82, v83
s_waitcnt vmcnt(9)
v_mfma_f32_16x16x32_bf16 v[100:103], v[84:87], v[20:23], v[100:103]
v_max3_u32 v0, v0, v84, v85
v_max3_u32 v0, v0, v86, v87
s_waitcnt vmcnt(8)
v_mfma_f32_16x16x32_bf16 v[100:103], v[88:91], v[20:23], v[100:103]
v_max3_u32 v0, v0, v88, v89
v_max3_u32 v0, v0, v90, v91
v_cmp_eq_u32 vcc, -1, v0
s_cbranch_vccz L_prok_w2f
buffer_load_dwordx4 v[60:63], v1, s[4:7], s68 offen offset:0 sc1
buffer_load_dwordx4 v[64:67], v1, s[4:7], s68 offen offset:1024 sc1
buffer_load_dwordx4 v[68:71], v1, s[4:7], s68 offen offset:2048 sc1
buffer_load_dwordx4 v[72:75], v1, s[4:7], s68 offen offset:3072 sc1
buffer_load_dwordx4 v[76:79], v1, s[4:7], s48 offen offset:0 sc1
buffer_load_dwordx4 v[80:83], v1, s[4:7], s48 offen offset:1024 sc1
buffer_load_dwordx4 v[84:87], v1, s[4:7], s48 offen offset:2048 sc1
buffer_load_dwordx4 v[88:91], v1, s[4:7], s48 offen offset:3072 sc1
s_add_u32 s51, s51, 1
s_cmp_gt_u32 s51, 300000
s_cbranch_scc1 L_end
s_branch L_pr0_w2f
L_prok_w2f:
s_nop 3
v_cvt_pk_bf16_f32 v104, v100, v101
v_cvt_pk_bf16_f32 v105, v102, v103
buffer_store_dwordx2 v[104:105], v13, s[4:7], s49 offen
s_barrier
s_waitcnt vmcnt(1)
s_sleep 2
s_mov_b32 s46, s69
buffer_load_dwordx4 v[28:31], v1, s[4:7], s46 offen offset:0 sc1
buffer_load_dwordx4 v[32:35], v1, s[4:7], s46 offen offset:1024 sc1
v_mov_b64 v[60:61], 0
v_mov_b64 v[62:63], 0
v_mov_b64 v[64:65], 0
v_mov_b64 v[66:67], 0
v_mov_b64 v[68:69], 0
v_mov_b64 v[70:71], 0
v_mov_b64 v[72:73], 0
v_mov_b64 v[74:75], 0
v_mov_b64 v[76:77], 0
v_mov_b64 v[78:79], 0
v_mov_b64 v[80:81], 0
v_mov_b64 v[82:83], 0
v_mov_b64 v[100:101], -1
v_mov_b64 v[102:103], -1
s_add_u32 s47, s68, 4096
s_add_u32 s34, s34, 1
s_add_u32 s35, s34, 1
s_and_b32 s43, s34, 1
s_lshl_b32 s43, s43, 14
s_xor_b32 s42, s43, 16384
v_add_u32 v14, s42, v2
s_add_u32 s43, s43, 122880
s_mov_b32 m0, s43
s_add_u32 s42, s34, 1
s_cmp_eq_u32 s34, 63
s_cselect_b32 s42, 62, s42
s_lshl_b32 s64, s42, 19
s_lshl_b32 s40, s32, 14
s_add_u32 s64, s64, s40
s_add_u32 s64, s64, 8192
s_lshl_b32 s50, s34, 5
s_add_u32 s50, s50, s32
s_lshl_b32 s65, s50, 11
s_add_u32 s65, s65, 41944064
s_lshl_b32 s66, s50, 12
s_add_u32 s66, s66, 33556480
s_and_b32 s45, s34, 1
s_mul_i32 s45, s45, 262144
s_mul_i32 s40, s32, 8192
s_add_u32 s68, s45, s40
s_add_u32 s68, s68, 46137344
s_add_u32 s45, s45, s56
s_add_u32 s45, s45, 46268416
s_add_u32 s67, s45, 32768
s_add_u32 s40, s34, 1
s_and_b32 s40, s40, 3
s_lshl_b32 s40, s40, 13
s_add_u32 s69, s40, 47190016
s_add_u32 s49, s40, s57
s_add_u32 s48, s68, 4096
s_add_u32 s52, s34, 3
s_and_b32 s52, s52, 3
s_lshl_b32 s52, s52, 13
s_add_u32 s52, s52, s57
L_pa_w2f:
buffer_load_dwordx4 v[84:87], v1, s[4:7], s46 offen offset:0 sc1
buffer_load_dwordx4 v[88:91], v1, s[4:7], s46 offen offset:1024 sc1
s_waitcnt vmcnt(2)
v_max3_u32 v0, v28, v29, v30
v_max3_u32 v15, v31, v32, v33
v_max3_u32 v0, v0, v34, v35
v_max_u32 v0, v0, v15
v_cmp_eq_u32 vcc, -1, v0
s_cbranch_vccz L_paok_w2f
buffer_load_dwordx4 v[28:31], v1, s[4:7], s46 offen offset:0 sc1
buffer_load_dwordx4 v[32:35], v1, s[4:7], s46 offen offset:1024 sc1
s_add_u32 s51, s51, 1
s_cmp_gt_u32 s51, 300000
s_cbranch_scc1 L_end
s_waitcnt vmcnt(2)
v_max3_u32 v0, v84, v85, v86
v_max3_u32 v15, v87, v88, v89
v_max3_u32 v0, v0, v90, v91
v_max_u32 v0, v0, v15
v_cmp_eq_u32 vcc, -1, v0
s_cbranch_vccnz L_pa_w2f
v_mov_b64 v[28:29], v[84:85]
v_mov_b64 v[30:31], v[86:87]
v_mov_b64 v[32:33], v[88:89]
v_mov_b64 v[34:35], v[90:91]
s_branch L_paok2_w2f
L_paok_w2f:
L_paok2_w2f:
s_branch L_step_w2f
L_step_w3f:
v_smfmac_f32_16x16x64_bf16 v[60:63], v[28:31], a[48:55], v3
ds_write_b128 v2, v[28:31] offset:38912
v_smfmac_f32_16x16x64_bf16 v[64:67], v[28:31], a[112:119], v3
ds_write_b128 v2, v[32:35] offset:39936
v_smfmac_f32_16x16x64_bf16 v[68:71], v[28:31], a[176:183], v3
v_smfmac_f32_16x16x64_bf16 v[72:75], v[28:31], a[240:247], v3
v_smfmac_f32_16x16x64_bf16 v[60:63], v[32:35], a[56:63], v3
v_smfmac_f32_16x16x64_bf16 v[64:67], v[32:35], a[120:127], v3
v_smfmac_f32_16x16x64_bf16 v[68:71], v[32:35], a[184:191], v3
v_smfmac_f32_16x16x64_bf16 v[72:75], v[32:35], a[248:255], v3
s_waitcnt lgkmcnt(0)
s_barrier
ds_read_b128 v[36:39], v2 offset:32768
ds_read_b128 v[40:43], v2 offset:33792
v_smfmac_f32_16x16x64_bf16 v[76:79], v[28:31], v[176:183], v3
ds_read_b128 v[44:47], v2 offset:34816
ds_read_b128 v[48:51], v2 offset:35840
v_smfmac_f32_16x16x64_bf16 v[80:83], v[28:31], v[240:247], v3
ds_read_b128 v[52:55], v2 offset:36864
ds_read_b128 v[56:59], v2 offset:37888
v_smfmac_f32_16x16x64_bf16 v[76:79], v[32:35], v[184:191], v3
v_smfmac_f32_16x16x64_bf16 v[80:83], v[32:35], v[248:255], v3
s_waitcnt lgkmcnt(4)
v_smfmac_f32_16x16x64_bf16 v[60:63], v[36:39], a[0:7], v3
v_smfmac_f32_16x16x64_bf16 v[64:67], v[36:39], a[64:71], v3
v_smfmac_f32_16x16x64_bf16 v[60:63], v[40:43], a[8:15], v3
v_smfmac_f32_16x16x64_bf16 v[64:67], v[40:43], a[72:79], v3
s_waitcnt vmcnt(0) lgkmcnt(0)
v_smfmac_f32_16x16x64_bf16 v[60:63], v[44:47], a[16:23], v3
ds_read_b128 v[28:31], v14 offset:0
v_smfmac_f32_16x16x64_bf16 v[64:67], v[44:47], a[80:87], v3
buffer_store_dword v16, off, s[4:7], s62 sc1
s_add_u32 s62, s62, 4
ds_read_b128 v[32:35], v14 offset:1024
v_smfmac_f32_16x16x64_bf16 v[60:63], v[48:51], a[24:31], v3
ds_read_b128 v[104:107], v14 offset:5120
v_smfmac_f32_16x16x64_bf16 v[64:67], v[48:51], a[88:95], v3
buffer_store_dwordx4 v[100:103], v1, s[4:7], s47 offen offset:0
ds_read_b128 v[108:111], v14 offset:6144
v_smfmac_f32_16x16x64_bf16 v[60:63], v[52:55], a[32:39], v3
v_smfmac_f32_16x16x64_bf16 v[64:67], v[52:55], a[96:103], v3
v_smfmac_f32_16x16x64_bf16 v[60:63], v[56:59], a[40:47], v3
v_smfmac_f32_16x16x64_bf16 v[64:67], v[56:59], a[104:111], v3
buffer_store_dwordx4 v[100:103], v1, s[4:7], s47 offen offset:1024
v_smfmac_f32_16x16x64_bf16 v[68:71], v[36:39], a[128:135], v3
v_smfmac_f32_16x16x64_bf16 v[72:75], v[36:39], a[192:199], v3
ds_read_b128 v[100:103], v14 offset:4096
v_add_f32 v60, v60, v61
v_smfmac_f32_16x16x64_bf16 v[68:71], v[40:43], a[136:143], v3
v_add_f32 v62, v62, v63
v_smfmac_f32_16x16x64_bf16 v[72:75], v[40:43], a[200:207], v3
buffer_load_dwordx4 v1, s[4:7], s64 offen offset:0 sc1 lds
v_cvt_pk_bf16_f32 v0, v60, v62
v_smfmac_f32_16x16x64_bf16 v[68:71], v[44:47], a[144:151], v3
v_add_f32 v64, v64, v65
v_smfmac_f32_16x16x64_bf16 v[72:75], v[44:47], a[208:215], v3
v_add_f32 v66, v66, v67
v_smfmac_f32_16x16x64_bf16 v[68:71], v[48:51], a[152:159], v3
v_cvt_pk_bf16_f32 v15, v64, v66
v_smfmac_f32_16x16x64_bf16 v[72:75], v[48:51], a[216:223], v3
buffer_load_dwordx4 v1, s[4:7], s64 offen offset:1024 sc1 lds
ds_write2_b32 v4, v0, v15 offset0:0 offset1:64
v_smfmac_f32_16x16x64_bf16 v[68:71], v[52:55], a[160:167], v3
v_smfmac_f32_16x16x64_bf16 v[72:75], v[52:55], a[224:231], v3
ds_read_b128 v[64:67], v14 offset:7168
v_smfmac_f32_16x16x64_bf16 v[68:71], v[56:59], a[168:175], v3
v_smfmac_f32_16x16x64_bf16 v[72:75], v[56:59], a[232:239], v3
buffer_load_dwordx4 v1, s[4:7], s64 offen offset:2048 sc1 lds
v_smfmac_f32_16x16x64_bf16 v[76:79], v[36:39], v[128:135], v3
s_nop 0
v_add_f32 v68, v68, v69
v_add_f32 v70, v70, v71
v_cvt_pk_bf16_f32 v0, v68, v70
v_smfmac_f32_16x16x64_bf16 v[80:83], v[36:39], v[192:199], v3
v_add_f32 v72, v72, v73
v_add_f32 v74, v74, v75
v_cvt_pk_bf16_f32 v15, v72, v74
ds_write2_b32 v5, v0, v15 offset0:0 offset1:128
ds_read_b128 v[36:39], v14 offset:2048
v_smfmac_f32_16x16x64_bf16 v[76:79], v[40:43], v[136:143], v3
s_waitcnt lgkmcnt(0)
s_barrier
ds_read_b64_tr_b16 v[84:85], v6 offset:0
ds_read_b64_tr_b16 v[86:87], v6 offset:64
v_smfmac_f32_16x16x64_bf16 v[80:83], v[40:43], v[200:207], v3
ds_read_b64_tr_b16 v[88:89], v6 offset:512
ds_read_b64_tr_b16 v[90:91], v6 offset:576
v_smfmac_f32_16x16x64_bf16 v[76:79], v[44:47], v[144:151], v3
ds_read_b64_tr_b16 v[92:93], v6 offset:1024
ds_read_b64_tr_b16 v[94:95], v6 offset:1088
v_smfmac_f32_16x16x64_bf16 v[80:83], v[44:47], v[208:215], v3
ds_read_b64_tr_b16 v[96:97], v6 offset:1536
ds_read_b64_tr_b16 v[98:99], v6 offset:1600
v_smfmac_f32_16x16x64_bf16 v[76:79], v[48:51], v[152:159], v3
ds_read_b128 v[40:43], v14 offset:3072
v_smfmac_f32_16x16x64_bf16 v[80:83], v[48:51], v[216:223], v3
v_smfmac_f32_16x16x64_bf16 v[76:79], v[52:55], v[160:167], v3
ds_read_b64_tr_b16 v[44:45], v7 offset:0
ds_read_b64_tr_b16 v[46:47], v7 offset:128
ds_read_b64_tr_b16 v[48:49], v7 offset:1024
ds_read_b64_tr_b16 v[50:51], v7 offset:1152
v_smfmac_f32_16x16x64_bf16 v[80:83], v[52:55], v[224:231], v3
ds_read_b64_tr_b16 v[52:53], v7 offset:2048
ds_read_b64_tr_b16 v[54:55], v7 offset:2176
v_smfmac_f32_16x16x64_bf16 v[76:79], v[56:59], v[168:175], v3
v_smfmac_f32_16x16x64_bf16 v[80:83], v[56:59], v[232:239], v3
ds_read_b64_tr_b16 v[56:57], v7 offset:3072
ds_read_b64_tr_b16 v[58:59], v7 offset:3200
s_waitcnt lgkmcnt(8)
v_mfma_f32_16x16x32_bf16 v[72:75], v[100:103], v[84:87], 0
v_mfma_f32_16x16x32_bf16 v[72:75], v[104:107], v[88:91], v[72:75]
v_add_f32 v76, v76, v77
v_add_f32 v78, v78, v79
v_mfma_f32_16x16x32_bf16 v[72:75], v[108:111], v[92:95], v[72:75]
v_cvt_pk_bf16_f32 v77, v76, v78
v_add_f32 v80, v80, v81
v_mfma_f32_16x16x32_bf16 v[72:75], v[64:67], v[96:99], v[72:75]
buffer_load_dwordx4 v1, s[4:7], s64 offen offset:3072 sc1 lds
v_add_f32 v82, v82, v83
v_cvt_pk_bf16_f32 v83, v80, v82
v_mfma_f32_16x16x32_bf16 v[68:71], v[28:31], v[84:87], 0
v_mov_b32 v82, v77
v_lshrrev_b32 v15, 1, v1
ds_read_b128 v[100:103], v10 offset:0
v_mfma_f32_16x16x32_bf16 v[68:71], v[32:35], v[88:91], v[68:71]
ds_read_b128 v[104:107], v10 offset:1024
v_mfma_f32_16x16x32_bf16 v[68:71], v[36:39], v[92:95], v[68:71]
buffer_store_dwordx2 v[82:83], v15, s[4:7], s65 offen sc1
v_mfma_f32_16x16x32_bf16 v[68:71], v[40:43], v[96:99], v[68:71]
s_waitcnt lgkmcnt(2)
v_mfma_f32_16x16x32_bf16 v[60:63], v[44:47], v[84:87], 0
ds_read_b128 v[28:31], v14 offset:14336
v_max3_f32 v0, v72, v73, v74
v_mfma_f32_16x16x32_bf16 v[60:63], v[48:51], v[88:91], v[60:63]
ds_read_b128 v[32:35], v14 offset:15360
v_mfma_f32_16x16x32_bf16 v[60:63], v[52:55], v[92:95], v[60:63]
ds_read_b128 v[36:39], v11 offset:0
v_max3_f32 v0, v0, v75, v68
v_max3_f32 v0, v0, v69, v70
v_mfma_f32_16x16x32_bf16 v[60:63], v[56:59], v[96:99], v[60:63]
ds_read_b128 v[40:43], v11 offset:1024
buffer_store_dwordx4 v[56:59], v1, s[4:7], s66 offen sc1
v_max_f32 v0, v0, v71
s_cmp_eq_u32 s34, 63
s_cbranch_scc1 L_chain_fin
s_nop 1
s_nop 0
v_max3_f32 v0, v0, v60, v61
v_mov_b32 v15, v0
s_nop 1
v_permlane16_swap_b32 v0, v15
v_max_f32 v0, v0, v15
v_mov_b32 v15, v0
s_nop 1
v_permlane32_swap_b32 v0, v15
v_max_f32 v0, v0, v15
v_mul_f32 v62, s38, v0
v_pk_fma_f32 v[68:69], v[68:69], s[38:39], v[62:63] op_sel_hi:[1,1,0] neg_lo:[0,0,1] neg_hi:[0,0,1]
v_pk_fma_f32 v[70:71], v[70:71], s[38:39], v[62:63] op_sel_hi:[1,1,0] neg_lo:[0,0,1] neg_hi:[0,0,1]
v_pk_fma_f32 v[72:73], v[72:73], s[38:39], v[62:63] op_sel_hi:[1,1,0] neg_lo:[0,0,1] neg_hi:[0,0,1]
v_pk_fma_f32 v[74:75], v[74:75], s[38:39], v[62:63] op_sel_hi:[1,1,0] neg_lo:[0,0,1] neg_hi:[0,0,1]
v_pk_fma_f32 v[60:61], v[60:61], s[38:39], v[62:63] op_sel_hi:[1,1,0] neg_lo:[0,0,1] neg_hi:[0,0,1]
v_exp_f32 v68, v68
v_exp_f32 v69, v69
ds_read_b128 v[44:47], v10 offset:2048
v_exp_f32 v70, v70
v_exp_f32 v71, v71
ds_read_b128 v[48:51], v10 offset:3072
v_cvt_pk_bf16_f32 v76, v68, v69
v_exp_f32 v72, v72
v_cvt_pk_bf16_f32 v77, v70, v71
v_exp_f32 v73, v73
s_waitcnt lgkmcnt(4)
v_mfma_f32_16x16x16_bf16 v[92:95], v[16:17], v[76:77], 0
v_exp_f32 v74, v74
v_mfma_f32_16x16x16_bf16 v[84:87], v[28:29], v[76:77], 0
v_exp_f32 v75, v75
v_mfma_f32_16x16x16_bf16 v[88:91], v[32:33], v[76:77], 0
v_cvt_pk_bf16_f32 v78, v72, v73
v_exp_f32 v60, v60
v_cvt_pk_bf16_f32 v79, v74, v75
v_exp_f32 v61, v61
s_nop 0
v_mfma_f32_16x16x16_bf16 v[92:95], v[16:17], v[78:79], v[92:95]
ds_read_b128 v[52:55], v11 offset:2048
v_cvt_pk_bf16_f32 v24, v60, v61
v_mfma_f32_16x16x16_bf16 v[84:87], v[30:31], v[78:79], v[84:87]
ds_read_b128 v[56:59], v11 offset:3072
v_cvt_pk_bf16_f32 v27, v60, v61
v_mfma_f32_16x16x16_bf16 v[88:91], v[34:35], v[78:79], v[88:91]
v_mfma_f32_16x16x16_bf16 v[92:95], v[16:17], v[24:25], v[92:95]
v_mfma_f32_16x16x16_bf16 v[84:87], v[82:83], v[24:25], v[84:87]
v_mfma_f32_16x16x16_bf16 v[88:91], v[82:83], v[26:27], v[88:91]
s_nop 0
v_rcp_f32 v0, v92
s_nop 2
v_pk_mul_f32 v[84:85], v[84:85], v[0:1] op_sel_hi:[1,0]
v_pk_mul_f32 v[86:87], v[86:87], v[0:1] op_sel_hi:[1,0]
v_cvt_pk_bf16_f32 v84, v84, v85
v_cvt_pk_bf16_f32 v85, v86, v87
ds_write_b64 v8, v[84:85]
v_pk_mul_f32 v[88:89], v[88:89], v[0:1] op_sel_hi:[1,0]
v_pk_mul_f32 v[90:91], v[90:91], v[0:1] op_sel_hi:[1,0]
v_cvt_pk_bf16_f32 v88, v88, v89
v_cvt_pk_bf16_f32 v89, v90, v91
ds_write_b64 v8, v[88:89] offset:32
v_mov_b64 v[68:69], 0
v_mov_b64 v[70:71], 0
v_mov_b64 v[72:73], 0
v_mov_b64 v[74:75], 0
v_mov_b64 v[76:77], 0
v_mov_b64 v[78:79], 0
v_mov_b64 v[60:61], 0
v_mov_b64 v[62:63], 0
s_waitcnt vmcnt(6) lgkmcnt(0)
s_barrier
ds_read_b128 v[28:31], v9
ds_read_b128 v[32:35], v9 offset:128
ds_read_b128 v[84:87], v10 offset:4096
ds_read_b128 v[88:91], v10 offset:5120
v_mov_b64 v[64:65], 0
v_mov_b64 v[66:67], 0
v_mov_b64 v[80:81], 0
v_mov_b64 v[82:83], 0
v_mov_b64 v[96:97], 0
v_mov_b64 v[98:99], 0
v_mov_b64 v[92:93], 0
v_mov_b64 v[94:95], 0
s_waitcnt lgkmcnt(2)
v_smfmac_f32_16x16x64_bf16 v[72:75], v[28:31], v[100:107], v3
ds_read_b128 v[100:103], v11 offset:4096
ds_read_b128 v[104:107], v11 offset:5120
v_smfmac_f32_16x16x64_bf16 v[72:75], v[32:35], v[36:43], v3
ds_read_b128 v[36:39], v10 offset:6144
ds_read_b128 v[40:43], v10 offset:7168
v_smfmac_f32_16x16x64_bf16 v[76:79], v[28:31], v[44:51], v3
ds_read_b128 v[44:47], v11 offset:6144
ds_read_b128 v[48:51], v11 offset:7168
v_smfmac_f32_16x16x64_bf16 v[76:79], v[32:35], v[52:59], v3
ds_read_b128 v[52:55], v10 offset:8192
ds_read_b128 v[56:59], v10 offset:9216
v_add_f32 v72, v72, v73
v_smfmac_f32_16x16x64_bf16 v[68:71], v[28:31], v[112:119], v3
v_add_f32 v74, v74, v75
v_cvt_pk_bf16_f32 v109, v72, v74
v_smfmac_f32_16x16x64_bf16 v[68:71], v[32:35], v[120:127], v3
s_nop 0
v_add_f32 v76, v76, v77
v_add_f32 v78, v78, v79
s_waitcnt lgkmcnt(6)
v_smfmac_f32_16x16x64_bf16 v[60:63], v[28:31], v[84:91], v3
ds_read_b128 v[84:87], v11 offset:8192
ds_read_b128 v[88:91], v11 offset:9216
v_cvt_pk_bf16_f32 v110, v76, v78
v_smfmac_f32_16x16x64_bf16 v[60:63], v[32:35], v[100:107], v3
ds_read_b128 v[100:103], v10 offset:10240
ds_read_b128 v[104:107], v10 offset:11264
v_add_f32 v68, v68, v69
s_waitcnt lgkmcnt(6)
v_smfmac_f32_16x16x64_bf16 v[64:67], v[28:31], v[36:43], v3
ds_read_b128 v[36:39], v11 offset:10240
ds_read_b128 v[40:43], v11 offset:11264
v_add_f32 v70, v70, v71
v_cvt_pk_bf16_f32 v108, v68, v70
v_smfmac_f32_16x16x64_bf16 v[64:67], v[32:35], v[44:51], v3
ds_read_b128 v[44:47], v10 offset:12288
ds_read_b128 v[48:51], v10 offset:13312
v_add_f32 v60, v60, v61
v_add_f32 v62, v62, v63
v_cvt_pk_bf16_f32 v111, v60, v62
buffer_store_dwordx4 v[108:111], v12, s[4:7], s45 offen
s_waitcnt lgkmcnt(6)
v_smfmac_f32_16x16x64_bf16 v[80:83], v[28:31], v[52:59], v3
ds_read_b128 v[52:55], v11 offset:12288
ds_read_b128 v[56:59], v11 offset:13312
v_smfmac_f32_16x16x64_bf16 v[80:83], v[32:35], v[84:91], v3
v_add_f32 v64, v64, v65
v_add_f32 v66, v66, v67
s_waitcnt lgkmcnt(4)
v_smfmac_f32_16x16x64_bf16 v[96:99], v[28:31], v[100:107], v3
v_cvt_pk_bf16_f32 v108, v64, v66
v_smfmac_f32_16x16x64_bf16 v[96:99], v[32:35], v[36:43], v3
s_nop 0
v_add_f32 v80, v80, v81
v_add_f32 v82, v82, v83
s_waitcnt lgkmcnt(0)
v_smfmac_f32_16x16x64_bf16 v[92:95], v[28:31], v[44:51], v3
v_cvt_pk_bf16_f32 v109, v80, v82
v_smfmac_f32_16x16x64_bf16 v[92:95], v[32:35], v[52:59], v3
v_add_f32 v96, v96, v97
v_add_f32 v98, v98, v99
v_cvt_pk_bf16_f32 v110, v96, v98
s_nop 4
v_add_f32 v92, v92, v93
v_add_f32 v94, v94, v95
v_cvt_pk_bf16_f32 v111, v92, v94
buffer_store_dwordx4 v[108:111], v12, s[4:7], s67 offen
s_mov_b32 s46, s69
v_mov_b64 v[60:61], 0
v_mov_b64 v[62:63], 0
v_mov_b64 v[64:65], 0
v_mov_b64 v[66:67], 0
v_mov_b64 v[68:69], 0
v_mov_b64 v[70:71], 0
v_mov_b64 v[72:73], 0
v_mov_b64 v[74:75], 0
v_mov_b64 v[76:77], 0
v_mov_b64 v[78:79], 0
v_mov_b64 v[80:81], 0
v_mov_b64 v[82:83], 0
v_mov_b64 v[100:101], -1
v_mov_b64 v[102:103], -1
s_add_u32 s47, s68, 6144
s_add_u32 s34, s34, 1
s_add_u32 s35, s34, 1
s_and_b32 s43, s34, 1
s_lshl_b32 s43, s43, 14
s_xor_b32 s42, s43, 16384
v_add_u32 v14, s42, v2
s_add_u32 s43, s43, 126976
s_mov_b32 m0, s43
s_add_u32 s42, s34, 1
s_cmp_eq_u32 s34, 63
s_cselect_b32 s42, 62, s42
s_lshl_b32 s64, s42, 19
s_lshl_b32 s40, s32, 14
s_add_u32 s64, s64, s40
s_add_u32 s64, s64, 12288
s_lshl_b32 s50, s34, 5
s_add_u32 s50, s50, s32
s_lshl_b32 s65, s50, 11
s_add_u32 s65, s65, 41944576
s_lshl_b32 s66, s50, 12
s_add_u32 s66, s66, 33557504
s_and_b32 s45, s34, 1
s_mul_i32 s45, s45, 262144
s_mul_i32 s40, s32, 8192
s_add_u32 s68, s45, s40
s_add_u32 s68, s68, 46137344
s_add_u32 s45, s45, s56
s_add_u32 s45, s45, 46333952
s_add_u32 s67, s45, 32768
s_add_u32 s40, s34, 1
s_and_b32 s40, s40, 3
s_lshl_b32 s40, s40, 13
s_add_u32 s69, s40, 47192064
s_barrier
s_sleep 3
buffer_load_dwordx4 v[28:31], v1, s[4:7], s46 offen offset:0 sc1
buffer_load_dwordx4 v[32:35], v1, s[4:7], s46 offen offset:1024 sc1
s_sleep 1
L_pa_w3f:
buffer_load_dwordx4 v[84:87], v1, s[4:7], s46 offen offset:0 sc1
buffer_load_dwordx4 v[88:91], v1, s[4:7], s46 offen offset:1024 sc1
s_waitcnt vmcnt(2)
v_max3_u32 v0, v28, v29, v30
v_max3_u32 v15, v31, v32, v33
v_max3_u32 v0, v0, v34, v35
v_max_u32 v0, v0, v15
v_cmp_eq_u32 vcc, -1, v0
s_cbranch_vccz L_paok_w3f
buffer_load_dwordx4 v[28:31], v1, s[4:7], s46 offen offset:0 sc1
buffer_load_dwordx4 v[32:35], v1, s[4:7], s46 offen offset:1024 sc1
s_add_u32 s51, s51, 1
s_cmp_gt_u32 s51, 300000
s_cbranch_scc1 L_end
s_waitcnt vmcnt(2)
v_max3_u32 v0, v84, v85, v86
v_max3_u32 v15, v87, v88, v89
v_max3_u32 v0, v0, v90, v91
v_max_u32 v0, v0, v15
v_cmp_eq_u32 vcc, -1, v0
s_cbranch_vccnz L_pa_w3f
v_mov_b64 v[28:29], v[84:85]
v_mov_b64 v[30:31], v[86:87]
v_mov_b64 v[32:33], v[88:89]
v_mov_b64 v[34:35], v[90:91]
s_branch L_paok2_w3f
L_paok_w3f:
L_paok2_w3f:
s_branch L_step_w3f
L_step_w0s:
v_smfmac_f32_16x16x64_bf16 v[60:63], v[28:31], a[0:7], v3
ds_write_b128 v2, v[28:31] offset:32768
v_smfmac_f32_16x16x64_bf16 v[64:67], v[28:31], a[64:71], v3
ds_write_b128 v2, v[32:35] offset:33792
v_smfmac_f32_16x16x64_bf16 v[68:71], v[28:31], a[128:135], v3
v_smfmac_f32_16x16x64_bf16 v[72:75], v[28:31], a[192:199], v3
v_smfmac_f32_16x16x64_bf16 v[60:63], v[32:35], a[8:15], v3
v_smfmac_f32_16x16x64_bf16 v[64:67], v[32:35], a[72:79], v3
v_smfmac_f32_16x16x64_bf16 v[68:71], v[32:35], a[136:143], v3
v_smfmac_f32_16x16x64_bf16 v[72:75], v[32:35], a[200:207], v3
s_waitcnt lgkmcnt(0)
s_barrier
ds_read_b128 v[36:39], v2 offset:34816
ds_read_b128 v[40:43], v2 offset:35840
v_smfmac_f32_16x16x64_bf16 v[76:79], v[28:31], v[128:135], v3
ds_read_b128 v[44:47], v2 offset:36864
ds_read_b128 v[48:51], v2 offset:37888
v_smfmac_f32_16x16x64_bf16 v[80:83], v[28:31], v[192:199], v3
ds_read_b128 v[52:55], v2 offset:38912
ds_read_b128 v[56:59], v2 offset:39936
v_smfmac_f32_16x16x64_bf16 v[76:79], v[32:35], v[136:143], v3
v_smfmac_f32_16x16x64_bf16 v[80:83], v[32:35], v[200:207], v3
s_waitcnt lgkmcnt(4)
v_smfmac_f32_16x16x64_bf16 v[60:63], v[36:39], a[16:23], v3
v_smfmac_f32_16x16x64_bf16 v[64:67], v[36:39], a[80:87], v3
v_smfmac_f32_16x16x64_bf16 v[60:63], v[40:43], a[24:31], v3
v_smfmac_f32_16x16x64_bf16 v[64:67], v[40:43], a[88:95], v3
s_waitcnt vmcnt(0) lgkmcnt(0)
v_smfmac_f32_16x16x64_bf16 v[60:63], v[44:47], a[32:39], v3
buffer_store_dwordx4 v[100:103], v1, s[4:7], s47 offen offset:0 sc1
ds_read_b128 v[28:31], v14 offset:0
v_smfmac_f32_16x16x64_bf16 v[64:67], v[44:47], a[96:103], v3
ds_read_b128 v[32:35], v14 offset:1024
v_smfmac_f32_16x16x64_bf16 v[60:63], v[48:51], a[40:47], v3
ds_read_b128 v[104:107], v14 offset:5120
v_smfmac_f32_16x16x64_bf16 v[64:67], v[48:51], a[104:111], v3
ds_read_b128 v[108:111], v14 offset:6144
v_smfmac_f32_16x16x64_bf16 v[60:63], v[52:55], a[48:55], v3
buffer_store_dwordx4 v[100:103], v1, s[4:7], s47 offen offset:1024 sc1
v_smfmac_f32_16x16x64_bf16 v[64:67], v[52:55], a[112:119], v3
v_smfmac_f32_16x16x64_bf16 v[60:63], v[56:59], a[56:63], v3
v_smfmac_f32_16x16x64_bf16 v[64:67], v[56:59], a[120:127], v3
v_smfmac_f32_16x16x64_bf16 v[68:71], v[36:39], a[144:151], v3
buffer_load_dwordx4 v1, s[4:7], s64 offen offset:0 sc1 lds
v_smfmac_f32_16x16x64_bf16 v[72:75], v[36:39], a[208:215], v3
ds_read_b128 v[100:103], v14 offset:4096
v_add_f32 v60, v60, v61
v_smfmac_f32_16x16x64_bf16 v[68:71], v[40:43], a[152:159], v3
v_add_f32 v62, v62, v63
v_smfmac_f32_16x16x64_bf16 v[72:75], v[40:43], a[216:223], v3
v_cvt_pk_bf16_f32 v0, v60, v62
v_smfmac_f32_16x16x64_bf16 v[68:71], v[44:47], a[160:167], v3
buffer_load_dwordx4 v1, s[4:7], s64 offen offset:1024 sc1 lds
v_add_f32 v64, v64, v65
v_smfmac_f32_16x16x64_bf16 v[72:75], v[44:47], a[224:231], v3
v_add_f32 v66, v66, v67
v_smfmac_f32_16x16x64_bf16 v[68:71], v[48:51], a[168:175], v3
v_cvt_pk_bf16_f32 v15, v64, v66
v_smfmac_f32_16x16x64_bf16 v[72:75], v[48:51], a[232:239], v3
ds_write2_b32 v4, v0, v15 offset0:0 offset1:64
v_smfmac_f32_16x16x64_bf16 v[68:71], v[52:55], a[176:183], v3
buffer_load_dwordx4 v1, s[4:7], s64 offen offset:2048 sc1 lds
v_smfmac_f32_16x16x64_bf16 v[72:75], v[52:55], a[240:247], v3
ds_read_b128 v[64:67], v14 offset:7168
v_smfmac_f32_16x16x64_bf16 v[68:71], v[56:59], a[184:191], v3
v_smfmac_f32_16x16x64_bf16 v[72:75], v[56:59], a[248:255], v3
v_smfmac_f32_16x16x64_bf16 v[76:79], v[36:39], v[144:151], v3
s_nop 0
v_add_f32 v68, v68, v69
v_add_f32 v70, v70, v71
v_cvt_pk_bf16_f32 v0, v68, v70
v_smfmac_f32_16x16x64_bf16 v[80:83], v[36:39], v[208:215], v3
v_add_f32 v72, v72, v73
v_add_f32 v74, v74, v75
v_cvt_pk_bf16_f32 v15, v72, v74
ds_write2_b32 v5, v0, v15 offset0:0 offset1:128
ds_read_b128 v[36:39], v14 offset:2048
v_smfmac_f32_16x16x64_bf16 v[76:79], v[40:43], v[152:159], v3
s_waitcnt lgkmcnt(0)
s_barrier
ds_read_b64_tr_b16 v[84:85], v6 offset:0
ds_read_b64_tr_b16 v[86:87], v6 offset:64
v_smfmac_f32_16x16x64_bf16 v[80:83], v[40:43], v[216:223], v3
ds_read_b64_tr_b16 v[88:89], v6 offset:512
ds_read_b64_tr_b16 v[90:91], v6 offset:576
v_smfmac_f32_16x16x64_bf16 v[76:79], v[44:47], v[160:167], v3
ds_read_b64_tr_b16 v[92:93], v6 offset:1024
ds_read_b64_tr_b16 v[94:95], v6 offset:1088
v_smfmac_f32_16x16x64_bf16 v[80:83], v[44:47], v[224:231], v3
ds_read_b64_tr_b16 v[96:97], v6 offset:1536
ds_read_b64_tr_b16 v[98:99], v6 offset:1600
v_smfmac_f32_16x16x64_bf16 v[76:79], v[48:51], v[168:175], v3
ds_read_b128 v[40:43], v14 offset:3072
v_smfmac_f32_16x16x64_bf16 v[80:83], v[48:51], v[232:239], v3
v_smfmac_f32_16x16x64_bf16 v[76:79], v[52:55], v[176:183], v3
ds_read_b64_tr_b16 v[44:45], v7 offset:0
ds_read_b64_tr_b16 v[46:47], v7 offset:128
ds_read_b64_tr_b16 v[48:49], v7 offset:1024
ds_read_b64_tr_b16 v[50:51], v7 offset:1152
v_smfmac_f32_16x16x64_bf16 v[80:83], v[52:55], v[240:247], v3
ds_read_b64_tr_b16 v[52:53], v7 offset:2048
ds_read_b64_tr_b16 v[54:55], v7 offset:2176
v_smfmac_f32_16x16x64_bf16 v[76:79], v[56:59], v[184:191], v3
v_smfmac_f32_16x16x64_bf16 v[80:83], v[56:59], v[248:255], v3
ds_read_b64_tr_b16 v[56:57], v7 offset:3072
ds_read_b64_tr_b16 v[58:59], v7 offset:3200
s_waitcnt lgkmcnt(8)
v_mfma_f32_16x16x32_bf16 v[72:75], v[100:103], v[84:87], 0
buffer_load_dwordx4 v1, s[4:7], s64 offen offset:3072 sc1 lds
v_mfma_f32_16x16x32_bf16 v[72:75], v[104:107], v[88:91], v[72:75]
v_add_f32 v76, v76, v77
v_add_f32 v78, v78, v79
v_mfma_f32_16x16x32_bf16 v[72:75], v[108:111], v[92:95], v[72:75]
v_cvt_pk_bf16_f32 v77, v76, v78
v_add_f32 v80, v80, v81
v_mfma_f32_16x16x32_bf16 v[72:75], v[64:67], v[96:99], v[72:75]
v_add_f32 v82, v82, v83
v_cvt_pk_bf16_f32 v83, v80, v82
v_mfma_f32_16x16x32_bf16 v[68:71], v[28:31], v[84:87], 0
v_mov_b32 v82, v77
v_lshrrev_b32 v15, 1, v1
ds_read_b128 v[100:103], v10 offset:0
v_mfma_f32_16x16x32_bf16 v[68:71], v[32:35], v[88:91], v[68:71]
ds_read_b128 v[104:107], v10 offset:1024
buffer_store_dwordx2 v[82:83], v15, s[4:7], s65 offen sc1
v_mfma_f32_16x16x32_bf16 v[68:71], v[36:39], v[92:95], v[68:71]
v_mfma_f32_16x16x32_bf16 v[68:71], v[40:43], v[96:99], v[68:71]
s_waitcnt lgkmcnt(2)
v_mfma_f32_16x16x32_bf16 v[60:63], v[44:47], v[84:87], 0
ds_read_b128 v[28:31], v14 offset:8192
buffer_store_dwordx4 v[44:47], v1, s[4:7], s66 offen sc1
v_max3_f32 v0, v72, v73, v74
v_mfma_f32_16x16x32_bf16 v[60:63], v[48:51], v[88:91], v[60:63]
ds_read_b128 v[32:35], v14 offset:9216
v_mfma_f32_16x16x32_bf16 v[60:63], v[52:55], v[92:95], v[60:63]
ds_read_b128 v[36:39], v11 offset:0
v_max3_f32 v0, v0, v75, v68
v_max3_f32 v0, v0, v69, v70
v_mfma_f32_16x16x32_bf16 v[60:63], v[56:59], v[96:99], v[60:63]
ds_read_b128 v[40:43], v11 offset:1024
v_max_f32 v0, v0, v71
s_cmp_eq_u32 s34, 63
s_cbranch_scc1 L_chain_fin
s_nop 1
s_nop 1
v_max3_f32 v0, v0, v60, v61
v_mov_b32 v15, v0
s_nop 1
v_permlane16_swap_b32 v0, v15
v_max_f32 v0, v0, v15
v_mov_b32 v15, v0
s_nop 1
v_permlane32_swap_b32 v0, v15
v_max_f32 v0, v0, v15
v_mul_f32 v62, s38, v0
v_pk_fma_f32 v[68:69], v[68:69], s[38:39], v[62:63] op_sel_hi:[1,1,0] neg_lo:[0,0,1] neg_hi:[0,0,1]
v_pk_fma_f32 v[70:71], v[70:71], s[38:39], v[62:63] op_sel_hi:[1,1,0] neg_lo:[0,0,1] neg_hi:[0,0,1]
v_pk_fma_f32 v[72:73], v[72:73], s[38:39], v[62:63] op_sel_hi:[1,1,0] neg_lo:[0,0,1] neg_hi:[0,0,1]
v_pk_fma_f32 v[74:75], v[74:75], s[38:39], v[62:63] op_sel_hi:[1,1,0] neg_lo:[0,0,1] neg_hi:[0,0,1]
v_pk_fma_f32 v[60:61], v[60:61], s[38:39], v[62:63] op_sel_hi:[1,1,0] neg_lo:[0,0,1] neg_hi:[0,0,1]
v_exp_f32 v68, v68
v_exp_f32 v69, v69
ds_read_b128 v[44:47], v10 offset:2048
v_exp_f32 v70, v70
v_exp_f32 v71, v71
ds_read_b128 v[48:51], v10 offset:3072
v_cvt_pk_bf16_f32 v76, v68, v69
v_exp_f32 v72, v72
v_cvt_pk_bf16_f32 v77, v70, v71
v_exp_f32 v73, v73
s_waitcnt lgkmcnt(4)
v_mfma_f32_16x16x16_bf16 v[92:95], v[16:17], v[76:77], 0
v_exp_f32 v74, v74
v_mfma_f32_16x16x16_bf16 v[84:87], v[28:29], v[76:77], 0
v_exp_f32 v75, v75
v_mfma_f32_16x16x16_bf16 v[88:91], v[32:33], v[76:77], 0
v_cvt_pk_bf16_f32 v78, v72, v73
v_exp_f32 v60, v60
v_cvt_pk_bf16_f32 v79, v74, v75
v_exp_f32 v61, v61
s_nop 0
v_mfma_f32_16x16x16_bf16 v[92:95], v[16:17], v[78:79], v[92:95]
ds_read_b128 v[52:55], v11 offset:2048
v_cvt_pk_bf16_f32 v24, v60, v61
v_mfma_f32_16x16x16_bf16 v[84:87], v[30:31], v[78:79], v[84:87]
ds_read_b128 v[56:59], v11 offset:3072
v_cvt_pk_bf16_f32 v27, v60, v61
v_mfma_f32_16x16x16_bf16 v[88:91], v[34:35], v[78:79], v[88:91]
v_mfma_f32_16x16x16_bf16 v[92:95], v[16:17], v[24:25], v[92:95]
v_mfma_f32_16x16x16_bf16 v[84:87], v[82:83], v[24:25], v[84:87]
v_mfma_f32_16x16x16_bf16 v[88:91], v[82:83], v[26:27], v[88:91]
s_nop 0
v_rcp_f32 v0, v92
s_nop 2
v_pk_mul_f32 v[84:85], v[84:85], v[0:1] op_sel_hi:[1,0]
v_pk_mul_f32 v[86:87], v[86:87], v[0:1] op_sel_hi:[1,0]
v_cvt_pk_bf16_f32 v84, v84, v85
v_cvt_pk_bf16_f32 v85, v86, v87
ds_write_b64 v8, v[84:85]
v_pk_mul_f32 v[88:89], v[88:89], v[0:1] op_sel_hi:[1,0]
v_pk_mul_f32 v[90:91], v[90:91], v[0:1] op_sel_hi:[1,0]
v_cvt_pk_bf16_f32 v88, v88, v89
v_cvt_pk_bf16_f32 v89, v90, v91
ds_write_b64 v8, v[88:89] offset:32
v_mov_b64 v[68:69], 0
v_mov_b64 v[70:71], 0
v_mov_b64 v[72:73], 0
v_mov_b64 v[74:75], 0
v_mov_b64 v[76:77], 0
v_mov_b64 v[78:79], 0
v_mov_b64 v[60:61], 0
v_mov_b64 v[62:63], 0
s_waitcnt vmcnt(6) lgkmcnt(0)
s_barrier
ds_read_b128 v[28:31], v9
ds_read_b128 v[32:35], v9 offset:128
ds_read_b128 v[84:87], v10 offset:4096
ds_read_b128 v[88:91], v10 offset:5120
v_mov_b64 v[64:65], 0
v_mov_b64 v[66:67], 0
v_mov_b64 v[80:81], 0
v_mov_b64 v[82:83], 0
v_mov_b64 v[96:97], 0
v_mov_b64 v[98:99], 0
v_mov_b64 v[92:93], 0
v_mov_b64 v[94:95], 0
s_waitcnt lgkmcnt(2)
v_smfmac_f32_16x16x64_bf16 v[72:75], v[28:31], v[100:107], v3
ds_read_b128 v[100:103], v11 offset:4096
ds_read_b128 v[104:107], v11 offset:5120
v_smfmac_f32_16x16x64_bf16 v[72:75], v[32:35], v[36:43], v3
ds_read_b128 v[36:39], v10 offset:6144
ds_read_b128 v[40:43], v10 offset:7168
v_smfmac_f32_16x16x64_bf16 v[76:79], v[28:31], v[44:51], v3
ds_read_b128 v[44:47], v11 offset:6144
ds_read_b128 v[48:51], v11 offset:7168
v_smfmac_f32_16x16x64_bf16 v[76:79], v[32:35], v[52:59], v3
ds_read_b128 v[52:55], v10 offset:8192
ds_read_b128 v[56:59], v10 offset:9216
v_add_f32 v72, v72, v73
v_smfmac_f32_16x16x64_bf16 v[68:71], v[28:31], v[112:119], v3
v_add_f32 v74, v74, v75
v_cvt_pk_bf16_f32 v109, v72, v74
v_smfmac_f32_16x16x64_bf16 v[68:71], v[32:35], v[120:127], v3
s_nop 0
v_add_f32 v76, v76, v77
v_add_f32 v78, v78, v79
s_waitcnt lgkmcnt(6)
v_smfmac_f32_16x16x64_bf16 v[60:63], v[28:31], v[84:91], v3
ds_read_b128 v[84:87], v11 offset:8192
ds_read_b128 v[88:91], v11 offset:9216
v_cvt_pk_bf16_f32 v110, v76, v78
v_smfmac_f32_16x16x64_bf16 v[60:63], v[32:35], v[100:107], v3
ds_read_b128 v[100:103], v10 offset:10240
ds_read_b128 v[104:107], v10 offset:11264
v_add_f32 v68, v68, v69
s_waitcnt lgkmcnt(6)
v_smfmac_f32_16x16x64_bf16 v[64:67], v[28:31], v[36:43], v3
ds_read_b128 v[36:39], v11 offset:10240
ds_read_b128 v[40:43], v11 offset:11264
v_add_f32 v70, v70, v71
v_cvt_pk_bf16_f32 v108, v68, v70
v_smfmac_f32_16x16x64_bf16 v[64:67], v[32:35], v[44:51], v3
ds_read_b128 v[44:47], v10 offset:12288
ds_read_b128 v[48:51], v10 offset:13312
v_add_f32 v60, v60, v61
v_add_f32 v62, v62, v63
v_cvt_pk_bf16_f32 v111, v60, v62
buffer_store_dwordx4 v[108:111], v12, s[4:7], s45 offen sc1
s_waitcnt lgkmcnt(6)
v_smfmac_f32_16x16x64_bf16 v[80:83], v[28:31], v[52:59], v3
ds_read_b128 v[52:55], v11 offset:12288
ds_read_b128 v[56:59], v11 offset:13312
v_smfmac_f32_16x16x64_bf16 v[80:83], v[32:35], v[84:91], v3
v_add_f32 v64, v64, v65
v_add_f32 v66, v66, v67
s_waitcnt lgkmcnt(4)
v_smfmac_f32_16x16x64_bf16 v[96:99], v[28:31], v[100:107], v3
v_cvt_pk_bf16_f32 v108, v64, v66
v_smfmac_f32_16x16x64_bf16 v[96:99], v[32:35], v[36:43], v3
s_nop 0
v_add_f32 v80, v80, v81
v_add_f32 v82, v82, v83
s_waitcnt lgkmcnt(0)
v_smfmac_f32_16x16x64_bf16 v[92:95], v[28:31], v[44:51], v3
v_cvt_pk_bf16_f32 v109, v80, v82
v_smfmac_f32_16x16x64_bf16 v[92:95], v[32:35], v[52:59], v3
v_add_f32 v96, v96, v97
v_add_f32 v98, v98, v99
v_cvt_pk_bf16_f32 v110, v96, v98
s_nop 4
v_add_f32 v92, v92, v93
v_add_f32 v94, v94, v95
v_cvt_pk_bf16_f32 v111, v92, v94
buffer_store_dwordx4 v[108:111], v12, s[4:7], s67 offen sc1
s_mov_b32 s46, s69
s_add_u32 s43, s34, 2
s_min_u32 s43, s43, 63
s_cmp_gt_u32 s60, s43
s_cbranch_scc1 L_kr63
v_lshrrev_b32 v15, 2, v1
L_krl63:
buffer_load_dword v0, v15, s[4:7], s61 offen sc1
s_add_u32 s51, s51, 1
s_cmp_gt_u32 s51, 300000
s_cbranch_scc1 L_end
s_waitcnt vmcnt(0)
v_cmp_eq_u32 vcc, 0, v0
s_ff1_i32_b64 s60, vcc
s_min_u32 s60, s60, 64
s_cmp_gt_u32 s60, s43
s_cbranch_scc0 L_krl63
L_kr63:
s_mov_b32 s44, s35
v_mov_b64 v[60:61], 0
v_mov_b64 v[62:63], 0
v_mov_b64 v[64:65], 0
v_mov_b64 v[66:67], 0
v_mov_b64 v[68:69], 0
v_mov_b64 v[70:71], 0
v_mov_b64 v[72:73], 0
v_mov_b64 v[74:75], 0
v_mov_b64 v[76:77], 0
v_mov_b64 v[78:79], 0
v_mov_b64 v[80:81], 0
v_mov_b64 v[82:83], 0
v_mov_b64 v[100:101], -1
v_mov_b64 v[102:103], -1
s_add_u32 s47, s68, 0
s_add_u32 s34, s34, 1
s_add_u32 s35, s34, 1
s_and_b32 s43, s34, 1
s_lshl_b32 s43, s43, 14
s_xor_b32 s42, s43, 16384
v_add_u32 v14, s42, v2
s_add_u32 s43, s43, 114688
s_mov_b32 m0, s43
s_add_u32 s42, s34, 1
s_cmp_eq_u32 s34, 63
s_cselect_b32 s42, 62, s42
s_lshl_b32 s64, s42, 19
s_lshl_b32 s40, s32, 14
s_add_u32 s64, s64, s40
s_add_u32 s64, s64, 0
s_lshl_b32 s50, s34, 5
s_add_u32 s50, s50, s32
s_lshl_b32 s65, s50, 11
s_add_u32 s65, s65, 41943040
s_lshl_b32 s66, s50, 12
s_add_u32 s66, s66, 33554432
s_and_b32 s45, s34, 1
s_mul_i32 s45, s45, 262144
s_mul_i32 s40, s32, 8192
s_add_u32 s68, s45, s40
s_add_u32 s68, s68, 46137344
s_add_u32 s45, s45, s56
s_add_u32 s45, s45, 46137344
s_add_u32 s67, s45, 32768
s_add_u32 s40, s34, 1
s_and_b32 s40, s40, 3
s_lshl_b32 s40, s40, 13
s_add_u32 s69, s40, 47185920
s_barrier
s_sleep 3
buffer_load_dwordx4 v[28:31], v1, s[4:7], s46 offen offset:0 sc1
buffer_load_dwordx4 v[32:35], v1, s[4:7], s46 offen offset:1024 sc1
s_sleep 1
L_pa_w0s:
buffer_load_dwordx4 v[84:87], v1, s[4:7], s46 offen offset:0 sc1
buffer_load_dwordx4 v[88:91], v1, s[4:7], s46 offen offset:1024 sc1
s_waitcnt vmcnt(2)
v_max3_u32 v0, v28, v29, v30
v_max3_u32 v15, v31, v32, v33
v_max3_u32 v0, v0, v34, v35
v_max_u32 v0, v0, v15
v_cmp_eq_u32 vcc, -1, v0
s_cbranch_vccz L_paok_w0s
buffer_load_dwordx4 v[28:31], v1, s[4:7], s46 offen offset:0 sc1
buffer_load_dwordx4 v[32:35], v1, s[4:7], s46 offen offset:1024 sc1
s_add_u32 s51, s51, 1
s_cmp_gt_u32 s51, 300000
s_cbranch_scc1 L_end
s_waitcnt vmcnt(2)
v_max3_u32 v0, v84, v85, v86
v_max3_u32 v15, v87, v88, v89
v_max3_u32 v0, v0, v90, v91
v_max_u32 v0, v0, v15
v_cmp_eq_u32 vcc, -1, v0
s_cbranch_vccnz L_pa_w0s
v_mov_b64 v[28:29], v[84:85]
v_mov_b64 v[30:31], v[86:87]
v_mov_b64 v[32:33], v[88:89]
v_mov_b64 v[34:35], v[90:91]
s_branch L_paok2_w0s
L_paok_w0s:
L_paok2_w0s:
s_branch L_step_w0s
L_step_w1s:
v_smfmac_f32_16x16x64_bf16 v[60:63], v[28:31], a[16:23], v3
ds_write_b128 v2, v[28:31] offset:34816
v_smfmac_f32_16x16x64_bf16 v[64:67], v[28:31], a[80:87], v3
ds_write_b128 v2, v[32:35] offset:35840
v_smfmac_f32_16x16x64_bf16 v[68:71], v[28:31], a[144:151], v3
v_smfmac_f32_16x16x64_bf16 v[72:75], v[28:31], a[208:215], v3
v_smfmac_f32_16x16x64_bf16 v[60:63], v[32:35], a[24:31], v3
v_smfmac_f32_16x16x64_bf16 v[64:67], v[32:35], a[88:95], v3
v_smfmac_f32_16x16x64_bf16 v[68:71], v[32:35], a[152:159], v3
v_smfmac_f32_16x16x64_bf16 v[72:75], v[32:35], a[216:223], v3
s_waitcnt lgkmcnt(0)
s_barrier
ds_read_b128 v[36:39], v2 offset:32768
ds_read_b128 v[40:43], v2 offset:33792
v_smfmac_f32_16x16x64_bf16 v[76:79], v[28:31], v[144:151], v3
ds_read_b128 v[44:47], v2 offset:36864
ds_read_b128 v[48:51], v2 offset:37888
v_smfmac_f32_16x16x64_bf16 v[80:83], v[28:31], v[208:215], v3
ds_read_b128 v[52:55], v2 offset:38912
ds_read_b128 v[56:59], v2 offset:39936
v_smfmac_f32_16x16x64_bf16 v[76:79], v[32:35], v[152:159], v3
v_smfmac_f32_16x16x64_bf16 v[80:83], v[32:35], v[216:223], v3
s_waitcnt lgkmcnt(4)
v_smfmac_f32_16x16x64_bf16 v[60:63], v[36:39], a[0:7], v3
v_smfmac_f32_16x16x64_bf16 v[64:67], v[36:39], a[64:71], v3
v_smfmac_f32_16x16x64_bf16 v[60:63], v[40:43], a[8:15], v3
v_smfmac_f32_16x16x64_bf16 v[64:67], v[40:43], a[72:79], v3
s_waitcnt vmcnt(0) lgkmcnt(0)
v_smfmac_f32_16x16x64_bf16 v[60:63], v[44:47], a[32:39], v3
ds_read_b128 v[28:31], v14 offset:0
v_smfmac_f32_16x16x64_bf16 v[64:67], v[44:47], a[96:103], v3
buffer_store_dwordx4 v[100:103], v1, s[4:7], s47 offen offset:0 sc1
ds_read_b128 v[32:35], v14 offset:1024
v_smfmac_f32_16x16x64_bf16 v[60:63], v[48:51], a[40:47], v3
ds_read_b128 v[104:107], v14 offset:5120
v_smfmac_f32_16x16x64_bf16 v[64:67], v[48:51], a[104:111], v3
ds_read_b128 v[108:111], v14 offset:6144
v_smfmac_f32_16x16x64_bf16 v[60:63], v[52:55], a[48:55], v3
v_smfmac_f32_16x16x64_bf16 v[64:67], v[52:55], a[112:119], v3
buffer_store_dwordx4 v[100:103], v1, s[4:7], s47 offen offset:1024 sc1
v_smfmac_f32_16x16x64_bf16 v[60:63], v[56:59], a[56:63], v3
v_smfmac_f32_16x16x64_bf16 v[64:67], v[56:59], a[120:127], v3
v_smfmac_f32_16x16x64_bf16 v[68:71], v[36:39], a[128:135], v3
v_smfmac_f32_16x16x64_bf16 v[72:75], v[36:39], a[192:199], v3
ds_read_b128 v[100:103], v14 offset:4096
buffer_load_dwordx4 v1, s[4:7], s64 offen offset:0 sc1 lds
v_add_f32 v60, v60, v61
v_smfmac_f32_16x16x64_bf16 v[68:71], v[40:43], a[136:143], v3
v_add_f32 v62, v62, v63
v_smfmac_f32_16x16x64_bf16 v[72:75], v[40:43], a[200:207], v3
v_cvt_pk_bf16_f32 v0, v60, v62
v_smfmac_f32_16x16x64_bf16 v[68:71], v[44:47], a[160:167], v3
v_add_f32 v64, v64, v65
v_smfmac_f32_16x16x64_bf16 v[72:75], v[44:47], a[224:231], v3
buffer_load_dwordx4 v1, s[4:7], s64 offen offset:1024 sc1 lds
v_add_f32 v66, v66, v67
v_smfmac_f32_16x16x64_bf16 v[68:71], v[48:51], a[168:175], v3
v_cvt_pk_bf16_f32 v15, v64, v66
v_smfmac_f32_16x16x64_bf16 v[72:75], v[48:51], a[232:239], v3
ds_write2_b32 v4, v0, v15 offset0:0 offset1:64
v_smfmac_f32_16x16x64_bf16 v[68:71], v[52:55], a[176:183], v3
v_smfmac_f32_16x16x64_bf16 v[72:75], v[52:55], a[240:247], v3
buffer_load_dwordx4 v1, s[4:7], s64 offen offset:2048 sc1 lds
ds_read_b128 v[64:67], v14 offset:7168
v_smfmac_f32_16x16x64_bf16 v[68:71], v[56:59], a[184:191], v3
v_smfmac_f32_16x16x64_bf16 v[72:75], v[56:59], a[248:255], v3
v_smfmac_f32_16x16x64_bf16 v[76:79], v[36:39], v[128:135], v3
s_nop 0
v_add_f32 v68, v68, v69
v_add_f32 v70, v70, v71
v_cvt_pk_bf16_f32 v0, v68, v70
v_smfmac_f32_16x16x64_bf16 v[80:83], v[36:39], v[192:199], v3
v_add_f32 v72, v72, v73
v_add_f32 v74, v74, v75
v_cvt_pk_bf16_f32 v15, v72, v74
ds_write2_b32 v5, v0, v15 offset0:0 offset1:128
ds_read_b128 v[36:39], v14 offset:2048
v_smfmac_f32_16x16x64_bf16 v[76:79], v[40:43], v[136:143], v3
s_waitcnt lgkmcnt(0)
s_barrier
ds_read_b64_tr_b16 v[84:85], v6 offset:0
ds_read_b64_tr_b16 v[86:87], v6 offset:64
v_smfmac_f32_16x16x64_bf16 v[80:83], v[40:43], v[200:207], v3
ds_read_b64_tr_b16 v[88:89], v6 offset:512
ds_read_b64_tr_b16 v[90:91], v6 offset:576
v_smfmac_f32_16x16x64_bf16 v[76:79], v[44:47], v[160:167], v3
ds_read_b64_tr_b16 v[92:93], v6 offset:1024
ds_read_b64_tr_b16 v[94:95], v6 offset:1088
v_smfmac_f32_16x16x64_bf16 v[80:83], v[44:47], v[224:231], v3
ds_read_b64_tr_b16 v[96:97], v6 offset:1536
ds_read_b64_tr_b16 v[98:99], v6 offset:1600
v_smfmac_f32_16x16x64_bf16 v[76:79], v[48:51], v[168:175], v3
ds_read_b128 v[40:43], v14 offset:3072
v_smfmac_f32_16x16x64_bf16 v[80:83], v[48:51], v[232:239], v3
v_smfmac_f32_16x16x64_bf16 v[76:79], v[52:55], v[176:183], v3
ds_read_b64_tr_b16 v[44:45], v7 offset:0
ds_read_b64_tr_b16 v[46:47], v7 offset:128
ds_read_b64_tr_b16 v[48:49], v7 offset:1024
ds_read_b64_tr_b16 v[50:51], v7 offset:1152
v_smfmac_f32_16x16x64_bf16 v[80:83], v[52:55], v[240:247], v3
ds_read_b64_tr_b16 v[52:53], v7 offset:2048
ds_read_b64_tr_b16 v[54:55], v7 offset:2176
v_smfmac_f32_16x16x64_bf16 v[76:79], v[56:59], v[184:191], v3
v_smfmac_f32_16x16x64_bf16 v[80:83], v[56:59], v[248:255], v3
ds_read_b64_tr_b16 v[56:57], v7 offset:3072
ds_read_b64_tr_b16 v[58:59], v7 offset:3200
s_waitcnt lgkmcnt(8)
v_mfma_f32_16x16x32_bf16 v[72:75], v[100:103], v[84:87], 0
v_mfma_f32_16x16x32_bf16 v[72:75], v[104:107], v[88:91], v[72:75]
buffer_load_dwordx4 v1, s[4:7], s64 offen offset:3072 sc1 lds
v_add_f32 v76, v76, v77
v_add_f32 v78, v78, v79
v_mfma_f32_16x16x32_bf16 v[72:75], v[108:111], v[92:95], v[72:75]
v_cvt_pk_bf16_f32 v77, v76, v78
v_add_f32 v80, v80, v81
v_mfma_f32_16x16x32_bf16 v[72:75], v[64:67], v[96:99], v[72:75]
v_add_f32 v82, v82, v83
v_cvt_pk_bf16_f32 v83, v80, v82
v_mfma_f32_16x16x32_bf16 v[68:71], v[28:31], v[84:87], 0
v_mov_b32 v82, v77
v_lshrrev_b32 v15, 1, v1
ds_read_b128 v[100:103], v10 offset:0
v_mfma_f32_16x16x32_bf16 v[68:71], v[32:35], v[88:91], v[68:71]
ds_read_b128 v[104:107], v10 offset:1024
v_mfma_f32_16x16x32_bf16 v[68:71], v[36:39], v[92:95], v[68:71]
buffer_store_dwordx2 v[82:83], v15, s[4:7], s65 offen sc1
v_mfma_f32_16x16x32_bf16 v[68:71], v[40:43], v[96:99], v[68:71]
s_waitcnt lgkmcnt(2)
v_mfma_f32_16x16x32_bf16 v[60:63], v[44:47], v[84:87], 0
ds_read_b128 v[28:31], v14 offset:10240
v_max3_f32 v0, v72, v73, v74
v_mfma_f32_16x16x32_bf16 v[60:63], v[48:51], v[88:91], v[60:63]
ds_read_b128 v[32:35], v14 offset:11264
buffer_store_dwordx4 v[48:51], v1, s[4:7], s66 offen sc1
v_mfma_f32_16x16x32_bf16 v[60:63], v[52:55], v[92:95], v[60:63]
ds_read_b128 v[36:39], v11 offset:0
v_max3_f32 v0, v0, v75, v68
v_max3_f32 v0, v0, v69, v70
v_mfma_f32_16x16x32_bf16 v[60:63], v[56:59], v[96:99], v[60:63]
ds_read_b128 v[40:43], v11 offset:1024
v_max_f32 v0, v0, v71
s_cmp_eq_u32 s34, 63
s_cbranch_scc1 L_chain_fin
s_nop 1
s_nop 1
v_max3_f32 v0, v0, v60, v61
v_mov_b32 v15, v0
s_nop 1
v_permlane16_swap_b32 v0, v15
v_max_f32 v0, v0, v15
v_mov_b32 v15, v0
s_nop 1
v_permlane32_swap_b32 v0, v15
v_max_f32 v0, v0, v15
v_mul_f32 v62, s38, v0
v_pk_fma_f32 v[68:69], v[68:69], s[38:39], v[62:63] op_sel_hi:[1,1,0] neg_lo:[0,0,1] neg_hi:[0,0,1]
v_pk_fma_f32 v[70:71], v[70:71], s[38:39], v[62:63] op_sel_hi:[1,1,0] neg_lo:[0,0,1] neg_hi:[0,0,1]
v_pk_fma_f32 v[72:73], v[72:73], s[38:39], v[62:63] op_sel_hi:[1,1,0] neg_lo:[0,0,1] neg_hi:[0,0,1]
v_pk_fma_f32 v[74:75], v[74:75], s[38:39], v[62:63] op_sel_hi:[1,1,0] neg_lo:[0,0,1] neg_hi:[0,0,1]
v_pk_fma_f32 v[60:61], v[60:61], s[38:39], v[62:63] op_sel_hi:[1,1,0] neg_lo:[0,0,1] neg_hi:[0,0,1]
v_exp_f32 v68, v68
v_exp_f32 v69, v69
ds_read_b128 v[44:47], v10 offset:2048
v_exp_f32 v70, v70
v_exp_f32 v71, v71
ds_read_b128 v[48:51], v10 offset:3072
v_cvt_pk_bf16_f32 v76, v68, v69
v_exp_f32 v72, v72
v_cvt_pk_bf16_f32 v77, v70, v71
v_exp_f32 v73, v73
s_waitcnt lgkmcnt(4)
v_mfma_f32_16x16x16_bf16 v[92:95], v[16:17], v[76:77], 0
v_exp_f32 v74, v74
v_mfma_f32_16x16x16_bf16 v[84:87], v[28:29], v[76:77], 0
v_exp_f32 v75, v75
v_mfma_f32_16x16x16_bf16 v[88:91], v[32:33], v[76:77], 0
v_cvt_pk_bf16_f32 v78, v72, v73
v_exp_f32 v60, v60
v_cvt_pk_bf16_f32 v79, v74, v75
v_exp_f32 v61, v61
s_nop 0
v_mfma_f32_16x16x16_bf16 v[92:95], v[16:17], v[78:79], v[92:95]
ds_read_b128 v[52:55], v11 offset:2048
v_cvt_pk_bf16_f32 v24, v60, v61
v_mfma_f32_16x16x16_bf16 v[84:87], v[30:31], v[78:79], v[84:87]
ds_read_b128 v[56:59], v11 offset:3072
v_cvt_pk_bf16_f32 v27, v60, v61
v_mfma_f32_16x16x16_bf16 v[88:91], v[34:35], v[78:79], v[88:91]
v_mfma_f32_16x16x16_bf16 v[92:95], v[16:17], v[24:25], v[92:95]
v_mfma_f32_16x16x16_bf16 v[84:87], v[82:83], v[24:25], v[84:87]
v_mfma_f32_16x16x16_bf16 v[88:91], v[82:83], v[26:27], v[88:91]
s_nop 0
v_rcp_f32 v0, v92
s_nop 2
v_pk_mul_f32 v[84:85], v[84:85], v[0:1] op_sel_hi:[1,0]
v_pk_mul_f32 v[86:87], v[86:87], v[0:1] op_sel_hi:[1,0]
v_cvt_pk_bf16_f32 v84, v84, v85
v_cvt_pk_bf16_f32 v85, v86, v87
ds_write_b64 v8, v[84:85]
v_pk_mul_f32 v[88:89], v[88:89], v[0:1] op_sel_hi:[1,0]
v_pk_mul_f32 v[90:91], v[90:91], v[0:1] op_sel_hi:[1,0]
v_cvt_pk_bf16_f32 v88, v88, v89
v_cvt_pk_bf16_f32 v89, v90, v91
ds_write_b64 v8, v[88:89] offset:32
v_mov_b64 v[68:69], 0
v_mov_b64 v[70:71], 0
v_mov_b64 v[72:73], 0
v_mov_b64 v[74:75], 0
v_mov_b64 v[76:77], 0
v_mov_b64 v[78:79], 0
v_mov_b64 v[60:61], 0
v_mov_b64 v[62:63], 0
s_waitcnt vmcnt(6) lgkmcnt(0)
s_barrier
ds_read_b128 v[28:31], v9
ds_read_b128 v[32:35], v9 offset:128
ds_read_b128 v[84:87], v10 offset:4096
ds_read_b128 v[88:91], v10 offset:5120
v_mov_b64 v[64:65], 0
v_mov_b64 v[66:67], 0
v_mov_b64 v[80:81], 0
v_mov_b64 v[82:83], 0
v_mov_b64 v[96:97], 0
v_mov_b64 v[98:99], 0
v_mov_b64 v[92:93], 0
v_mov_b64 v[94:95], 0
s_waitcnt lgkmcnt(2)
v_smfmac_f32_16x16x64_bf16 v[72:75], v[28:31], v[100:107], v3
ds_read_b128 v[100:103], v11 offset:4096
ds_read_b128 v[104:107], v11 offset:5120
v_smfmac_f32_16x16x64_bf16 v[72:75], v[32:35], v[36:43], v3
ds_read_b128 v[36:39], v10 offset:6144
ds_read_b128 v[40:43], v10 offset:7168
v_smfmac_f32_16x16x64_bf16 v[76:79], v[28:31], v[44:51], v3
ds_read_b128 v[44:47], v11 offset:6144
ds_read_b128 v[48:51], v11 offset:7168
v_smfmac_f32_16x16x64_bf16 v[76:79], v[32:35], v[52:59], v3
ds_read_b128 v[52:55], v10 offset:8192
ds_read_b128 v[56:59], v10 offset:9216
v_add_f32 v72, v72, v73
v_smfmac_f32_16x16x64_bf16 v[68:71], v[28:31], v[112:119], v3
v_add_f32 v74, v74, v75
v_cvt_pk_bf16_f32 v109, v72, v74
v_smfmac_f32_16x16x64_bf16 v[68:71], v[32:35], v[120:127], v3
s_nop 0
v_add_f32 v76, v76, v77
v_add_f32 v78, v78, v79
s_waitcnt lgkmcnt(6)
v_smfmac_f32_16x16x64_bf16 v[60:63], v[28:31], v[84:91], v3
ds_read_b128 v[84:87], v11 offset:8192
ds_read_b128 v[88:91], v11 offset:9216
v_cvt_pk_bf16_f32 v110, v76, v78
v_smfmac_f32_16x16x64_bf16 v[60:63], v[32:35], v[100:107], v3
ds_read_b128 v[100:103], v10 offset:10240
ds_read_b128 v[104:107], v10 offset:11264
v_add_f32 v68, v68, v69
s_waitcnt lgkmcnt(6)
v_smfmac_f32_16x16x64_bf16 v[64:67], v[28:31], v[36:43], v3
ds_read_b128 v[36:39], v11 offset:10240
ds_read_b128 v[40:43], v11 offset:11264
v_add_f32 v70, v70, v71
v_cvt_pk_bf16_f32 v108, v68, v70
v_smfmac_f32_16x16x64_bf16 v[64:67], v[32:35], v[44:51], v3
ds_read_b128 v[44:47], v10 offset:12288
ds_read_b128 v[48:51], v10 offset:13312
v_add_f32 v60, v60, v61
v_add_f32 v62, v62, v63
v_cvt_pk_bf16_f32 v111, v60, v62
buffer_store_dwordx4 v[108:111], v12, s[4:7], s45 offen sc1
s_waitcnt lgkmcnt(6)
v_smfmac_f32_16x16x64_bf16 v[80:83], v[28:31], v[52:59], v3
ds_read_b128 v[52:55], v11 offset:12288
ds_read_b128 v[56:59], v11 offset:13312
v_smfmac_f32_16x16x64_bf16 v[80:83], v[32:35], v[84:91], v3
v_add_f32 v64, v64, v65
v_add_f32 v66, v66, v67
s_waitcnt lgkmcnt(4)
v_smfmac_f32_16x16x64_bf16 v[96:99], v[28:31], v[100:107], v3
v_cvt_pk_bf16_f32 v108, v64, v66
v_smfmac_f32_16x16x64_bf16 v[96:99], v[32:35], v[36:43], v3
s_nop 0
v_add_f32 v80, v80, v81
v_add_f32 v82, v82, v83
s_waitcnt lgkmcnt(0)
v_smfmac_f32_16x16x64_bf16 v[92:95], v[28:31], v[44:51], v3
v_cvt_pk_bf16_f32 v109, v80, v82
v_smfmac_f32_16x16x64_bf16 v[92:95], v[32:35], v[52:59], v3
v_add_f32 v96, v96, v97
v_add_f32 v98, v98, v99
v_cvt_pk_bf16_f32 v110, v96, v98
s_nop 4
v_add_f32 v92, v92, v93
v_add_f32 v94, v94, v95
v_cvt_pk_bf16_f32 v111, v92, v94
buffer_store_dwordx4 v[108:111], v12, s[4:7], s67 offen sc1
s_mov_b32 s46, s69
v_mov_b64 v[60:61], 0
v_mov_b64 v[62:63], 0
v_mov_b64 v[64:65], 0
v_mov_b64 v[66:67], 0
v_mov_b64 v[68:69], 0
v_mov_b64 v[70:71], 0
v_mov_b64 v[72:73], 0
v_mov_b64 v[74:75], 0
v_mov_b64 v[76:77], 0
v_mov_b64 v[78:79], 0
v_mov_b64 v[80:81], 0
v_mov_b64 v[82:83], 0
v_mov_b64 v[100:101], -1
v_mov_b64 v[102:103], -1
s_add_u32 s47, s68, 2048
s_add_u32 s34, s34, 1
s_add_u32 s35, s34, 1
s_and_b32 s43, s34, 1
s_lshl_b32 s43, s43, 14
s_xor_b32 s42, s43, 16384
v_add_u32 v14, s42, v2
s_add_u32 s43, s43, 118784
s_mov_b32 m0, s43
s_add_u32 s42, s34, 1
s_cmp_eq_u32 s34, 63
s_cselect_b32 s42, 62, s42
s_lshl_b32 s64, s42, 19
s_lshl_b32 s40, s32, 14
s_add_u32 s64, s64, s40
s_add_u32 s64, s64, 4096
s_lshl_b32 s50, s34, 5
s_add_u32 s50, s50, s32
s_lshl_b32 s65, s50, 11
s_add_u32 s65, s65, 41943552
s_lshl_b32 s66, s50, 12
s_add_u32 s66, s66, 33555456
s_and_b32 s45, s34, 1
s_mul_i32 s45, s45, 262144
s_mul_i32 s40, s32, 8192
s_add_u32 s68, s45, s40
s_add_u32 s68, s68, 46137344
s_add_u32 s45, s45, s56
s_add_u32 s45, s45, 46202880
s_add_u32 s67, s45, 32768
s_add_u32 s40, s34, 1
s_and_b32 s40, s40, 3
s_lshl_b32 s40, s40, 13
s_add_u32 s69, s40, 47187968
s_barrier
s_sleep 3
buffer_load_dwordx4 v[28:31], v1, s[4:7], s46 offen offset:0 sc1
buffer_load_dwordx4 v[32:35], v1, s[4:7], s46 offen offset:1024 sc1
s_sleep 1
L_pa_w1s:
buffer_load_dwordx4 v[84:87], v1, s[4:7], s46 offen offset:0 sc1
buffer_load_dwordx4 v[88:91], v1, s[4:7], s46 offen offset:1024 sc1
s_waitcnt vmcnt(2)
v_max3_u32 v0, v28, v29, v30
v_max3_u32 v15, v31, v32, v33
v_max3_u32 v0, v0, v34, v35
v_max_u32 v0, v0, v15
v_cmp_eq_u32 vcc, -1, v0
s_cbranch_vccz L_paok_w1s
buffer_load_dwordx4 v[28:31], v1, s[4:7], s46 offen offset:0 sc1
buffer_load_dwordx4 v[32:35], v1, s[4:7], s46 offen offset:1024 sc1
s_add_u32 s51, s51, 1
s_cmp_gt_u32 s51, 300000
s_cbranch_scc1 L_end
s_waitcnt vmcnt(2)
v_max3_u32 v0, v84, v85, v86
v_max3_u32 v15, v87, v88, v89
v_max3_u32 v0, v0, v90, v91
v_max_u32 v0, v0, v15
v_cmp_eq_u32 vcc, -1, v0
s_cbranch_vccnz L_pa_w1s
v_mov_b64 v[28:29], v[84:85]
v_mov_b64 v[30:31], v[86:87]
v_mov_b64 v[32:33], v[88:89]
v_mov_b64 v[34:35], v[90:91]
s_branch L_paok2_w1s
L_paok_w1s:
L_paok2_w1s:
s_branch L_step_w1s
L_step_w2s:
v_smfmac_f32_16x16x64_bf16 v[60:63], v[28:31], a[32:39], v3
ds_write_b128 v2, v[28:31] offset:36864
v_smfmac_f32_16x16x64_bf16 v[64:67], v[28:31], a[96:103], v3
ds_write_b128 v2, v[32:35] offset:37888
v_smfmac_f32_16x16x64_bf16 v[68:71], v[28:31], a[160:167], v3
v_smfmac_f32_16x16x64_bf16 v[72:75], v[28:31], a[224:231], v3
v_smfmac_f32_16x16x64_bf16 v[60:63], v[32:35], a[40:47], v3
v_smfmac_f32_16x16x64_bf16 v[64:67], v[32:35], a[104:111], v3
v_smfmac_f32_16x16x64_bf16 v[68:71], v[32:35], a[168:175], v3
v_smfmac_f32_16x16x64_bf16 v[72:75], v[32:35], a[232:239], v3
s_waitcnt lgkmcnt(0)
s_barrier
ds_read_b128 v[36:39], v2 offset:32768
ds_read_b128 v[40:43], v2 offset:33792
v_smfmac_f32_16x16x64_bf16 v[76:79], v[28:31], v[160:167], v3
ds_read_b128 v[44:47], v2 offset:34816
ds_read_b128 v[48:51], v2 offset:35840
v_smfmac_f32_16x16x64_bf16 v[80:83], v[28:31], v[224:231], v3
ds_read_b128 v[52:55], v2 offset:38912
ds_read_b128 v[56:59], v2 offset:39936
v_smfmac_f32_16x16x64_bf16 v[76:79], v[32:35], v[168:175], v3
v_smfmac_f32_16x16x64_bf16 v[80:83], v[32:35], v[232:239], v3
s_waitcnt lgkmcnt(4)
v_smfmac_f32_16x16x64_bf16 v[60:63], v[36:39], a[0:7], v3
v_smfmac_f32_16x16x64_bf16 v[64:67], v[36:39], a[64:71], v3
v_smfmac_f32_16x16x64_bf16 v[60:63], v[40:43], a[8:15], v3
v_smfmac_f32_16x16x64_bf16 v[64:67], v[40:43], a[72:79], v3
s_waitcnt vmcnt(0) lgkmcnt(0)
v_smfmac_f32_16x16x64_bf16 v[60:63], v[44:47], a[16:23], v3
ds_read_b128 v[28:31], v14 offset:0
v_smfmac_f32_16x16x64_bf16 v[64:67], v[44:47], a[80:87], v3
buffer_store_dwordx2 v[100:101], v13, s[4:7], s52 offen sc1
ds_read_b128 v[32:35], v14 offset:1024
v_smfmac_f32_16x16x64_bf16 v[60:63], v[48:51], a[24:31], v3
buffer_store_dwordx4 v[100:103], v1, s[4:7], s47 offen offset:0 sc1
ds_read_b128 v[104:107], v14 offset:5120
v_smfmac_f32_16x16x64_bf16 v[64:67], v[48:51], a[88:95], v3
ds_read_b128 v[108:111], v14 offset:6144
v_smfmac_f32_16x16x64_bf16 v[60:63], v[52:55], a[48:55], v3
v_smfmac_f32_16x16x64_bf16 v[64:67], v[52:55], a[112:119], v3
v_smfmac_f32_16x16x64_bf16 v[60:63], v[56:59], a[56:63], v3
buffer_store_dwordx4 v[100:103], v1, s[4:7], s47 offen offset:1024 sc1
v_smfmac_f32_16x16x64_bf16 v[64:67], v[56:59], a[120:127], v3
v_smfmac_f32_16x16x64_bf16 v[68:71], v[36:39], a[128:135], v3
v_smfmac_f32_16x16x64_bf16 v[72:75], v[36:39], a[192:199], v3
ds_read_b128 v[100:103], v14 offset:4096
v_add_f32 v60, v60, v61
v_smfmac_f32_16x16x64_bf16 v[68:71], v[40:43], a[136:143], v3
buffer_load_dwordx4 v1, s[4:7], s64 offen offset:0 sc1 lds
v_add_f32 v62, v62, v63
v_smfmac_f32_16x16x64_bf16 v[72:75], v[40:43], a[200:207], v3
v_cvt_pk_bf16_f32 v0, v60, v62
v_smfmac_f32_16x16x64_bf16 v[68:71], v[44:47], a[144:151], v3
v_add_f32 v64, v64, v65
v_smfmac_f32_16x16x64_bf16 v[72:75], v[44:47], a[208:215], v3
v_add_f32 v66, v66, v67
v_smfmac_f32_16x16x64_bf16 v[68:71], v[48:51], a[152:159], v3
buffer_load_dwordx4 v1, s[4:7], s64 offen offset:1024 sc1 lds
v_cvt_pk_bf16_f32 v15, v64, v66
v_smfmac_f32_16x16x64_bf16 v[72:75], v[48:51], a[216:223], v3
ds_write2_b32 v4, v0, v15 offset0:0 offset1:64
v_smfmac_f32_16x16x64_bf16 v[68:71], v[52:55], a[176:183], v3
v_smfmac_f32_16x16x64_bf16 v[72:75], v[52:55], a[240:247], v3
ds_read_b128 v[64:67], v14 offset:7168
v_smfmac_f32_16x16x64_bf16 v[68:71], v[56:59], a[184:191], v3
buffer_load_dwordx4 v1, s[4:7], s64 offen offset:2048 sc1 lds
v_smfmac_f32_16x16x64_bf16 v[72:75], v[56:59], a[248:255], v3
v_smfmac_f32_16x16x64_bf16 v[76:79], v[36:39], v[128:135], v3
s_nop 0
v_add_f32 v68, v68, v69
v_add_f32 v70, v70, v71
v_cvt_pk_bf16_f32 v0, v68, v70
v_smfmac_f32_16x16x64_bf16 v[80:83], v[36:39], v[192:199], v3
v_add_f32 v72, v72, v73
v_add_f32 v74, v74, v75
v_cvt_pk_bf16_f32 v15, v72, v74
ds_write2_b32 v5, v0, v15 offset0:0 offset1:128
ds_read_b128 v[36:39], v14 offset:2048
v_smfmac_f32_16x16x64_bf16 v[76:79], v[40:43], v[136:143], v3
s_waitcnt lgkmcnt(0)
s_barrier
ds_read_b64_tr_b16 v[84:85], v6 offset:0
ds_read_b64_tr_b16 v[86:87], v6 offset:64
v_smfmac_f32_16x16x64_bf16 v[80:83], v[40:43], v[200:207], v3
ds_read_b64_tr_b16 v[88:89], v6 offset:512
ds_read_b64_tr_b16 v[90:91], v6 offset:576
v_smfmac_f32_16x16x64_bf16 v[76:79], v[44:47], v[144:151], v3
ds_read_b64_tr_b16 v[92:93], v6 offset:1024
ds_read_b64_tr_b16 v[94:95], v6 offset:1088
v_smfmac_f32_16x16x64_bf16 v[80:83], v[44:47], v[208:215], v3
ds_read_b64_tr_b16 v[96:97], v6 offset:1536
ds_read_b64_tr_b16 v[98:99], v6 offset:1600
v_smfmac_f32_16x16x64_bf16 v[76:79], v[48:51], v[152:159], v3
ds_read_b128 v[40:43], v14 offset:3072
v_smfmac_f32_16x16x64_bf16 v[80:83], v[48:51], v[216:223], v3
v_smfmac_f32_16x16x64_bf16 v[76:79], v[52:55], v[176:183], v3
ds_read_b64_tr_b16 v[44:45], v7 offset:0
ds_read_b64_tr_b16 v[46:47], v7 offset:128
ds_read_b64_tr_b16 v[48:49], v7 offset:1024
ds_read_b64_tr_b16 v[50:51], v7 offset:1152
v_smfmac_f32_16x16x64_bf16 v[80:83], v[52:55], v[240:247], v3
ds_read_b64_tr_b16 v[52:53], v7 offset:2048
ds_read_b64_tr_b16 v[54:55], v7 offset:2176
v_smfmac_f32_16x16x64_bf16 v[76:79], v[56:59], v[184:191], v3
v_smfmac_f32_16x16x64_bf16 v[80:83], v[56:59], v[248:255], v3
ds_read_b64_tr_b16 v[56:57], v7 offset:3072
ds_read_b64_tr_b16 v[58:59], v7 offset:3200
s_waitcnt lgkmcnt(8)
v_mfma_f32_16x16x32_bf16 v[72:75], v[100:103], v[84:87], 0
v_mfma_f32_16x16x32_bf16 v[72:75], v[104:107], v[88:91], v[72:75]
v_add_f32 v76, v76, v77
v_add_f32 v78, v78, v79
v_mfma_f32_16x16x32_bf16 v[72:75], v[108:111], v[92:95], v[72:75]
buffer_load_dwordx4 v1, s[4:7], s64 offen offset:3072 sc1 lds
v_cvt_pk_bf16_f32 v77, v76, v78
v_add_f32 v80, v80, v81
v_mfma_f32_16x16x32_bf16 v[72:75], v[64:67], v[96:99], v[72:75]
v_add_f32 v82, v82, v83
v_cvt_pk_bf16_f32 v83, v80, v82
v_mfma_f32_16x16x32_bf16 v[68:71], v[28:31], v[84:87], 0
v_mov_b32 v82, v77
v_lshrrev_b32 v15, 1, v1
ds_read_b128 v[100:103], v10 offset:0
v_mfma_f32_16x16x32_bf16 v[68:71], v[32:35], v[88:91], v[68:71]
ds_read_b128 v[104:107], v10 offset:1024
buffer_store_dwordx2 v[82:83], v15, s[4:7], s65 offen sc1
v_mfma_f32_16x16x32_bf16 v[68:71], v[36:39], v[92:95], v[68:71]
v_mfma_f32_16x16x32_bf16 v[68:71], v[40:43], v[96:99], v[68:71]
s_waitcnt lgkmcnt(2)
v_mfma_f32_16x16x32_bf16 v[60:63], v[44:47], v[84:87], 0
ds_read_b128 v[28:31], v14 offset:12288
v_max3_f32 v0, v72, v73, v74
v_mfma_f32_16x16x32_bf16 v[60:63], v[48:51], v[88:91], v[60:63]
ds_read_b128 v[32:35], v14 offset:13312
v_mfma_f32_16x16x32_bf16 v[60:63], v[52:55], v[92:95], v[60:63]
ds_read_b128 v[36:39], v11 offset:0
buffer_store_dwordx4 v[52:55], v1, s[4:7], s66 offen sc1
v_max3_f32 v0, v0, v75, v68
v_max3_f32 v0, v0, v69, v70
v_mfma_f32_16x16x32_bf16 v[60:63], v[56:59], v[96:99], v[60:63]
ds_read_b128 v[40:43], v11 offset:1024
v_max_f32 v0, v0, v71
s_cmp_eq_u32 s34, 63
s_cbranch_scc1 L_chain_fin
s_nop 1
s_nop 1
v_max3_f32 v0, v0, v60, v61
v_mov_b32 v15, v0
s_nop 1
v_permlane16_swap_b32 v0, v15
v_max_f32 v0, v0, v15
v_mov_b32 v15, v0
s_nop 1
v_permlane32_swap_b32 v0, v15
v_max_f32 v0, v0, v15
v_mul_f32 v62, s38, v0
v_pk_fma_f32 v[68:69], v[68:69], s[38:39], v[62:63] op_sel_hi:[1,1,0] neg_lo:[0,0,1] neg_hi:[0,0,1]
v_pk_fma_f32 v[70:71], v[70:71], s[38:39], v[62:63] op_sel_hi:[1,1,0] neg_lo:[0,0,1] neg_hi:[0,0,1]
v_pk_fma_f32 v[72:73], v[72:73], s[38:39], v[62:63] op_sel_hi:[1,1,0] neg_lo:[0,0,1] neg_hi:[0,0,1]
v_pk_fma_f32 v[74:75], v[74:75], s[38:39], v[62:63] op_sel_hi:[1,1,0] neg_lo:[0,0,1] neg_hi:[0,0,1]
v_pk_fma_f32 v[60:61], v[60:61], s[38:39], v[62:63] op_sel_hi:[1,1,0] neg_lo:[0,0,1] neg_hi:[0,0,1]
v_exp_f32 v68, v68
v_exp_f32 v69, v69
ds_read_b128 v[44:47], v10 offset:2048
v_exp_f32 v70, v70
v_exp_f32 v71, v71
ds_read_b128 v[48:51], v10 offset:3072
v_cvt_pk_bf16_f32 v76, v68, v69
v_exp_f32 v72, v72
v_cvt_pk_bf16_f32 v77, v70, v71
v_exp_f32 v73, v73
s_waitcnt lgkmcnt(4)
v_mfma_f32_16x16x16_bf16 v[92:95], v[16:17], v[76:77], 0
v_exp_f32 v74, v74
v_mfma_f32_16x16x16_bf16 v[84:87], v[28:29], v[76:77], 0
v_exp_f32 v75, v75
v_mfma_f32_16x16x16_bf16 v[88:91], v[32:33], v[76:77], 0
v_cvt_pk_bf16_f32 v78, v72, v73
v_exp_f32 v60, v60
v_cvt_pk_bf16_f32 v79, v74, v75
v_exp_f32 v61, v61
s_nop 0
v_mfma_f32_16x16x16_bf16 v[92:95], v[16:17], v[78:79], v[92:95]
ds_read_b128 v[52:55], v11 offset:2048
v_cvt_pk_bf16_f32 v24, v60, v61
v_mfma_f32_16x16x16_bf16 v[84:87], v[30:31], v[78:79], v[84:87]
ds_read_b128 v[56:59], v11 offset:3072
v_cvt_pk_bf16_f32 v27, v60, v61
v_mfma_f32_16x16x16_bf16 v[88:91], v[34:35], v[78:79], v[88:91]
v_mfma_f32_16x16x16_bf16 v[92:95], v[16:17], v[24:25], v[92:95]
v_mfma_f32_16x16x16_bf16 v[84:87], v[82:83], v[24:25], v[84:87]
v_mfma_f32_16x16x16_bf16 v[88:91], v[82:83], v[26:27], v[88:91]
s_nop 0
v_rcp_f32 v0, v92
s_nop 2
v_pk_mul_f32 v[84:85], v[84:85], v[0:1] op_sel_hi:[1,0]
v_pk_mul_f32 v[86:87], v[86:87], v[0:1] op_sel_hi:[1,0]
v_cvt_pk_bf16_f32 v84, v84, v85
v_cvt_pk_bf16_f32 v85, v86, v87
ds_write_b64 v8, v[84:85]
v_pk_mul_f32 v[88:89], v[88:89], v[0:1] op_sel_hi:[1,0]
v_pk_mul_f32 v[90:91], v[90:91], v[0:1] op_sel_hi:[1,0]
v_cvt_pk_bf16_f32 v88, v88, v89
v_cvt_pk_bf16_f32 v89, v90, v91
ds_write_b64 v8, v[88:89] offset:32
v_mov_b64 v[68:69], 0
v_mov_b64 v[70:71], 0
v_mov_b64 v[72:73], 0
v_mov_b64 v[74:75], 0
v_mov_b64 v[76:77], 0
v_mov_b64 v[78:79], 0
v_mov_b64 v[60:61], 0
v_mov_b64 v[62:63], 0
s_waitcnt vmcnt(6) lgkmcnt(0)
s_barrier
ds_read_b128 v[28:31], v9
ds_read_b128 v[32:35], v9 offset:128
ds_read_b128 v[84:87], v10 offset:4096
ds_read_b128 v[88:91], v10 offset:5120
v_mov_b64 v[64:65], 0
v_mov_b64 v[66:67], 0
v_mov_b64 v[80:81], 0
v_mov_b64 v[82:83], 0
v_mov_b64 v[96:97], 0
v_mov_b64 v[98:99], 0
v_mov_b64 v[92:93], 0
v_mov_b64 v[94:95], 0
s_waitcnt lgkmcnt(2)
v_smfmac_f32_16x16x64_bf16 v[72:75], v[28:31], v[100:107], v3
ds_read_b128 v[100:103], v11 offset:4096
ds_read_b128 v[104:107], v11 offset:5120
v_smfmac_f32_16x16x64_bf16 v[72:75], v[32:35], v[36:43], v3
ds_read_b128 v[36:39], v10 offset:6144
ds_read_b128 v[40:43], v10 offset:7168
v_smfmac_f32_16x16x64_bf16 v[76:79], v[28:31], v[44:51], v3
ds_read_b128 v[44:47], v11 offset:6144
ds_read_b128 v[48:51], v11 offset:7168
v_smfmac_f32_16x16x64_bf16 v[76:79], v[32:35], v[52:59], v3
ds_read_b128 v[52:55], v10 offset:8192
ds_read_b128 v[56:59], v10 offset:9216
v_add_f32 v72, v72, v73
v_smfmac_f32_16x16x64_bf16 v[68:71], v[28:31], v[112:119], v3
v_add_f32 v74, v74, v75
v_cvt_pk_bf16_f32 v109, v72, v74
v_smfmac_f32_16x16x64_bf16 v[68:71], v[32:35], v[120:127], v3
s_nop 0
v_add_f32 v76, v76, v77
v_add_f32 v78, v78, v79
s_waitcnt lgkmcnt(6)
v_smfmac_f32_16x16x64_bf16 v[60:63], v[28:31], v[84:91], v3
ds_read_b128 v[84:87], v11 offset:8192
ds_read_b128 v[88:91], v11 offset:9216
v_cvt_pk_bf16_f32 v110, v76, v78
v_smfmac_f32_16x16x64_bf16 v[60:63], v[32:35], v[100:107], v3
ds_read_b128 v[100:103], v10 offset:10240
ds_read_b128 v[104:107], v10 offset:11264
v_add_f32 v68, v68, v69
s_waitcnt lgkmcnt(6)
v_smfmac_f32_16x16x64_bf16 v[64:67], v[28:31], v[36:43], v3
ds_read_b128 v[36:39], v11 offset:10240
ds_read_b128 v[40:43], v11 offset:11264
v_add_f32 v70, v70, v71
v_cvt_pk_bf16_f32 v108, v68, v70
v_smfmac_f32_16x16x64_bf16 v[64:67], v[32:35], v[44:51], v3
ds_read_b128 v[44:47], v10 offset:12288
ds_read_b128 v[48:51], v10 offset:13312
v_add_f32 v60, v60, v61
v_add_f32 v62, v62, v63
v_cvt_pk_bf16_f32 v111, v60, v62
buffer_store_dwordx4 v[108:111], v12, s[4:7], s45 offen sc1
s_waitcnt lgkmcnt(6)
v_smfmac_f32_16x16x64_bf16 v[80:83], v[28:31], v[52:59], v3
ds_read_b128 v[52:55], v11 offset:12288
ds_read_b128 v[56:59], v11 offset:13312
v_smfmac_f32_16x16x64_bf16 v[80:83], v[32:35], v[84:91], v3
v_add_f32 v64, v64, v65
v_add_f32 v66, v66, v67
s_waitcnt lgkmcnt(4)
v_smfmac_f32_16x16x64_bf16 v[96:99], v[28:31], v[100:107], v3
v_cvt_pk_bf16_f32 v108, v64, v66
v_smfmac_f32_16x16x64_bf16 v[96:99], v[32:35], v[36:43], v3
s_nop 0
v_add_f32 v80, v80, v81
v_add_f32 v82, v82, v83
s_waitcnt lgkmcnt(0)
v_smfmac_f32_16x16x64_bf16 v[92:95], v[28:31], v[44:51], v3
v_cvt_pk_bf16_f32 v109, v80, v82
v_smfmac_f32_16x16x64_bf16 v[92:95], v[32:35], v[52:59], v3
v_add_f32 v96, v96, v97
v_add_f32 v98, v98, v99
v_cvt_pk_bf16_f32 v110, v96, v98
s_nop 4
v_add_f32 v92, v92, v93
v_add_f32 v94, v94, v95
v_cvt_pk_bf16_f32 v111, v92, v94
buffer_store_dwordx4 v[108:111], v12, s[4:7], s67 offen sc1
s_mov_b32 s44, 0
s_sleep 4
buffer_load_dwordx4 v[28:31], v1, s[4:7], s68 offen offset:0 sc1
buffer_load_dwordx4 v[32:35], v1, s[4:7], s68 offen offset:1024 sc1
buffer_load_dwordx4 v[36:39], v1, s[4:7], s68 offen offset:2048 sc1
buffer_load_dwordx4 v[40:43], v1, s[4:7], s68 offen offset:3072 sc1
buffer_load_dwordx4 v[44:47], v1, s[4:7], s48 offen offset:0 sc1
buffer_load_dwordx4 v[48:51], v1, s[4:7], s48 offen offset:1024 sc1
buffer_load_dwordx4 v[52:55], v1, s[4:7], s48 offen offset:2048 sc1
buffer_load_dwordx4 v[56:59], v1, s[4:7], s48 offen offset:3072 sc1
s_sleep 1
buffer_load_dwordx4 v[60:63], v1, s[4:7], s68 offen offset:0 sc1
buffer_load_dwordx4 v[64:67], v1, s[4:7], s68 offen offset:1024 sc1
buffer_load_dwordx4 v[68:71], v1, s[4:7], s68 offen offset:2048 sc1
buffer_load_dwordx4 v[72:75], v1, s[4:7], s68 offen offset:3072 sc1
buffer_load_dwordx4 v[76:79], v1, s[4:7], s48 offen offset:0 sc1
buffer_load_dwordx4 v[80:83], v1, s[4:7], s48 offen offset:1024 sc1
buffer_load_dwordx4 v[84:87], v1, s[4:7], s48 offen offset:2048 sc1
buffer_load_dwordx4 v[88:91], v1, s[4:7], s48 offen offset:3072 sc1
L_pr0_w2s:
s_waitcnt vmcnt(15)
v_mfma_f32_16x16x32_bf16 v[100:103], v[28:31], v[20:23], 0
v_max3_u32 v0, v28, v29, v30
v_max_u32 v0, v0, v31
s_waitcnt vmcnt(14)
v_mfma_f32_16x16x32_bf16 v[100:103], v[32:35], v[20:23], v[100:103]
v_max3_u32 v0, v0, v32, v33
v_max3_u32 v0, v0, v34, v35
s_waitcnt vmcnt(13)
v_mfma_f32_16x16x32_bf16 v[100:103], v[36:39], v[20:23], v[100:103]
v_max3_u32 v0, v0, v36, v37
v_max3_u32 v0, v0, v38, v39
s_waitcnt vmcnt(12)
v_mfma_f32_16x16x32_bf16 v[100:103], v[40:43], v[20:23], v[100:103]
v_max3_u32 v0, v0, v40, v41
v_max3_u32 v0, v0, v42, v43
s_waitcnt vmcnt(11)
v_mfma_f32_16x16x32_bf16 v[100:103], v[44:47], v[20:23], v[100:103]
v_max3_u32 v0, v0, v44, v45
v_max3_u32 v0, v0, v46, v47
s_waitcnt vmcnt(10)
v_mfma_f32_16x16x32_bf16 v[100:103], v[48:51], v[20:23], v[100:103]
v_max3_u32 v0, v0, v48, v49
v_max3_u32 v0, v0, v50, v51
s_waitcnt vmcnt(9)
v_mfma_f32_16x16x32_bf16 v[100:103], v[52:55], v[20:23], v[100:103]
v_max3_u32 v0, v0, v52, v53
v_max3_u32 v0, v0, v54, v55
s_waitcnt vmcnt(8)
v_mfma_f32_16x16x32_bf16 v[100:103], v[56:59], v[20:23], v[100:103]
v_max3_u32 v0, v0, v56, v57
v_max3_u32 v0, v0, v58, v59
v_cmp_eq_u32 vcc, -1, v0
s_cbranch_vccz L_prok_w2s
buffer_load_dwordx4 v[28:31], v1, s[4:7], s68 offen offset:0 sc1
buffer_load_dwordx4 v[32:35], v1, s[4:7], s68 offen offset:1024 sc1
buffer_load_dwordx4 v[36:39], v1, s[4:7], s68 offen offset:2048 sc1
buffer_load_dwordx4 v[40:43], v1, s[4:7], s68 offen offset:3072 sc1
buffer_load_dwordx4 v[44:47], v1, s[4:7], s48 offen offset:0 sc1
buffer_load_dwordx4 v[48:51], v1, s[4:7], s48 offen offset:1024 sc1
buffer_load_dwordx4 v[52:55], v1, s[4:7], s48 offen offset:2048 sc1
buffer_load_dwordx4 v[56:59], v1, s[4:7], s48 offen offset:3072 sc1
s_waitcnt vmcnt(15)
v_mfma_f32_16x16x32_bf16 v[100:103], v[60:63], v[20:23], 0
v_max3_u32 v0, v60, v61, v62
v_max_u32 v0, v0, v63
s_waitcnt vmcnt(14)
v_mfma_f32_16x16x32_bf16 v[100:103], v[64:67], v[20:23], v[100:103]
v_max3_u32 v0, v0, v64, v65
v_max3_u32 v0, v0, v66, v67
s_waitcnt vmcnt(13)
v_mfma_f32_16x16x32_bf16 v[100:103], v[68:71], v[20:23], v[100:103]
v_max3_u32 v0, v0, v68, v69
v_max3_u32 v0, v0, v70, v71
s_waitcnt vmcnt(12)
v_mfma_f32_16x16x32_bf16 v[100:103], v[72:75], v[20:23], v[100:103]
v_max3_u32 v0, v0, v72, v73
v_max3_u32 v0, v0, v74, v75
s_waitcnt vmcnt(11)
v_mfma_f32_16x16x32_bf16 v[100:103], v[76:79], v[20:23], v[100:103]
v_max3_u32 v0, v0, v76, v77
v_max3_u32 v0, v0, v78, v79
s_waitcnt vmcnt(10)
v_mfma_f32_16x16x32_bf16 v[100:103], v[80:83], v[20:23], v[100:103]
v_max3_u32 v0, v0, v80, v81
v_max3_u32 v0, v0, v82, v83
s_waitcnt vmcnt(9)
v_mfma_f32_16x16x32_bf16 v[100:103], v[84:87], v[20:23], v[100:103]
v_max3_u32 v0, v0, v84, v85
v_max3_u32 v0, v0, v86, v87
s_waitcnt vmcnt(8)
v_mfma_f32_16x16x32_bf16 v[100:103], v[88:91], v[20:23], v[100:103]
v_max3_u32 v0, v0, v88, v89
v_max3_u32 v0, v0, v90, v91
v_cmp_eq_u32 vcc, -1, v0
s_cbranch_vccz L_prok_w2s
buffer_load_dwordx4 v[60:63], v1, s[4:7], s68 offen offset:0 sc1
buffer_load_dwordx4 v[64:67], v1, s[4:7], s68 offen offset:1024 sc1
buffer_load_dwordx4 v[68:71], v1, s[4:7], s68 offen offset:2048 sc1
buffer_load_dwordx4 v[72:75], v1, s[4:7], s68 offen offset:3072 sc1
buffer_load_dwordx4 v[76:79], v1, s[4:7], s48 offen offset:0 sc1
buffer_load_dwordx4 v[80:83], v1, s[4:7], s48 offen offset:1024 sc1
buffer_load_dwordx4 v[84:87], v1, s[4:7], s48 offen offset:2048 sc1
buffer_load_dwordx4 v[88:91], v1, s[4:7], s48 offen offset:3072 sc1
s_add_u32 s51, s51, 1
s_cmp_gt_u32 s51, 300000
s_cbranch_scc1 L_end
s_branch L_pr0_w2s
L_prok_w2s:
s_nop 3
v_cvt_pk_bf16_f32 v104, v100, v101
v_cvt_pk_bf16_f32 v105, v102, v103
buffer_store_dwordx2 v[104:105], v13, s[4:7], s49 offen sc1
s_barrier
s_waitcnt vmcnt(1)
s_sleep 2
s_mov_b32 s46, s69
buffer_load_dwordx4 v[28:31], v1, s[4:7], s46 offen offset:0 sc1
buffer_load_dwordx4 v[32:35], v1, s[4:7], s46 offen offset:1024 sc1
v_mov_b64 v[60:61], 0
v_mov_b64 v[62:63], 0
v_mov_b64 v[64:65], 0
v_mov_b64 v[66:67], 0
v_mov_b64 v[68:69], 0
v_mov_b64 v[70:71], 0
v_mov_b64 v[72:73], 0
v_mov_b64 v[74:75], 0
v_mov_b64 v[76:77], 0
v_mov_b64 v[78:79], 0
v_mov_b64 v[80:81], 0
v_mov_b64 v[82:83], 0
v_mov_b64 v[100:101], -1
v_mov_b64 v[102:103], -1
s_add_u32 s47, s68, 4096
s_add_u32 s34, s34, 1
s_add_u32 s35, s34, 1
s_and_b32 s43, s34, 1
s_lshl_b32 s43, s43, 14
s_xor_b32 s42, s43, 16384
v_add_u32 v14, s42, v2
s_add_u32 s43, s43, 122880
s_mov_b32 m0, s43
s_add_u32 s42, s34, 1
s_cmp_eq_u32 s34, 63
s_cselect_b32 s42, 62, s42
s_lshl_b32 s64, s42, 19
s_lshl_b32 s40, s32, 14
s_add_u32 s64, s64, s40
s_add_u32 s64, s64, 8192
s_lshl_b32 s50, s34, 5
s_add_u32 s50, s50, s32
s_lshl_b32 s65, s50, 11
s_add_u32 s65, s65, 41944064
s_lshl_b32 s66, s50, 12
s_add_u32 s66, s66, 33556480
s_and_b32 s45, s34, 1
s_mul_i32 s45, s45, 262144
s_mul_i32 s40, s32, 8192
s_add_u32 s68, s45, s40
s_add_u32 s68, s68, 46137344
s_add_u32 s45, s45, s56
s_add_u32 s45, s45, 46268416
s_add_u32 s67, s45, 32768
s_add_u32 s40, s34, 1
s_and_b32 s40, s40, 3
s_lshl_b32 s40, s40, 13
s_add_u32 s69, s40, 47190016
s_add_u32 s49, s40, s57
s_add_u32 s48, s68, 4096
s_add_u32 s52, s34, 3
s_and_b32 s52, s52, 3
s_lshl_b32 s52, s52, 13
s_add_u32 s52, s52, s57
L_pa_w2s:
buffer_load_dwordx4 v[84:87], v1, s[4:7], s46 offen offset:0 sc1
buffer_load_dwordx4 v[88:91], v1, s[4:7], s46 offen offset:1024 sc1
s_waitcnt vmcnt(2)
v_max3_u32 v0, v28, v29, v30
v_max3_u32 v15, v31, v32, v33
v_max3_u32 v0, v0, v34, v35
v_max_u32 v0, v0, v15
v_cmp_eq_u32 vcc, -1, v0
s_cbranch_vccz L_paok_w2s
buffer_load_dwordx4 v[28:31], v1, s[4:7], s46 offen offset:0 sc1
buffer_load_dwordx4 v[32:35], v1, s[4:7], s46 offen offset:1024 sc1
s_add_u32 s51, s51, 1
s_cmp_gt_u32 s51, 300000
s_cbranch_scc1 L_end
s_waitcnt vmcnt(2)
v_max3_u32 v0, v84, v85, v86
v_max3_u32 v15, v87, v88, v89
v_max3_u32 v0, v0, v90, v91
v_max_u32 v0, v0, v15
v_cmp_eq_u32 vcc, -1, v0
s_cbranch_vccnz L_pa_w2s
v_mov_b64 v[28:29], v[84:85]
v_mov_b64 v[30:31], v[86:87]
v_mov_b64 v[32:33], v[88:89]
v_mov_b64 v[34:35], v[90:91]
s_branch L_paok2_w2s
L_paok_w2s:
L_paok2_w2s:
s_branch L_step_w2s
L_step_w3s:
v_smfmac_f32_16x16x64_bf16 v[60:63], v[28:31], a[48:55], v3
ds_write_b128 v2, v[28:31] offset:38912
v_smfmac_f32_16x16x64_bf16 v[64:67], v[28:31], a[112:119], v3
ds_write_b128 v2, v[32:35] offset:39936
v_smfmac_f32_16x16x64_bf16 v[68:71], v[28:31], a[176:183], v3
v_smfmac_f32_16x16x64_bf16 v[72:75], v[28:31], a[240:247], v3
v_smfmac_f32_16x16x64_bf16 v[60:63], v[32:35], a[56:63], v3
v_smfmac_f32_16x16x64_bf16 v[64:67], v[32:35], a[120:127], v3
v_smfmac_f32_16x16x64_bf16 v[68:71], v[32:35], a[184:191], v3
v_smfmac_f32_16x16x64_bf16 v[72:75], v[32:35], a[248:255], v3
s_waitcnt lgkmcnt(0)
s_barrier
ds_read_b128 v[36:39], v2 offset:32768
ds_read_b128 v[40:43], v2 offset:33792
v_smfmac_f32_16x16x64_bf16 v[76:79], v[28:31], v[176:183], v3
ds_read_b128 v[44:47], v2 offset:34816
ds_read_b128 v[48:51], v2 offset:35840
v_smfmac_f32_16x16x64_bf16 v[80:83], v[28:31], v[240:247], v3
ds_read_b128 v[52:55], v2 offset:36864
ds_read_b128 v[56:59], v2 offset:37888
v_smfmac_f32_16x16x64_bf16 v[76:79], v[32:35], v[184:191], v3
v_smfmac_f32_16x16x64_bf16 v[80:83], v[32:35], v[248:255], v3
s_waitcnt lgkmcnt(4)
v_smfmac_f32_16x16x64_bf16 v[60:63], v[36:39], a[0:7], v3
v_smfmac_f32_16x16x64_bf16 v[64:67], v[36:39], a[64:71], v3
v_smfmac_f32_16x16x64_bf16 v[60:63], v[40:43], a[8:15], v3
v_smfmac_f32_16x16x64_bf16 v[64:67], v[40:43], a[72:79], v3
s_waitcnt vmcnt(0) lgkmcnt(0)
v_smfmac_f32_16x16x64_bf16 v[60:63], v[44:47], a[16:23], v3
ds_read_b128 v[28:31], v14 offset:0
v_smfmac_f32_16x16x64_bf16 v[64:67], v[44:47], a[80:87], v3
buffer_store_dword v16, off, s[4:7], s62 sc1
s_add_u32 s62, s62, 4
ds_read_b128 v[32:35], v14 offset:1024
v_smfmac_f32_16x16x64_bf16 v[60:63], v[48:51], a[24:31], v3
ds_read_b128 v[104:107], v14 offset:5120
v_smfmac_f32_16x16x64_bf16 v[64:67], v[48:51], a[88:95], v3
buffer_store_dwordx4 v[100:103], v1, s[4:7], s47 offen offset:0 sc1
ds_read_b128 v[108:111], v14 offset:6144
v_smfmac_f32_16x16x64_bf16 v[60:63], v[52:55], a[32:39], v3
v_smfmac_f32_16x16x64_bf16 v[64:67], v[52:55], a[96:103], v3
v_smfmac_f32_16x16x64_bf16 v[60:63], v[56:59], a[40:47], v3
v_smfmac_f32_16x16x64_bf16 v[64:67], v[56:59], a[104:111], v3
buffer_store_dwordx4 v[100:103], v1, s[4:7], s47 offen offset:1024 sc1
v_smfmac_f32_16x16x64_bf16 v[68:71], v[36:39], a[128:135], v3
v_smfmac_f32_16x16x64_bf16 v[72:75], v[36:39], a[192:199], v3
ds_read_b128 v[100:103], v14 offset:4096
v_add_f32 v60, v60, v61
v_smfmac_f32_16x16x64_bf16 v[68:71], v[40:43], a[136:143], v3
v_add_f32 v62, v62, v63
v_smfmac_f32_16x16x64_bf16 v[72:75], v[40:43], a[200:207], v3
buffer_load_dwordx4 v1, s[4:7], s64 offen offset:0 sc1 lds
v_cvt_pk_bf16_f32 v0, v60, v62
v_smfmac_f32_16x16x64_bf16 v[68:71], v[44:47], a[144:151], v3
v_add_f32 v64, v64, v65
v_smfmac_f32_16x16x64_bf16 v[72:75], v[44:47], a[208:215], v3
v_add_f32 v66, v66, v67
v_smfmac_f32_16x16x64_bf16 v[68:71], v[48:51], a[152:159], v3
v_cvt_pk_bf16_f32 v15, v64, v66
v_smfmac_f32_16x16x64_bf16 v[72:75], v[48:51], a[216:223], v3
buffer_load_dwordx4 v1, s[4:7], s64 offen offset:1024 sc1 lds
ds_write2_b32 v4, v0, v15 offset0:0 offset1:64
v_smfmac_f32_16x16x64_bf16 v[68:71], v[52:55], a[160:167], v3
v_smfmac_f32_16x16x64_bf16 v[72:75], v[52:55], a[224:231], v3
ds_read_b128 v[64:67], v14 offset:7168
v_smfmac_f32_16x16x64_bf16 v[68:71], v[56:59], a[168:175], v3
v_smfmac_f32_16x16x64_bf16 v[72:75], v[56:59], a[232:239], v3
buffer_load_dwordx4 v1, s[4:7], s64 offen offset:2048 sc1 lds
v_smfmac_f32_16x16x64_bf16 v[76:79], v[36:39], v[128:135], v3
s_nop 0
v_add_f32 v68, v68, v69
v_add_f32 v70, v70, v71
v_cvt_pk_bf16_f32 v0, v68, v70
v_smfmac_f32_16x16x64_bf16 v[80:83], v[36:39], v[192:199], v3
v_add_f32 v72, v72, v73
v_add_f32 v74, v74, v75
v_cvt_pk_bf16_f32 v15, v72, v74
ds_write2_b32 v5, v0, v15 offset0:0 offset1:128
ds_read_b128 v[36:39], v14 offset:2048
v_smfmac_f32_16x16x64_bf16 v[76:79], v[40:43], v[136:143], v3
s_waitcnt lgkmcnt(0)
s_barrier
ds_read_b64_tr_b16 v[84:85], v6 offset:0
ds_read_b64_tr_b16 v[86:87], v6 offset:64
v_smfmac_f32_16x16x64_bf16 v[80:83], v[40:43], v[200:207], v3
ds_read_b64_tr_b16 v[88:89], v6 offset:512
ds_read_b64_tr_b16 v[90:91], v6 offset:576
v_smfmac_f32_16x16x64_bf16 v[76:79], v[44:47], v[144:151], v3
ds_read_b64_tr_b16 v[92:93], v6 offset:1024
ds_read_b64_tr_b16 v[94:95], v6 offset:1088
v_smfmac_f32_16x16x64_bf16 v[80:83], v[44:47], v[208:215], v3
ds_read_b64_tr_b16 v[96:97], v6 offset:1536
ds_read_b64_tr_b16 v[98:99], v6 offset:1600
v_smfmac_f32_16x16x64_bf16 v[76:79], v[48:51], v[152:159], v3
ds_read_b128 v[40:43], v14 offset:3072
v_smfmac_f32_16x16x64_bf16 v[80:83], v[48:51], v[216:223], v3
v_smfmac_f32_16x16x64_bf16 v[76:79], v[52:55], v[160:167], v3
ds_read_b64_tr_b16 v[44:45], v7 offset:0
ds_read_b64_tr_b16 v[46:47], v7 offset:128
ds_read_b64_tr_b16 v[48:49], v7 offset:1024
ds_read_b64_tr_b16 v[50:51], v7 offset:1152
v_smfmac_f32_16x16x64_bf16 v[80:83], v[52:55], v[224:231], v3
ds_read_b64_tr_b16 v[52:53], v7 offset:2048
ds_read_b64_tr_b16 v[54:55], v7 offset:2176
v_smfmac_f32_16x16x64_bf16 v[76:79], v[56:59], v[168:175], v3
v_smfmac_f32_16x16x64_bf16 v[80:83], v[56:59], v[232:239], v3
ds_read_b64_tr_b16 v[56:57], v7 offset:3072
ds_read_b64_tr_b16 v[58:59], v7 offset:3200
s_waitcnt lgkmcnt(8)
v_mfma_f32_16x16x32_bf16 v[72:75], v[100:103], v[84:87], 0
v_mfma_f32_16x16x32_bf16 v[72:75], v[104:107], v[88:91], v[72:75]
v_add_f32 v76, v76, v77
v_add_f32 v78, v78, v79
v_mfma_f32_16x16x32_bf16 v[72:75], v[108:111], v[92:95], v[72:75]
v_cvt_pk_bf16_f32 v77, v76, v78
v_add_f32 v80, v80, v81
v_mfma_f32_16x16x32_bf16 v[72:75], v[64:67], v[96:99], v[72:75]
buffer_load_dwordx4 v1, s[4:7], s64 offen offset:3072 sc1 lds
v_add_f32 v82, v82, v83
v_cvt_pk_bf16_f32 v83, v80, v82
v_mfma_f32_16x16x32_bf16 v[68:71], v[28:31], v[84:87], 0
v_mov_b32 v82, v77
v_lshrrev_b32 v15, 1, v1
ds_read_b128 v[100:103], v10 offset:0
v_mfma_f32_16x16x32_bf16 v[68:71], v[32:35], v[88:91], v[68:71]
ds_read_b128 v[104:107], v10 offset:1024
v_mfma_f32_16x16x32_bf16 v[68:71], v[36:39], v[92:95], v[68:71]
buffer_store_dwordx2 v[82:83], v15, s[4:7], s65 offen sc1
v_mfma_f32_16x16x32_bf16 v[68:71], v[40:43], v[96:99], v[68:71]
s_waitcnt lgkmcnt(2)
v_mfma_f32_16x16x32_bf16 v[60:63], v[44:47], v[84:87], 0
ds_read_b128 v[28:31], v14 offset:14336
v_max3_f32 v0, v72, v73, v74
v_mfma_f32_16x16x32_bf16 v[60:63], v[48:51], v[88:91], v[60:63]
ds_read_b128 v[32:35], v14 offset:15360
v_mfma_f32_16x16x32_bf16 v[60:63], v[52:55], v[92:95], v[60:63]
ds_read_b128 v[36:39], v11 offset:0
v_max3_f32 v0, v0, v75, v68
v_max3_f32 v0, v0, v69, v70
v_mfma_f32_16x16x32_bf16 v[60:63], v[56:59], v[96:99], v[60:63]
ds_read_b128 v[40:43], v11 offset:1024
buffer_store_dwordx4 v[56:59], v1, s[4:7], s66 offen sc1
v_max_f32 v0, v0, v71
s_cmp_eq_u32 s34, 63
s_cbranch_scc1 L_chain_fin
s_nop 1
s_nop 0
v_max3_f32 v0, v0, v60, v61
v_mov_b32 v15, v0
s_nop 1
v_permlane16_swap_b32 v0, v15
v_max_f32 v0, v0, v15
v_mov_b32 v15, v0
s_nop 1
v_permlane32_swap_b32 v0, v15
v_max_f32 v0, v0, v15
v_mul_f32 v62, s38, v0
v_pk_fma_f32 v[68:69], v[68:69], s[38:39], v[62:63] op_sel_hi:[1,1,0] neg_lo:[0,0,1] neg_hi:[0,0,1]
v_pk_fma_f32 v[70:71], v[70:71], s[38:39], v[62:63] op_sel_hi:[1,1,0] neg_lo:[0,0,1] neg_hi:[0,0,1]
v_pk_fma_f32 v[72:73], v[72:73], s[38:39], v[62:63] op_sel_hi:[1,1,0] neg_lo:[0,0,1] neg_hi:[0,0,1]
v_pk_fma_f32 v[74:75], v[74:75], s[38:39], v[62:63] op_sel_hi:[1,1,0] neg_lo:[0,0,1] neg_hi:[0,0,1]
v_pk_fma_f32 v[60:61], v[60:61], s[38:39], v[62:63] op_sel_hi:[1,1,0] neg_lo:[0,0,1] neg_hi:[0,0,1]
v_exp_f32 v68, v68
v_exp_f32 v69, v69
ds_read_b128 v[44:47], v10 offset:2048
v_exp_f32 v70, v70
v_exp_f32 v71, v71
ds_read_b128 v[48:51], v10 offset:3072
v_cvt_pk_bf16_f32 v76, v68, v69
v_exp_f32 v72, v72
v_cvt_pk_bf16_f32 v77, v70, v71
v_exp_f32 v73, v73
s_waitcnt lgkmcnt(4)
v_mfma_f32_16x16x16_bf16 v[92:95], v[16:17], v[76:77], 0
v_exp_f32 v74, v74
v_mfma_f32_16x16x16_bf16 v[84:87], v[28:29], v[76:77], 0
v_exp_f32 v75, v75
v_mfma_f32_16x16x16_bf16 v[88:91], v[32:33], v[76:77], 0
v_cvt_pk_bf16_f32 v78, v72, v73
v_exp_f32 v60, v60
v_cvt_pk_bf16_f32 v79, v74, v75
v_exp_f32 v61, v61
s_nop 0
v_mfma_f32_16x16x16_bf16 v[92:95], v[16:17], v[78:79], v[92:95]
ds_read_b128 v[52:55], v11 offset:2048
v_cvt_pk_bf16_f32 v24, v60, v61
v_mfma_f32_16x16x16_bf16 v[84:87], v[30:31], v[78:79], v[84:87]
ds_read_b128 v[56:59], v11 offset:3072
v_cvt_pk_bf16_f32 v27, v60, v61
v_mfma_f32_16x16x16_bf16 v[88:91], v[34:35], v[78:79], v[88:91]
v_mfma_f32_16x16x16_bf16 v[92:95], v[16:17], v[24:25], v[92:95]
v_mfma_f32_16x16x16_bf16 v[84:87], v[82:83], v[24:25], v[84:87]
v_mfma_f32_16x16x16_bf16 v[88:91], v[82:83], v[26:27], v[88:91]
s_nop 0
v_rcp_f32 v0, v92
s_nop 2
v_pk_mul_f32 v[84:85], v[84:85], v[0:1] op_sel_hi:[1,0]
v_pk_mul_f32 v[86:87], v[86:87], v[0:1] op_sel_hi:[1,0]
v_cvt_pk_bf16_f32 v84, v84, v85
v_cvt_pk_bf16_f32 v85, v86, v87
ds_write_b64 v8, v[84:85]
v_pk_mul_f32 v[88:89], v[88:89], v[0:1] op_sel_hi:[1,0]
v_pk_mul_f32 v[90:91], v[90:91], v[0:1] op_sel_hi:[1,0]
v_cvt_pk_bf16_f32 v88, v88, v89
v_cvt_pk_bf16_f32 v89, v90, v91
ds_write_b64 v8, v[88:89] offset:32
v_mov_b64 v[68:69], 0
v_mov_b64 v[70:71], 0
v_mov_b64 v[72:73], 0
v_mov_b64 v[74:75], 0
v_mov_b64 v[76:77], 0
v_mov_b64 v[78:79], 0
v_mov_b64 v[60:61], 0
v_mov_b64 v[62:63], 0
s_waitcnt vmcnt(6) lgkmcnt(0)
s_barrier
ds_read_b128 v[28:31], v9
ds_read_b128 v[32:35], v9 offset:128
ds_read_b128 v[84:87], v10 offset:4096
ds_read_b128 v[88:91], v10 offset:5120
v_mov_b64 v[64:65], 0
v_mov_b64 v[66:67], 0
v_mov_b64 v[80:81], 0
v_mov_b64 v[82:83], 0
v_mov_b64 v[96:97], 0
v_mov_b64 v[98:99], 0
v_mov_b64 v[92:93], 0
v_mov_b64 v[94:95], 0
s_waitcnt lgkmcnt(2)
v_smfmac_f32_16x16x64_bf16 v[72:75], v[28:31], v[100:107], v3
ds_read_b128 v[100:103], v11 offset:4096
ds_read_b128 v[104:107], v11 offset:5120
v_smfmac_f32_16x16x64_bf16 v[72:75], v[32:35], v[36:43], v3
ds_read_b128 v[36:39], v10 offset:6144
ds_read_b128 v[40:43], v10 offset:7168
v_smfmac_f32_16x16x64_bf16 v[76:79], v[28:31], v[44:51], v3
ds_read_b128 v[44:47], v11 offset:6144
ds_read_b128 v[48:51], v11 offset:7168
v_smfmac_f32_16x16x64_bf16 v[76:79], v[32:35], v[52:59], v3
ds_read_b128 v[52:55], v10 offset:8192
ds_read_b128 v[56:59], v10 offset:9216
v_add_f32 v72, v72, v73
v_smfmac_f32_16x16x64_bf16 v[68:71], v[28:31], v[112:119], v3
v_add_f32 v74, v74, v75
v_cvt_pk_bf16_f32 v109, v72, v74
v_smfmac_f32_16x16x64_bf16 v[68:71], v[32:35], v[120:127], v3
s_nop 0
v_add_f32 v76, v76, v77
v_add_f32 v78, v78, v79
s_waitcnt lgkmcnt(6)
v_smfmac_f32_16x16x64_bf16 v[60:63], v[28:31], v[84:91], v3
ds_read_b128 v[84:87], v11 offset:8192
ds_read_b128 v[88:91], v11 offset:9216
v_cvt_pk_bf16_f32 v110, v76, v78
v_smfmac_f32_16x16x64_bf16 v[60:63], v[32:35], v[100:107], v3
ds_read_b128 v[100:103], v10 offset:10240
ds_read_b128 v[104:107], v10 offset:11264
v_add_f32 v68, v68, v69
s_waitcnt lgkmcnt(6)
v_smfmac_f32_16x16x64_bf16 v[64:67], v[28:31], v[36:43], v3
ds_read_b128 v[36:39], v11 offset:10240
ds_read_b128 v[40:43], v11 offset:11264
v_add_f32 v70, v70, v71
v_cvt_pk_bf16_f32 v108, v68, v70
v_smfmac_f32_16x16x64_bf16 v[64:67], v[32:35], v[44:51], v3
ds_read_b128 v[44:47], v10 offset:12288
ds_read_b128 v[48:51], v10 offset:13312
v_add_f32 v60, v60, v61
v_add_f32 v62, v62, v63
v_cvt_pk_bf16_f32 v111, v60, v62
buffer_store_dwordx4 v[108:111], v12, s[4:7], s45 offen sc1
s_waitcnt lgkmcnt(6)
v_smfmac_f32_16x16x64_bf16 v[80:83], v[28:31], v[52:59], v3
ds_read_b128 v[52:55], v11 offset:12288
ds_read_b128 v[56:59], v11 offset:13312
v_smfmac_f32_16x16x64_bf16 v[80:83], v[32:35], v[84:91], v3
v_add_f32 v64, v64, v65
v_add_f32 v66, v66, v67
s_waitcnt lgkmcnt(4)
v_smfmac_f32_16x16x64_bf16 v[96:99], v[28:31], v[100:107], v3
v_cvt_pk_bf16_f32 v108, v64, v66
v_smfmac_f32_16x16x64_bf16 v[96:99], v[32:35], v[36:43], v3
s_nop 0
v_add_f32 v80, v80, v81
v_add_f32 v82, v82, v83
s_waitcnt lgkmcnt(0)
v_smfmac_f32_16x16x64_bf16 v[92:95], v[28:31], v[44:51], v3
v_cvt_pk_bf16_f32 v109, v80, v82
v_smfmac_f32_16x16x64_bf16 v[92:95], v[32:35], v[52:59], v3
v_add_f32 v96, v96, v97
v_add_f32 v98, v98, v99
v_cvt_pk_bf16_f32 v110, v96, v98
s_nop 4
v_add_f32 v92, v92, v93
v_add_f32 v94, v94, v95
v_cvt_pk_bf16_f32 v111, v92, v94
buffer_store_dwordx4 v[108:111], v12, s[4:7], s67 offen sc1
s_mov_b32 s46, s69
v_mov_b64 v[60:61], 0
v_mov_b64 v[62:63], 0
v_mov_b64 v[64:65], 0
v_mov_b64 v[66:67], 0
v_mov_b64 v[68:69], 0
v_mov_b64 v[70:71], 0
v_mov_b64 v[72:73], 0
v_mov_b64 v[74:75], 0
v_mov_b64 v[76:77], 0
v_mov_b64 v[78:79], 0
v_mov_b64 v[80:81], 0
v_mov_b64 v[82:83], 0
v_mov_b64 v[100:101], -1
v_mov_b64 v[102:103], -1
s_add_u32 s47, s68, 6144
s_add_u32 s34, s34, 1
s_add_u32 s35, s34, 1
s_and_b32 s43, s34, 1
s_lshl_b32 s43, s43, 14
s_xor_b32 s42, s43, 16384
v_add_u32 v14, s42, v2
s_add_u32 s43, s43, 126976
s_mov_b32 m0, s43
s_add_u32 s42, s34, 1
s_cmp_eq_u32 s34, 63
s_cselect_b32 s42, 62, s42
s_lshl_b32 s64, s42, 19
s_lshl_b32 s40, s32, 14
s_add_u32 s64, s64, s40
s_add_u32 s64, s64, 12288
s_lshl_b32 s50, s34, 5
s_add_u32 s50, s50, s32
s_lshl_b32 s65, s50, 11
s_add_u32 s65, s65, 41944576
s_lshl_b32 s66, s50, 12
s_add_u32 s66, s66, 33557504
s_and_b32 s45, s34, 1
s_mul_i32 s45, s45, 262144
s_mul_i32 s40, s32, 8192
s_add_u32 s68, s45, s40
s_add_u32 s68, s68, 46137344
s_add_u32 s45, s45, s56
s_add_u32 s45, s45, 46333952
s_add_u32 s67, s45, 32768
s_add_u32 s40, s34, 1
s_and_b32 s40, s40, 3
s_lshl_b32 s40, s40, 13
s_add_u32 s69, s40, 47192064
s_barrier
s_sleep 3
buffer_load_dwordx4 v[28:31], v1, s[4:7], s46 offen offset:0 sc1
buffer_load_dwordx4 v[32:35], v1, s[4:7], s46 offen offset:1024 sc1
s_sleep 1
L_pa_w3s:
buffer_load_dwordx4 v[84:87], v1, s[4:7], s46 offen offset:0 sc1
buffer_load_dwordx4 v[88:91], v1, s[4:7], s46 offen offset:1024 sc1
s_waitcnt vmcnt(2)
v_max3_u32 v0, v28, v29, v30
v_max3_u32 v15, v31, v32, v33
v_max3_u32 v0, v0, v34, v35
v_max_u32 v0, v0, v15
v_cmp_eq_u32 vcc, -1, v0
s_cbranch_vccz L_paok_w3s
buffer_load_dwordx4 v[28:31], v1, s[4:7], s46 offen offset:0 sc1
buffer_load_dwordx4 v[32:35], v1, s[4:7], s46 offen offset:1024 sc1
s_add_u32 s51, s51, 1
s_cmp_gt_u32 s51, 300000
s_cbranch_scc1 L_end
s_waitcnt vmcnt(2)
v_max3_u32 v0, v84, v85, v86
v_max3_u32 v15, v87, v88, v89
v_max3_u32 v0, v0, v90, v91
v_max_u32 v0, v0, v15
v_cmp_eq_u32 vcc, -1, v0
s_cbranch_vccnz L_pa_w3s
v_mov_b64 v[28:29], v[84:85]
v_mov_b64 v[30:31], v[86:87]
v_mov_b64 v[32:33], v[88:89]
v_mov_b64 v[34:35], v[90:91]
s_branch L_paok2_w3s
L_paok_w3s:
L_paok2_w3s:
s_branch L_step_w3s
L_chain_fin:
s_waitcnt vmcnt(0)
s_barrier
s_cmp_lg_u32 s33, 3
s_cbranch_scc1 L_end
buffer_store_dword v16, off, s[4:7], s62 sc1
s_branch L_end
L_end:
s_endpgm
.section .rodata,"a"
.p2align 6
.amdhsa_kernel adaLN_cond__memory_aug_recurrent_mem_tr__dense_activation_gelu__prompt_kernel
  .amdhsa_next_free_vgpr 512
  .amdhsa_next_free_sgpr 102
  .amdhsa_accum_offset 256
  .amdhsa_group_segment_fixed_size 0
  .amdhsa_kernarg_size 136
  .amdhsa_user_sgpr_count 2
  .amdhsa_user_sgpr_kernarg_segment_ptr 1
  .amdhsa_system_sgpr_workgroup_id_x 1
.end_amdhsa_kernel
```
